```python
import torch

def _softmax(x, axis=-1):
    return torch.softmax(x, dim=axis)
def _gelu(x):
    return torch.nn.functional.gelu(x, approximate="tanh")
def _silu(x):
    return torch.nn.functional.silu(x)
def _sigmoid(x):
    return torch.sigmoid(x)
def _layernorm(x, axis=-1, eps=1e-5):
    m = x.mean(dim=axis, keepdim=True)
    v = x.var(dim=axis, keepdim=True, unbiased=False)
    return (x - m) / torch.sqrt(v + eps)
def _scatter_add(tgt, idx, src, axis=0):
    return tgt.clone().index_add_(axis, idx, src)
def _segment_sum(src, seg, n):
    out = torch.zeros((n,) + src.shape[1:], dtype=src.dtype)
    return out.index_add_(0, seg, src)
def _pad(x, pw):
    flat = tuple(v for pair in reversed(pw) for v in pair)
    return torch.nn.functional.pad(x, flat)

kernel_name = 'interleave_layers__linear_kernel_hedgehog__ssm_conv_s4d__prompt'

def setup_inputs():

    _w = (lambda a: (lambda t: t.to(torch.bfloat16) if t.is_floating_point() else t)(torch.as_tensor(a)))
    def _A_setup():
        B, S, D, H = 1, 2048, 512, 32
        Dh = D // H
        return {
            "x": _w((lambda *s: torch.randn(*s, dtype=torch.bfloat16) * 0.05)(B, S, D)),
            "wqkv": _w((lambda *s: torch.randn(*s, dtype=torch.bfloat16) * 0.4)(D, 3 * D)),
            "w_phi": _w((lambda *s: torch.randn(*s, dtype=torch.bfloat16) * 0.4)(H, Dh, Dh) * (Dh ** -0.5)),
            "wo": _w((lambda *s: torch.randn(*s, dtype=torch.bfloat16) * 0.05)(D, D)),
        }
    _A_in = _A_setup()

    def _B_setup():
        Bsz, L, D, N = 1, 2048, 512, 128
        return {
            "u": _w((lambda *s: torch.randn(*s, dtype=torch.bfloat16) * 0.05)(Bsz, L, D)),
            "log_A_real": _w((lambda *s: torch.randn(*s, dtype=torch.bfloat16) * 6.4)(D, N) * 0.5),
            "A_imag": _w((lambda *s: torch.randn(*s, dtype=torch.bfloat16) * 0.4)(D, N) * 3.14),
            "C_real": _w((lambda *s: torch.randn(*s, dtype=torch.bfloat16) * 0.4)(D, N) / N ** 0.5),
            "C_imag": _w((lambda *s: torch.randn(*s, dtype=torch.bfloat16) * 0.4)(D, N) / N ** 0.5),
            "log_dt": _w((lambda *s: torch.randn(*s, dtype=torch.bfloat16) * 0.4)(D) * 0.5 - 4.0),
            "D_skip": _w((lambda *s: torch.randn(*s, dtype=torch.bfloat16) * 0.4)(D)),
        }
    _B_in = _B_setup()

    return {
        "A_x": _A_in["x"],
        "A_wqkv": _A_in["wqkv"],
        "A_w_phi": _A_in["w_phi"],
        "A_wo": _A_in["wo"],
        "B_u": _B_in["u"],
        "B_log_A_real": _B_in["log_A_real"],
        "B_A_imag": _B_in["A_imag"],
        "B_C_real": _B_in["C_real"],
        "B_C_imag": _B_in["C_imag"],
        "B_log_dt": _B_in["log_dt"],
        "B_D_skip": _B_in["D_skip"],
    }

def reference(A_x, A_wqkv, A_w_phi, A_wo, B_u, B_log_A_real, B_A_imag, B_C_real, B_C_imag, B_log_dt, B_D_skip):
    def _A_ref(x, wqkv, w_phi, wo):
        B, S, D = x.shape
        H = 32; Dh = D // H
        qkv = (lambda x, *d: x.permute(*d))((x @ wqkv).reshape(B, S, 3, H, Dh), 2, 0, 3, 1, 4)
        q, k, v = qkv[0], qkv[1], qkv[2]
        pq = torch.einsum("bhsd,hdf->bhsf", q, w_phi)
        pk = torch.einsum("bhsd,hdf->bhsf", k, w_phi)
        phi_q = torch.concatenate([_softmax(pq, axis=-1), _softmax(-pq, axis=-1)], axis=-1)
        phi_k = torch.concatenate([_softmax(pk, axis=-1), _softmax(-pk, axis=-1)], axis=-1)
        kv = torch.einsum("bhsf,bhsd->bhfd", phi_k, v)
        z  = torch.einsum("bhsf->bhf", phi_k)
        num = torch.einsum("bhqf,bhfd->bhqd", phi_q, kv)
        den = torch.einsum("bhqf,bhf->bhq", phi_q, z)[..., None] + 1e-6
        o = num / den
        return (lambda x, *d: x.permute(*d))(o, 0, 2, 1, 3).reshape(B, S, D) @ wo

    def _B_ref(u, log_A_real, A_imag, C_real, C_imag, log_dt, D_skip):
        L = u.shape[1]
        dt = torch.exp(log_dt)
        A = -torch.exp(log_A_real) + 1j * A_imag
        C = (C_real + 1j * C_imag) * dt[:, None]
        pos = (lambda x, dt: x.to(dt))(torch.arange(L), log_dt.dtype)
        P = torch.exp((A * dt[:, None])[:, :, None] * pos[None, None, :])
        K = 2.0 * torch.einsum("dn,dnl->dl", C, P).real
        L2 = 2 * L
        u_t = (lambda x, *d: x.permute(*d))(u, 0, 2, 1)
        Kf = (lambda x, *a, **k: torch.fft.rfft(x.float(), *a, **k))(K, L2)
        Uf = (lambda x, *a, **k: torch.fft.rfft(x.float(), *a, **k))(u_t, L2)
        y = (lambda x, *a, **k: torch.fft.irfft(x, *a, **k).to(torch.bfloat16))(Uf * Kf[None, :, :], L2)[:, :, :L]
        y = (lambda x, *d: x.permute(*d))(y, 0, 2, 1)
        return y + u * D_skip[None, None, :]

    x = A_x
    x = x + _A_ref(_layernorm(x, axis=-1), A_wqkv, A_w_phi, A_wo)
    x = x + _B_ref(_layernorm(x, axis=-1), B_log_A_real, B_A_imag, B_C_real, B_C_imag, B_log_dt, B_D_skip)
    x = x + _A_ref(_layernorm(x, axis=-1), A_wqkv, A_w_phi, A_wo)
    x = x + _B_ref(_layernorm(x, axis=-1), B_log_A_real, B_A_imag, B_C_real, B_C_imag, B_log_dt, B_D_skip)
    return x
```

```asm
; @launch grid=(256,1,1) block=(256,1,1) lds=163840
.amdgcn_target "amdgcn-amd-amdhsa--gfx950"
.text
.globl interleave_layers__linear_kernel_hedgehog__ssm_conv_s4d__prompt_kernel
.p2align 8
.type interleave_layers__linear_kernel_hedgehog__ssm_conv_s4d__prompt_kernel,@function
interleave_layers__linear_kernel_hedgehog__ssm_conv_s4d__prompt_kernel:
  s_cmp_ge_u32 s2, 256
  s_cbranch_scc1 L_end
  s_load_dwordx8 s[4:11], s[0:1], 0
  s_load_dwordx2 s[26:27], s[0:1], 104
  s_load_dwordx8 s[12:19], s[0:1], 40
  s_load_dwordx4 s[20:23], s[0:1], 72
  s_load_dwordx2 s[24:25], s[0:1], 88
  s_mov_b32 s42, s2
  v_and_b32 v1, 63, v0
  s_getpc_b64 s[56:57]
L_pc:
  s_lshr_b32 s58, s2, 3
  s_mul_i32 s58, s58, (L_end-L_pc)/32+128
  v_lshlrev_b32 v4, 3, v0
  v_add_u32 v4, s58, v4
  v_min_u32 v4, L_end-L_pc-8, v4
  global_load_dwordx2 a[252:253], v4, s[56:57]
  v_lshrrev_b32 v2, 6, v0
  s_nop 0
  v_readfirstlane_b32 s30, v2
  v_lshrrev_b32 v2, 5, v1
  v_and_b32 v3, 31, v1
  s_and_b32 s31, s2, 7
  s_lshr_b32 s32, s2, 3
  s_and_b32 s44, s32, 3
  s_lshl_b32 s33, s31, 2
  s_add_u32 s33, s33, s44
  s_lshr_b32 s34, s32, 2
  s_and_b32 s44, s34, 1
  s_lshl_b32 s35, s33, 1
  s_add_u32 s35, s35, s44
  s_lshr_b32 s36, s34, 1
  s_lshl_b32 s37, s31, 6
  s_lshl_b32 s44, s32, 1
  s_add_u32 s37, s37, s44
  s_lshl_b32 s39, s30, 10
  s_and_b32 s40, s30, 1
  s_lshr_b32 s41, s30, 1
  s_lshl_b32 s67, s34, 5
  s_add_u32 s67, s67, s33
  v_lshrrev_b32 v148, 3, v1
  s_lshl_b32 s44, s30, 3
  v_add_u32 v148, s44, v148
  v_mul_u32_u24 v148, 3072, v148
  s_lshl_b32 s44, s34, 7
  v_add_u32 v148, s44, v148
  v_bfe_u32 v150, v1, 4, 1
  v_lshlrev_b32 v150, 2, v150
  v_and_b32 v151, 7, v1
  v_xor_b32 v150, v150, v151
  v_xor_b32 v151, 2, v150
  v_lshl_add_u32 v149, v151, 4, v148
  v_lshl_add_u32 v148, v150, 4, v148
  v_lshrrev_b32 v152, 3, v1
  v_lshrrev_b32 v153, 1, v152
  s_lshl_b32 s44, s40, 2
  v_add_u32 v153, s44, v153
  v_and_b32 v154, 7, v1
  v_xor_b32 v153, v153, v154
  v_lshlrev_b32 v153, 4, v153
  s_lshl_b32 s44, s33, 6
  s_lshl_b32 s45, s30, 3
  s_add_u32 s44, s44, s45
  v_add_u32 v152, s44, v152
  v_lshlrev_b32 v152, 10, v152
  v_add_u32 v152, v152, v153
  s_waitcnt lgkmcnt(0)
  s_load_dword s38, s[26:27], 0
  s_mov_b32 s88, s26
  s_and_b32 s89, s27, 0xffff
  s_mov_b32 s90, 0x10000000
  s_mov_b32 s91, 0x20000
  s_mov_b32 s92, s24
  s_and_b32 s93, s25, 0xffff
  s_mov_b32 s94, 0x200000
  s_mov_b32 s95, 0x20000
  v_lshlrev_b32 v122, 21, v0
  v_min_u32 v122, 20971516, v122
  v_cmp_gt_u32 vcc, 10, v0
  s_nop 2
  s_and_saveexec_b64 s[46:47], vcc
  s_cbranch_execz L_pt_1
  buffer_load_dword a250, v122, s[88:91], 0 offen
L_pt_1:
  s_mov_b64 exec, s[46:47]
  v_mov_b32 v122, 0
  s_mov_b64 exec, 1
  buffer_load_dword a249, v122, s[92:95], 0 offen
  global_load_dword a248, v122, s[10:11]
  s_mov_b64 exec, -1
  s_mov_b64 exec, 1
  global_load_dword a245, v122, s[4:5]
  global_load_dword a244, v122, s[8:9]
  global_load_dword a243, v122, s[6:7]
  s_mov_b64 exec, -1
  s_lshl_b32 s44, s37, 8
  v_lshlrev_b32 v54, 1, v0
  v_add_u32 v54, s44, v54
  global_load_ushort v36, v54, s[12:13]
  global_load_ushort v37, v54, s[14:15]
  global_load_ushort v38, v54, s[16:17]
  global_load_ushort v39, v54, s[18:19]
  v_lshrrev_b32 v55, 7, v0
  v_add_u32 v55, s37, v55
  v_lshlrev_b32 v55, 1, v55
  global_load_ushort v40, v55, s[20:21]
  v_xor_b32 v54, 128, v54
  global_load_ushort v41, v54, s[16:17]
  global_load_ushort v42, v54, s[18:19]
  s_lshl_b32 s44, s37, 1
  s_add_u32 s46, s22, s44
  s_addc_u32 s47, s23, 0
  s_load_dword s66, s[46:47], 0
  s_add_u32 m0, s39, 65536
  v_add_u32 v150, 1024, v148
  global_load_lds_dwordx4 v150, s[6:7]
  s_add_u32 m0, s39, 69632
  v_add_u32 v150, 99328, v148
  global_load_lds_dwordx4 v150, s[6:7]
  s_add_u32 m0, s39, 73728
  v_add_u32 v150, 197632, v148
  global_load_lds_dwordx4 v150, s[6:7]
  s_add_u32 m0, s39, 77824
  v_add_u32 v150, 295936, v148
  global_load_lds_dwordx4 v150, s[6:7]
  s_add_u32 m0, s39, 81920
  v_add_u32 v150, 394240, v148
  global_load_lds_dwordx4 v150, s[6:7]
  s_add_u32 m0, s39, 86016
  v_add_u32 v150, 492544, v148
  global_load_lds_dwordx4 v150, s[6:7]
  s_add_u32 m0, s39, 90112
  v_add_u32 v150, 590848, v148
  global_load_lds_dwordx4 v150, s[6:7]
  s_add_u32 m0, s39, 94208
  v_add_u32 v150, 689152, v148
  global_load_lds_dwordx4 v150, s[6:7]
  s_add_u32 m0, s39, 98304
  v_add_u32 v150, 2048, v149
  global_load_lds_dwordx4 v150, s[6:7]
  s_add_u32 m0, s39, 102400
  v_add_u32 v150, 100352, v149
  global_load_lds_dwordx4 v150, s[6:7]
  s_add_u32 m0, s39, 106496
  v_add_u32 v150, 198656, v149
  global_load_lds_dwordx4 v150, s[6:7]
  s_add_u32 m0, s39, 110592
  v_add_u32 v150, 296960, v149
  global_load_lds_dwordx4 v150, s[6:7]
  v_bfe_u32 v54, v1, 2, 1
  v_lshlrev_b32 v54, 14, v54
  v_bfe_u32 v55, v1, 1, 1
  v_lshl_add_u32 v54, v55, 13, v54
  v_and_b32 v55, 1, v1
  v_lshl_add_u32 v54, v55, 2, v54
  s_lshl_b32 s44, s33, 8
  s_lshl_b32 s45, s40, 7
  s_add_u32 s44, s44, s45
  s_lshl_b32 s45, s34, 4
  s_add_u32 s44, s44, s45
  s_lshl_b32 s45, s41, 3
  s_add_u32 s44, s44, s45
  s_add_u32 s44, s44, 262144
  v_add_u32 v54, s44, v54
  v_mov_b32 v55, 0
  s_mov_b64 exec, 0xff
  buffer_store_dword v55, v54, s[88:91], 0 offen sc1
  s_mov_b64 exec, -1
  s_waitcnt lgkmcnt(0)
  s_add_u32 s38, s38, 0x9e3779b9
  s_getreg_b32 s69, hwreg(HW_REG_XCC_ID)
  s_and_b32 s69, s69, 15
  s_lshl_b32 s44, s33, 6
  s_lshl_b32 s45, s34, 3
  s_add_u32 s44, s44, s45
  s_add_u32 s44, s44, 491520
  v_mov_b32 v54, s44
  v_mov_b32 v126, s69
  v_mov_b32 v127, s38
  s_mov_b64 exec, 1
  buffer_store_dwordx2 v[126:127], v54, s[88:91], 0 offen sc1
  s_mov_b64 exec, -1
  s_waitcnt vmcnt(14)
  s_add_u32 m0, s39, 114688
  v_add_u32 v150, 395264, v149
  global_load_lds_dwordx4 v150, s[6:7]
  v_bfe_u32 v56, v1, 2, 2
  v_lshl_add_u32 v57, v2, 3, v56
  v_lshlrev_b32 v57, 7, v57
  v_and_b32 v58, 1, v1
  v_lshl_add_u32 v57, v58, 3, v57
  v_bfe_u32 v56, v1, 3, 1
  v_lshlrev_b32 v56, 2, v56
  v_bfe_u32 v58, v1, 4, 1
  v_bfe_u32 v59, v1, 1, 1
  s_lshl_b32 s44, s30, 1
  v_add_u32 v44, s44, v59
  v_lshl_add_u32 v47, v58, 1, v56
  v_xor_b32 v44, v44, v47
  v_lshl_add_u32 v44, v44, 4, v57
  s_add_u32 m0, s39, 118784
  v_add_u32 v150, 493568, v149
  global_load_lds_dwordx4 v150, s[6:7]
  v_sub_u32 v45, 1, v58
  v_lshlrev_b32 v45, 16, v45
  v_add3_u32 v45, v45, v44, 0
  v_add_u32 v45, 65536, v45
  v_lshl_add_u32 v44, v58, 15, v44
  v_add_u32 v44, 65536, v44
  s_lshl_b32 s44, s41, 2
  v_lshl_add_u32 v47, v58, 1, v59
  v_add_u32 v47, s44, v47
  v_xor_b32 v47, v47, v56
  v_lshl_add_u32 v47, v47, 4, v57
  v_add_u32 v47, 98304, v47
  v_and_b32 v144, 15, v1
  v_bfe_u32 v145, v1, 4, 1
  s_add_u32 m0, s39, 122880
  v_add_u32 v150, 591872, v149
  global_load_lds_dwordx4 v150, s[6:7]
  v_cmp_eq_u32 vcc, v144, v145
  v_mov_b32 v145, 0x3f803f80
  s_nop 0
  v_cndmask_b32 v144, 0, v145, vcc
  v_mov_b32 v145, v144
  v_mov_b32 v146, v144
  v_mov_b32 v147, v144
  s_xor_b32 s45, s40, 1
  v_bfe_u32 v24, v3, 1, 3
  v_lshlrev_b32 v25, 7, v3
  s_lshl_b32 s44, s40, 12
  s_lshl_b32 s45, s45, 12
  v_add_u32 v26, 0, v2
  v_xor_b32 v26, v26, v24
  v_lshl_add_u32 v26, v26, 4, v25
  s_add_u32 m0, s39, 126976
  v_add_u32 v150, 690176, v149
  global_load_lds_dwordx4 v150, s[6:7]
  v_add_u32 v112, s44, v26
  v_add_u32 v116, s45, v26
  v_add_u32 v26, 2, v2
  v_xor_b32 v26, v26, v24
  v_lshl_add_u32 v26, v26, 4, v25
  v_add_u32 v113, s44, v26
  v_add_u32 v117, s45, v26
  v_add_u32 v26, 4, v2
  v_xor_b32 v26, v26, v24
  v_lshl_add_u32 v26, v26, 4, v25
  v_add_u32 v114, s44, v26
  v_add_u32 v118, s45, v26
  v_add_u32 v26, 6, v2
  v_xor_b32 v26, v26, v24
  s_add_u32 m0, s39, 0
  v_add_u32 v153, 0, v152
  global_load_lds_dwordx4 v153, s[4:5]
  v_lshl_add_u32 v26, v26, 4, v25
  v_add_u32 v115, s44, v26
  v_add_u32 v119, s45, v26
  v_mov_b32 v24, s41
  v_cmp_eq_u32 vcc, 0, v24
  s_nop 1
  v_cndmask_b32 v24, v113, v112, vcc
  v_cndmask_b32 v25, v115, v114, vcc
  v_lshlrev_b32 v96, 3, v3
  s_lshl_b32 s44, s30, 8
  s_add_u32 s44, s44, 94208
  v_add_u32 v12, s44, v96
  s_lshl_b32 s44, s40, 8
  s_add_u32 s45, s44, 94208
  s_xor_b32 s44, s44, 256
  s_add_u32 m0, s39, 4096
  v_add_u32 v153, 32768, v152
  global_load_lds_dwordx4 v153, s[4:5]
  s_add_u32 s44, s44, 94208
  v_add_u32 v13, s45, v96
  v_add_u32 v14, s44, v96
  v_mul_u32_u24 v97, 80, v3
  v_lshl_add_u32 v97, v2, 5, v97
  s_mul_i32 s44, s30, 5120
  s_add_u32 s44, s44, 65536
  s_mul_i32 s45, s40, 2560
  s_xor_b32 s46, s40, 1
  s_mul_i32 s47, s46, 2560
  s_add_u32 s45, s45, s44
  s_add_u32 s47, s47, s44
  v_add_u32 v15, s45, v97
  v_add_u32 v16, s47, v97
  s_add_u32 m0, s39, 8192
  v_add_u32 v153, 128, v152
  global_load_lds_dwordx4 v153, s[4:5]
  v_bfe_u32 v97, v3, 3, 1
  v_lshlrev_b32 v97, 2, v97
  v_xor_b32 v97, v3, v97
  v_lshlrev_b32 v97, 5, v97
  v_lshl_add_u32 v97, v2, 3, v97
  s_lshl_b32 s44, s30, 11
  s_add_u32 s44, s44, 86016
  s_lshl_b32 s45, s40, 10
  s_lshl_b32 s46, s46, 10
  s_add_u32 s45, s45, s44
  s_add_u32 s46, s46, s44
  v_add_u32 v17, s45, v97
  v_add_u32 v18, s46, v97
  v_lshrrev_b32 v96, 4, v1
  s_add_u32 m0, s39, 12288
  v_add_u32 v153, 32896, v152
  global_load_lds_dwordx4 v153, s[4:5]
  v_bfe_u32 v97, v1, 2, 2
  v_lshl_add_u32 v98, v96, 3, v97
  v_mul_u32_u24 v19, 80, v98
  v_and_b32 v99, 3, v1
  v_lshl_add_u32 v19, v99, 3, v19
  s_mul_i32 s44, s30, 5120
  s_add_u32 s44, s44, 65536
  v_add_u32 v19, s44, v19
  v_and_b32 v100, 1, v96
  v_lshlrev_b32 v100, 2, v100
  v_xor_b32 v97, v98, v100
  v_xor_b32 v98, 4, v97
  v_lshlrev_b32 v97, 5, v97
  v_lshlrev_b32 v98, 5, v98
  s_add_u32 m0, s39, 16384
  v_add_u32 v153, 256, v152
  global_load_lds_dwordx4 v153, s[4:5]
  v_lshl_add_u32 v97, v99, 3, v97
  v_lshl_add_u32 v98, v99, 3, v98
  s_lshl_b32 s44, s30, 11
  s_add_u32 s44, s44, 86016
  v_add_u32 v23, s44, v97
  v_add_u32 v26, s44, v98
  s_mul_i32 s45, s67, 9216
  s_add_u32 s45, s45, 1048576
  s_lshl_b32 s46, s30, 11
  s_add_u32 s46, s46, s45
  v_and_b32 v97, 15, v1
  v_lshlrev_b32 v97, 7, v97
  v_lshl_add_u32 v97, v96, 4, v97
  v_add_u32 v27, s46, v97
  s_add_u32 m0, s39, 20480
  v_add_u32 v153, 33024, v152
  global_load_lds_dwordx4 v153, s[4:5]
  s_lshl_b32 s46, s30, 8
  s_add_u32 s46, s46, s45
  s_add_u32 s46, s46, 8192
  v_lshlrev_b32 v97, 3, v1
  v_add_u32 v120, s46, v97
  v_lshlrev_b32 v97, 4, v2
  s_lshl_b32 s44, s30, 7
  s_add_u32 s44, s44, 107520
  v_add_u32 v121, s44, v97
  v_lshlrev_b32 v218, 16, v36
  v_lshlrev_b32 v219, 16, v37
  v_lshlrev_b32 v220, 16, v38
  v_lshlrev_b32 v221, 16, v39
  v_lshlrev_b32 v222, 16, v40
  s_add_u32 m0, s39, 24576
  v_add_u32 v153, 384, v152
  global_load_lds_dwordx4 v153, s[4:5]
  v_mul_f32 v216, 0x3fb8aa3b, v222
  v_mov_b32 v217, 0x3fb8aa3b
  v_fma_f32 v217, v222, v217, -v216
  v_fmac_f32 v217, 0x32a57060, v222
  v_exp_f32 v223, v216
  v_mul_f32 v217, 0x3f317218, v217
  v_fmac_f32 v223, v223, v217
  v_cvt_pk_bf16_f32 v223, v223, v223
  v_lshlrev_b32 v223, 16, v223
  v_mul_f32 v216, 0x3fb8aa3b, v218
  v_mov_b32 v217, 0x3fb8aa3b
  v_fma_f32 v217, v218, v217, -v216
  v_fmac_f32 v217, 0x32a57060, v218
  v_exp_f32 v224, v216
  s_add_u32 m0, s39, 28672
  v_add_u32 v153, 33152, v152
  global_load_lds_dwordx4 v153, s[4:5]
  v_mul_f32 v217, 0x3f317218, v217
  v_fmac_f32 v224, v224, v217
  v_cvt_pk_bf16_f32 v224, v224, v224
  v_lshlrev_b32 v224, 16, v224
  v_mul_f32 v225, v224, v223
  v_mul_f32 v225, 0xbfb8aa3b, v225
  v_mul_f32 v226, v219, v223
  v_mul_f32 v226, 0.15915494, v226
  v_lshlrev_b32 v216, 16, v41
  v_lshlrev_b32 v217, 16, v42
  v_max_f32 v227, |v220|, |v221|
  v_max3_f32 v227, |v216|, |v217|, v227
  s_nop 1
  v_mov_b32_dpp v216, v227 row_ror:1 row_mask:0xf bank_mask:0xf
  v_max_f32 v227, v227, v216
  s_add_u32 m0, s39, 131072
  v_add_u32 v150, 787456, v148
  global_load_lds_dwordx4 v150, s[6:7]
  v_mov_b32_dpp v216, v227 row_ror:2 row_mask:0xf bank_mask:0xf
  v_max_f32 v227, v227, v216
  s_nop 1
  v_mov_b32_dpp v216, v227 row_ror:4 row_mask:0xf bank_mask:0xf
  v_max_f32 v227, v227, v216
  s_nop 1
  v_mov_b32_dpp v216, v227 row_ror:8 row_mask:0xf bank_mask:0xf
  v_max_f32 v227, v227, v216
  v_mov_b32 v216, v227
  s_nop 1
  v_permlane16_swap_b32 v227, v216
  v_max_f32 v227, v227, v216
  v_mov_b32 v216, v227
  s_nop 1
  v_permlane32_swap_b32 v227, v216
  v_max_f32 v227, v227, v216
  v_lshrrev_b32 v227, 23, v227
  v_max_u32 v227, 1, v227
  s_add_u32 m0, s39, 135168
  v_add_u32 v150, 885760, v148
  global_load_lds_dwordx4 v150, s[6:7]
  v_min_u32 v227, 253, v227
  v_sub_u32 v217, 254, v227
  v_lshlrev_b32 v217, 23, v217
  v_lshlrev_b32 v216, 23, v227
  v_mul_f32 v216, v216, v223
  v_mul_f32 v213, 0x3d000000, v216
  v_mul_f32 v220, v220, v217
  v_mul_f32 v221, v221, v217
  v_mul_f32 v216, 0x3f800000, v225
  v_exp_f32 v216, v216
  v_mul_f32 v217, 0x3f800000, v226
  v_fract_f32 v217, v217
  v_cos_f32 v228, v217
  v_sin_f32 v229, v217
  s_add_u32 m0, s39, 139264
  v_add_u32 v150, 984064, v148
  global_load_lds_dwordx4 v150, s[6:7]
  v_mul_f32 v228, v228, v216
  v_mul_f32 v229, v229, v216
  v_mul_f32 v216, 0x41000000, v225
  v_exp_f32 v216, v216
  v_mul_f32 v217, 0x41000000, v226
  v_fract_f32 v217, v217
  v_cos_f32 v230, v217
  v_sin_f32 v231, v217
  v_mul_f32 v230, v230, v216
  v_mul_f32 v231, v231, v216
  v_mul_f32 v216, 0x43800000, v225
  v_exp_f32 v216, v216
  v_mul_f32 v217, 0x43800000, v226
  v_fract_f32 v217, v217
  s_add_u32 m0, s39, 143360
  v_add_u32 v150, 1082368, v148
  global_load_lds_dwordx4 v150, s[6:7]
  v_cos_f32 v232, v217
  v_sin_f32 v233, v217
  v_mul_f32 v232, v232, v216
  v_mul_f32 v233, v233, v216
  v_mov_b32 v234, 1.0
  v_mov_b32 v235, 0
  v_cvt_pkrtz_f16_f32 v160, v234, -v235
  v_pk_mul_f32 v[236:237], v[234:235], v[230:231] op_sel_hi:[0,1]
  v_pk_fma_f32 v[236:237], v[234:235], v[230:231], v[236:237] op_sel:[1,1,0] op_sel_hi:[1,0,1] neg_lo:[0,1,0]
  v_cvt_pkrtz_f16_f32 v161, v236, -v237
  v_pk_mul_f32 v[234:235], v[236:237], v[230:231] op_sel_hi:[0,1]
  v_pk_fma_f32 v[234:235], v[236:237], v[230:231], v[234:235] op_sel:[1,1,0] op_sel_hi:[1,0,1] neg_lo:[0,1,0]
  v_cvt_pkrtz_f16_f32 v162, v234, -v235
  v_pk_mul_f32 v[236:237], v[234:235], v[230:231] op_sel_hi:[0,1]
  s_add_u32 m0, s39, 147456
  v_add_u32 v150, 1180672, v148
  global_load_lds_dwordx4 v150, s[6:7]
  v_pk_fma_f32 v[236:237], v[234:235], v[230:231], v[236:237] op_sel:[1,1,0] op_sel_hi:[1,0,1] neg_lo:[0,1,0]
  v_cvt_pkrtz_f16_f32 v163, v236, -v237
  v_pk_mul_f32 v[234:235], v[236:237], v[230:231] op_sel_hi:[0,1]
  v_pk_fma_f32 v[234:235], v[236:237], v[230:231], v[234:235] op_sel:[1,1,0] op_sel_hi:[1,0,1] neg_lo:[0,1,0]
  v_cvt_pkrtz_f16_f32 v164, v234, -v235
  v_pk_mul_f32 v[236:237], v[234:235], v[230:231] op_sel_hi:[0,1]
  v_pk_fma_f32 v[236:237], v[234:235], v[230:231], v[236:237] op_sel:[1,1,0] op_sel_hi:[1,0,1] neg_lo:[0,1,0]
  v_cvt_pkrtz_f16_f32 v165, v236, -v237
  v_pk_mul_f32 v[234:235], v[236:237], v[230:231] op_sel_hi:[0,1]
  v_pk_fma_f32 v[234:235], v[236:237], v[230:231], v[234:235] op_sel:[1,1,0] op_sel_hi:[1,0,1] neg_lo:[0,1,0]
  v_cvt_pkrtz_f16_f32 v166, v234, -v235
  v_pk_mul_f32 v[236:237], v[234:235], v[230:231] op_sel_hi:[0,1]
  v_pk_fma_f32 v[236:237], v[234:235], v[230:231], v[236:237] op_sel:[1,1,0] op_sel_hi:[1,0,1] neg_lo:[0,1,0]
  v_cvt_pkrtz_f16_f32 v167, v236, -v237
  s_add_u32 m0, s39, 151552
  v_add_u32 v150, 1278976, v148
  global_load_lds_dwordx4 v150, s[6:7]
  v_pk_mul_f32 v[234:235], v[236:237], v[230:231] op_sel_hi:[0,1]
  v_pk_fma_f32 v[234:235], v[236:237], v[230:231], v[234:235] op_sel:[1,1,0] op_sel_hi:[1,0,1] neg_lo:[0,1,0]
  v_cvt_pkrtz_f16_f32 v168, v234, -v235
  v_pk_mul_f32 v[236:237], v[234:235], v[230:231] op_sel_hi:[0,1]
  v_pk_fma_f32 v[236:237], v[234:235], v[230:231], v[236:237] op_sel:[1,1,0] op_sel_hi:[1,0,1] neg_lo:[0,1,0]
  v_cvt_pkrtz_f16_f32 v169, v236, -v237
  v_pk_mul_f32 v[234:235], v[236:237], v[230:231] op_sel_hi:[0,1]
  v_pk_fma_f32 v[234:235], v[236:237], v[230:231], v[234:235] op_sel:[1,1,0] op_sel_hi:[1,0,1] neg_lo:[0,1,0]
  v_cvt_pkrtz_f16_f32 v170, v234, -v235
  v_pk_mul_f32 v[236:237], v[234:235], v[230:231] op_sel_hi:[0,1]
  v_pk_fma_f32 v[236:237], v[234:235], v[230:231], v[236:237] op_sel:[1,1,0] op_sel_hi:[1,0,1] neg_lo:[0,1,0]
  v_cvt_pkrtz_f16_f32 v171, v236, -v237
  v_pk_mul_f32 v[234:235], v[236:237], v[230:231] op_sel_hi:[0,1]
  v_pk_fma_f32 v[234:235], v[236:237], v[230:231], v[234:235] op_sel:[1,1,0] op_sel_hi:[1,0,1] neg_lo:[0,1,0]
  s_add_u32 m0, s39, 155648
  v_add_u32 v150, 1377280, v148
  global_load_lds_dwordx4 v150, s[6:7]
  v_cvt_pkrtz_f16_f32 v172, v234, -v235
  v_pk_mul_f32 v[236:237], v[234:235], v[230:231] op_sel_hi:[0,1]
  v_pk_fma_f32 v[236:237], v[234:235], v[230:231], v[236:237] op_sel:[1,1,0] op_sel_hi:[1,0,1] neg_lo:[0,1,0]
  v_cvt_pkrtz_f16_f32 v173, v236, -v237
  v_pk_mul_f32 v[234:235], v[236:237], v[230:231] op_sel_hi:[0,1]
  v_pk_fma_f32 v[234:235], v[236:237], v[230:231], v[234:235] op_sel:[1,1,0] op_sel_hi:[1,0,1] neg_lo:[0,1,0]
  v_cvt_pkrtz_f16_f32 v174, v234, -v235
  v_pk_mul_f32 v[236:237], v[234:235], v[230:231] op_sel_hi:[0,1]
  v_pk_fma_f32 v[236:237], v[234:235], v[230:231], v[236:237] op_sel:[1,1,0] op_sel_hi:[1,0,1] neg_lo:[0,1,0]
  v_cvt_pkrtz_f16_f32 v175, v236, -v237
  v_pk_mul_f32 v[234:235], v[236:237], v[230:231] op_sel_hi:[0,1]
  v_pk_fma_f32 v[234:235], v[236:237], v[230:231], v[234:235] op_sel:[1,1,0] op_sel_hi:[1,0,1] neg_lo:[0,1,0]
  v_cvt_pkrtz_f16_f32 v176, v234, -v235
  v_pk_mul_f32 v[236:237], v[234:235], v[230:231] op_sel_hi:[0,1]
  s_add_u32 m0, s39, 159744
  v_add_u32 v150, 1475584, v148
  global_load_lds_dwordx4 v150, s[6:7]
  v_pk_fma_f32 v[236:237], v[234:235], v[230:231], v[236:237] op_sel:[1,1,0] op_sel_hi:[1,0,1] neg_lo:[0,1,0]
  v_cvt_pkrtz_f16_f32 v177, v236, -v237
  v_pk_mul_f32 v[234:235], v[236:237], v[230:231] op_sel_hi:[0,1]
  v_pk_fma_f32 v[234:235], v[236:237], v[230:231], v[234:235] op_sel:[1,1,0] op_sel_hi:[1,0,1] neg_lo:[0,1,0]
  v_cvt_pkrtz_f16_f32 v178, v234, -v235
  v_pk_mul_f32 v[236:237], v[234:235], v[230:231] op_sel_hi:[0,1]
  v_pk_fma_f32 v[236:237], v[234:235], v[230:231], v[236:237] op_sel:[1,1,0] op_sel_hi:[1,0,1] neg_lo:[0,1,0]
  v_cvt_pkrtz_f16_f32 v179, v236, -v237
  v_pk_mul_f32 v[234:235], v[236:237], v[230:231] op_sel_hi:[0,1]
  v_pk_fma_f32 v[234:235], v[236:237], v[230:231], v[234:235] op_sel:[1,1,0] op_sel_hi:[1,0,1] neg_lo:[0,1,0]
  v_cvt_pkrtz_f16_f32 v180, v234, -v235
  v_pk_mul_f32 v[236:237], v[234:235], v[230:231] op_sel_hi:[0,1]
  v_pk_fma_f32 v[236:237], v[234:235], v[230:231], v[236:237] op_sel:[1,1,0] op_sel_hi:[1,0,1] neg_lo:[0,1,0]
  v_cvt_pkrtz_f16_f32 v181, v236, -v237
  s_add_u32 m0, s39, 32768
  v_add_u32 v153, 512, v152
  global_load_lds_dwordx4 v153, s[4:5]
  v_pk_mul_f32 v[234:235], v[236:237], v[230:231] op_sel_hi:[0,1]
  v_pk_fma_f32 v[234:235], v[236:237], v[230:231], v[234:235] op_sel:[1,1,0] op_sel_hi:[1,0,1] neg_lo:[0,1,0]
  v_cvt_pkrtz_f16_f32 v182, v234, -v235
  v_pk_mul_f32 v[236:237], v[234:235], v[230:231] op_sel_hi:[0,1]
  v_pk_fma_f32 v[236:237], v[234:235], v[230:231], v[236:237] op_sel:[1,1,0] op_sel_hi:[1,0,1] neg_lo:[0,1,0]
  v_cvt_pkrtz_f16_f32 v183, v236, -v237
  v_pk_mul_f32 v[234:235], v[236:237], v[230:231] op_sel_hi:[0,1]
  v_pk_fma_f32 v[234:235], v[236:237], v[230:231], v[234:235] op_sel:[1,1,0] op_sel_hi:[1,0,1] neg_lo:[0,1,0]
  v_cvt_pkrtz_f16_f32 v184, v234, -v235
  v_pk_mul_f32 v[236:237], v[234:235], v[230:231] op_sel_hi:[0,1]
  v_pk_fma_f32 v[236:237], v[234:235], v[230:231], v[236:237] op_sel:[1,1,0] op_sel_hi:[1,0,1] neg_lo:[0,1,0]
  v_cvt_pkrtz_f16_f32 v185, v236, -v237
  v_pk_mul_f32 v[234:235], v[236:237], v[230:231] op_sel_hi:[0,1]
  v_pk_fma_f32 v[234:235], v[236:237], v[230:231], v[234:235] op_sel:[1,1,0] op_sel_hi:[1,0,1] neg_lo:[0,1,0]
  s_add_u32 m0, s39, 36864
  v_add_u32 v153, 33280, v152
  global_load_lds_dwordx4 v153, s[4:5]
  v_cvt_pkrtz_f16_f32 v186, v234, -v235
  v_pk_mul_f32 v[236:237], v[234:235], v[230:231] op_sel_hi:[0,1]
  v_pk_fma_f32 v[236:237], v[234:235], v[230:231], v[236:237] op_sel:[1,1,0] op_sel_hi:[1,0,1] neg_lo:[0,1,0]
  v_cvt_pkrtz_f16_f32 v187, v236, -v237
  v_pk_mul_f32 v[234:235], v[236:237], v[230:231] op_sel_hi:[0,1]
  v_pk_fma_f32 v[234:235], v[236:237], v[230:231], v[234:235] op_sel:[1,1,0] op_sel_hi:[1,0,1] neg_lo:[0,1,0]
  v_cvt_pkrtz_f16_f32 v188, v234, -v235
  v_pk_mul_f32 v[236:237], v[234:235], v[230:231] op_sel_hi:[0,1]
  v_pk_fma_f32 v[236:237], v[234:235], v[230:231], v[236:237] op_sel:[1,1,0] op_sel_hi:[1,0,1] neg_lo:[0,1,0]
  v_cvt_pkrtz_f16_f32 v189, v236, -v237
  v_pk_mul_f32 v[234:235], v[236:237], v[230:231] op_sel_hi:[0,1]
  v_pk_fma_f32 v[234:235], v[236:237], v[230:231], v[234:235] op_sel:[1,1,0] op_sel_hi:[1,0,1] neg_lo:[0,1,0]
  v_cvt_pkrtz_f16_f32 v190, v234, -v235
  v_pk_mul_f32 v[236:237], v[234:235], v[230:231] op_sel_hi:[0,1]
  s_add_u32 m0, s39, 40960
  v_add_u32 v153, 640, v152
  global_load_lds_dwordx4 v153, s[4:5]
  v_pk_fma_f32 v[236:237], v[234:235], v[230:231], v[236:237] op_sel:[1,1,0] op_sel_hi:[1,0,1] neg_lo:[0,1,0]
  v_cvt_pkrtz_f16_f32 v191, v236, -v237
  v_pk_mul_f32 v[238:239], v[228:229], v[228:229] op_sel_hi:[0,1]
  v_pk_fma_f32 v[238:239], v[228:229], v[228:229], v[238:239] op_sel:[1,1,0] op_sel_hi:[1,0,1] neg_lo:[0,1,0]
  v_pk_mul_f32 v[240:241], v[238:239], v[238:239] op_sel_hi:[0,1]
  v_pk_fma_f32 v[240:241], v[238:239], v[238:239], v[240:241] op_sel:[1,1,0] op_sel_hi:[1,0,1] neg_lo:[0,1,0]
  v_pk_mul_f32 v[242:243], v[240:241], v[238:239] op_sel_hi:[0,1]
  v_pk_fma_f32 v[242:243], v[240:241], v[238:239], v[242:243] op_sel:[1,1,0] op_sel_hi:[1,0,1] neg_lo:[0,1,0]
  v_cvt_pkrtz_f16_f32 v192, v220, v221
  v_pk_mul_f32 v[234:235], v[220:221], v[228:229] op_sel_hi:[0,1]
  v_pk_fma_f32 v[234:235], v[220:221], v[228:229], v[234:235] op_sel:[1,1,0] op_sel_hi:[1,0,1] neg_lo:[0,1,0]
  v_cvt_pkrtz_f16_f32 v193, v234, v235
  v_pk_mul_f32 v[236:237], v[234:235], v[228:229] op_sel_hi:[0,1]
  v_pk_fma_f32 v[236:237], v[234:235], v[228:229], v[236:237] op_sel:[1,1,0] op_sel_hi:[1,0,1] neg_lo:[0,1,0]
  s_add_u32 m0, s39, 45056
  v_add_u32 v153, 33408, v152
  global_load_lds_dwordx4 v153, s[4:5]
  v_cvt_pkrtz_f16_f32 v194, v236, v237
  v_pk_mul_f32 v[234:235], v[236:237], v[228:229] op_sel_hi:[0,1]
  v_pk_fma_f32 v[234:235], v[236:237], v[228:229], v[234:235] op_sel:[1,1,0] op_sel_hi:[1,0,1] neg_lo:[0,1,0]
  v_cvt_pkrtz_f16_f32 v195, v234, v235
  v_pk_mul_f32 v[236:237], v[234:235], v[228:229] op_sel_hi:[0,1]
  v_pk_fma_f32 v[236:237], v[234:235], v[228:229], v[236:237] op_sel:[1,1,0] op_sel_hi:[1,0,1] neg_lo:[0,1,0]
  v_cvt_pkrtz_f16_f32 v196, v236, v237
  v_pk_mul_f32 v[234:235], v[236:237], v[228:229] op_sel_hi:[0,1]
  v_pk_fma_f32 v[234:235], v[236:237], v[228:229], v[234:235] op_sel:[1,1,0] op_sel_hi:[1,0,1] neg_lo:[0,1,0]
  v_cvt_pkrtz_f16_f32 v197, v234, v235
  v_pk_mul_f32 v[236:237], v[234:235], v[228:229] op_sel_hi:[0,1]
  v_pk_fma_f32 v[236:237], v[234:235], v[228:229], v[236:237] op_sel:[1,1,0] op_sel_hi:[1,0,1] neg_lo:[0,1,0]
  v_cvt_pkrtz_f16_f32 v198, v236, v237
  v_pk_mul_f32 v[234:235], v[236:237], v[228:229] op_sel_hi:[0,1]
  s_add_u32 m0, s39, 49152
  v_add_u32 v153, 768, v152
  global_load_lds_dwordx4 v153, s[4:5]
  v_pk_fma_f32 v[234:235], v[236:237], v[228:229], v[234:235] op_sel:[1,1,0] op_sel_hi:[1,0,1] neg_lo:[0,1,0]
  v_cvt_pkrtz_f16_f32 v199, v234, v235
  v_pk_mul_f32 v[244:245], v[220:221], v[232:233] op_sel_hi:[0,1]
  v_pk_fma_f32 v[244:245], v[220:221], v[232:233], v[244:245] op_sel:[1,1,0] op_sel_hi:[1,0,1] neg_lo:[0,1,0]
  v_cvt_pkrtz_f16_f32 v200, v244, v245
  v_pk_mul_f32 v[248:249], v[244:245], v[238:239] op_sel_hi:[0,1]
  v_pk_fma_f32 v[248:249], v[244:245], v[238:239], v[248:249] op_sel:[1,1,0] op_sel_hi:[1,0,1] neg_lo:[0,1,0]
  v_cvt_pkrtz_f16_f32 v201, v248, v249
  v_pk_mul_f32 v[248:249], v[244:245], v[240:241] op_sel_hi:[0,1]
  v_pk_fma_f32 v[248:249], v[244:245], v[240:241], v[248:249] op_sel:[1,1,0] op_sel_hi:[1,0,1] neg_lo:[0,1,0]
  v_cvt_pkrtz_f16_f32 v202, v248, v249
  v_pk_mul_f32 v[248:249], v[244:245], v[242:243] op_sel_hi:[0,1]
  v_pk_fma_f32 v[248:249], v[244:245], v[242:243], v[248:249] op_sel:[1,1,0] op_sel_hi:[1,0,1] neg_lo:[0,1,0]
  v_cvt_pkrtz_f16_f32 v203, v248, v249
  s_add_u32 m0, s39, 53248
  v_add_u32 v153, 33536, v152
  global_load_lds_dwordx4 v153, s[4:5]
  v_pk_mul_f32 v[246:247], v[244:245], v[232:233] op_sel_hi:[0,1]
  v_pk_fma_f32 v[246:247], v[244:245], v[232:233], v[246:247] op_sel:[1,1,0] op_sel_hi:[1,0,1] neg_lo:[0,1,0]
  v_cvt_pkrtz_f16_f32 v204, v246, v247
  v_pk_mul_f32 v[248:249], v[246:247], v[240:241] op_sel_hi:[0,1]
  v_pk_fma_f32 v[248:249], v[246:247], v[240:241], v[248:249] op_sel:[1,1,0] op_sel_hi:[1,0,1] neg_lo:[0,1,0]
  v_cvt_pkrtz_f16_f32 v205, v248, v249
  v_pk_mul_f32 v[244:245], v[246:247], v[232:233] op_sel_hi:[0,1]
  v_pk_fma_f32 v[244:245], v[246:247], v[232:233], v[244:245] op_sel:[1,1,0] op_sel_hi:[1,0,1] neg_lo:[0,1,0]
  v_cvt_pkrtz_f16_f32 v206, v244, v245
  v_pk_mul_f32 v[248:249], v[244:245], v[240:241] op_sel_hi:[0,1]
  v_pk_fma_f32 v[248:249], v[244:245], v[240:241], v[248:249] op_sel:[1,1,0] op_sel_hi:[1,0,1] neg_lo:[0,1,0]
  v_cvt_pkrtz_f16_f32 v207, v248, v249
  v_pk_mul_f32 v[246:247], v[244:245], v[232:233] op_sel_hi:[0,1]
  v_pk_fma_f32 v[246:247], v[244:245], v[232:233], v[246:247] op_sel:[1,1,0] op_sel_hi:[1,0,1] neg_lo:[0,1,0]
  s_add_u32 m0, s39, 57344
  v_add_u32 v153, 896, v152
  global_load_lds_dwordx4 v153, s[4:5]
  v_cvt_pkrtz_f16_f32 v208, v246, v247
  v_pk_mul_f32 v[244:245], v[246:247], v[232:233] op_sel_hi:[0,1]
  v_pk_fma_f32 v[244:245], v[246:247], v[232:233], v[244:245] op_sel:[1,1,0] op_sel_hi:[1,0,1] neg_lo:[0,1,0]
  v_cvt_pkrtz_f16_f32 v209, v244, v245
  v_pk_mul_f32 v[246:247], v[244:245], v[232:233] op_sel_hi:[0,1]
  v_pk_fma_f32 v[246:247], v[244:245], v[232:233], v[246:247] op_sel:[1,1,0] op_sel_hi:[1,0,1] neg_lo:[0,1,0]
  v_cvt_pkrtz_f16_f32 v210, v246, v247
  v_pk_mul_f32 v[244:245], v[246:247], v[232:233] op_sel_hi:[0,1]
  v_pk_fma_f32 v[244:245], v[246:247], v[232:233], v[244:245] op_sel:[1,1,0] op_sel_hi:[1,0,1] neg_lo:[0,1,0]
  v_cvt_pkrtz_f16_f32 v211, v244, v245
  v_pk_mul_f32 v[246:247], v[244:245], v[232:233] op_sel_hi:[0,1]
  v_pk_fma_f32 v[246:247], v[244:245], v[232:233], v[246:247] op_sel:[1,1,0] op_sel_hi:[1,0,1] neg_lo:[0,1,0]
  v_cvt_pkrtz_f16_f32 v212, v246, v247
  s_add_u32 m0, s39, 61440
  v_add_u32 v153, 33664, v152
  global_load_lds_dwordx4 v153, s[4:5]
  v_lshrrev_b32 v156, 3, v3
  v_lshlrev_b32 v156, 2, v156
  v_and_b32 v157, 3, v3
  v_add_u32 v156, v156, v157
  v_lshlrev_b32 v156, 1, v156
  v_lshl_add_u32 v156, v2, 7, v156
  s_lshl_b32 s44, s34, 11
  s_lshl_b32 s45, s41, 10
  s_add_u32 s44, s44, s45
  v_add_u32 v156, s44, v156
  global_load_ushort v128, v156, s[8:9] offset:0
  global_load_ushort v129, v156, s[8:9] offset:32
  global_load_ushort v130, v156, s[8:9] offset:64
  global_load_ushort v131, v156, s[8:9] offset:96
  global_load_ushort v132, v156, s[8:9] offset:256
  global_load_ushort v133, v156, s[8:9] offset:288
  global_load_ushort v134, v156, s[8:9] offset:320
  global_load_ushort v135, v156, s[8:9] offset:352
  global_load_ushort v136, v156, s[8:9] offset:512
  global_load_ushort v137, v156, s[8:9] offset:544
  global_load_ushort v138, v156, s[8:9] offset:576
  global_load_ushort v139, v156, s[8:9] offset:608
  global_load_ushort v140, v156, s[8:9] offset:768
  global_load_ushort v141, v156, s[8:9] offset:800
  global_load_ushort v142, v156, s[8:9] offset:832
  global_load_ushort v143, v156, s[8:9] offset:864
  v_mov_b32 v20, 0
  v_mov_b32 v21, 0
  v_mov_b32 v22, 0x3f803f80
  s_waitcnt vmcnt(40)
  s_barrier
  ds_read_b64_tr_b16 a[0:1], v44 offset:0
  ds_read_b64_tr_b16 a[2:3], v44 offset:512
  ds_read_b64_tr_b16 a[4:5], v44 offset:2048
  ds_read_b64_tr_b16 a[6:7], v44 offset:2560
  ds_read_b64_tr_b16 a[8:9], v44 offset:4096
  ds_read_b64_tr_b16 a[10:11], v44 offset:4608
  ds_read_b64_tr_b16 a[12:13], v44 offset:6144
  ds_read_b64_tr_b16 a[14:15], v44 offset:6656
  ds_read_b64_tr_b16 a[16:17], v44 offset:8192
  ds_read_b64_tr_b16 a[18:19], v44 offset:8704
  ds_read_b64_tr_b16 a[20:21], v44 offset:10240
  ds_read_b64_tr_b16 a[22:23], v44 offset:10752
  ds_read_b64_tr_b16 a[24:25], v44 offset:12288
  ds_read_b64_tr_b16 a[26:27], v44 offset:12800
  ds_read_b64_tr_b16 a[28:29], v44 offset:14336
  ds_read_b64_tr_b16 a[30:31], v44 offset:14848
  ds_read_b64_tr_b16 a[32:33], v44 offset:16384
  ds_read_b64_tr_b16 a[34:35], v44 offset:16896
  ds_read_b64_tr_b16 a[36:37], v44 offset:18432
  ds_read_b64_tr_b16 a[38:39], v44 offset:18944
  ds_read_b64_tr_b16 a[40:41], v44 offset:20480
  ds_read_b64_tr_b16 a[42:43], v44 offset:20992
  ds_read_b64_tr_b16 a[44:45], v44 offset:22528
  ds_read_b64_tr_b16 a[46:47], v44 offset:23040
  ds_read_b64_tr_b16 a[48:49], v44 offset:24576
  ds_read_b64_tr_b16 a[50:51], v44 offset:25088
  ds_read_b64_tr_b16 a[52:53], v44 offset:26624
  ds_read_b64_tr_b16 a[54:55], v44 offset:27136
  ds_read_b64_tr_b16 a[56:57], v44 offset:28672
  ds_read_b64_tr_b16 a[58:59], v44 offset:29184
  ds_read_b64_tr_b16 a[60:61], v44 offset:30720
  ds_read_b64_tr_b16 a[62:63], v44 offset:31232
  s_waitcnt vmcnt(38)
  s_waitcnt lgkmcnt(0)
  s_barrier
  ds_read_b128 v[104:107], v24 offset:0
  ds_read_b128 v[80:83], v112 offset:0
  ds_read_b128 v[84:87], v116 offset:0
  ds_read_b128 v[88:91], v113 offset:0
  ds_read_b128 v[92:95], v117 offset:0
  ds_read_b128 v[96:99], v114 offset:0
  ds_read_b128 v[100:103], v118 offset:0
  s_waitcnt vmcnt(36)
  s_barrier
  s_waitcnt lgkmcnt(4)
  v_mfma_f32_32x32x16_bf16 v[48:63], a[0:3], v[80:83], 0
  ds_read_b128 v[108:111], v25 offset:0
  s_add_u32 m0, s39, 65536
  v_add_u32 v150, 788480, v149
  global_load_lds_dwordx4 v150, s[6:7]
  v_mfma_f32_32x32x16_bf16 v[64:79], a[0:3], v[84:87], 0
  ds_read_b128 v[80:83], v115 offset:0
  ds_read_b128 v[84:87], v119 offset:0
  s_add_u32 m0, s39, 69632
  v_add_u32 v150, 886784, v149
  global_load_lds_dwordx4 v150, s[6:7]
  v_mfma_f32_16x16x32_bf16 v[28:31], a[0:3], v[144:147], 0
  s_waitcnt lgkmcnt(5)
  v_mfma_f32_32x32x16_bf16 v[48:63], a[4:7], v[88:91], v[48:63]
  s_add_u32 m0, s39, 73728
  v_add_u32 v150, 985088, v149
  global_load_lds_dwordx4 v150, s[6:7]
  v_mfma_f32_32x32x16_bf16 v[64:79], a[4:7], v[92:95], v[64:79]
  ds_read_b128 v[88:91], v112 offset:8192
  ds_read_b128 v[92:95], v116 offset:8192
  s_add_u32 m0, s39, 77824
  v_add_u32 v150, 1083392, v149
  global_load_lds_dwordx4 v150, s[6:7]
  v_mfma_f32_16x16x32_bf16 v[28:31], a[4:7], v[144:147], v[28:31]
  v_dot2c_f32_bf16 v20, v104, v22
  v_dot2c_f32_bf16 v21, v104, v104
  v_dot2c_f32_bf16 v20, v105, v22
  v_dot2c_f32_bf16 v21, v105, v105
  v_dot2c_f32_bf16 v20, v106, v22
  v_dot2c_f32_bf16 v21, v106, v106
  v_dot2c_f32_bf16 v20, v107, v22
  v_dot2c_f32_bf16 v21, v107, v107
  s_waitcnt lgkmcnt(4)
  v_dot2c_f32_bf16 v20, v108, v22
  v_dot2c_f32_bf16 v21, v108, v108
  v_dot2c_f32_bf16 v20, v109, v22
  v_dot2c_f32_bf16 v21, v109, v109
  v_dot2c_f32_bf16 v20, v110, v22
  v_dot2c_f32_bf16 v21, v110, v110
  v_dot2c_f32_bf16 v20, v111, v22
  v_dot2c_f32_bf16 v21, v111, v111
  v_mfma_f32_32x32x16_bf16 v[48:63], a[8:11], v[96:99], v[48:63]
  ds_read_b128 v[104:107], v24 offset:8192
  s_add_u32 m0, s39, 81920
  v_add_u32 v150, 1181696, v149
  global_load_lds_dwordx4 v150, s[6:7]
  v_mfma_f32_32x32x16_bf16 v[64:79], a[8:11], v[100:103], v[64:79]
  ds_read_b128 v[96:99], v113 offset:8192
  ds_read_b128 v[100:103], v117 offset:8192
  s_add_u32 m0, s39, 86016
  v_add_u32 v150, 1280000, v149
  global_load_lds_dwordx4 v150, s[6:7]
  v_mfma_f32_16x16x32_bf16 v[28:31], a[8:11], v[144:147], v[28:31]
  s_waitcnt lgkmcnt(5)
  v_mfma_f32_32x32x16_bf16 v[48:63], a[12:15], v[80:83], v[48:63]
  s_add_u32 m0, s39, 90112
  v_add_u32 v150, 1378304, v149
  global_load_lds_dwordx4 v150, s[6:7]
  v_mfma_f32_32x32x16_bf16 v[64:79], a[12:15], v[84:87], v[64:79]
  ds_read_b128 v[80:83], v114 offset:8192
  ds_read_b128 v[84:87], v118 offset:8192
  s_add_u32 m0, s39, 94208
  v_add_u32 v150, 1476608, v149
  global_load_lds_dwordx4 v150, s[6:7]
  v_mfma_f32_16x16x32_bf16 v[28:31], a[12:15], v[144:147], v[28:31]
  s_waitcnt lgkmcnt(4)
  v_dot2c_f32_bf16 v20, v104, v22
  v_dot2c_f32_bf16 v21, v104, v104
  v_dot2c_f32_bf16 v20, v105, v22
  v_dot2c_f32_bf16 v21, v105, v105
  v_dot2c_f32_bf16 v20, v106, v22
  v_dot2c_f32_bf16 v21, v106, v106
  v_dot2c_f32_bf16 v20, v107, v22
  v_dot2c_f32_bf16 v21, v107, v107
  s_waitcnt vmcnt(42)
  s_barrier
  v_mfma_f32_32x32x16_bf16 v[48:63], a[16:19], v[88:91], v[48:63]
  ds_read_b128 v[108:111], v25 offset:8192
  s_add_u32 m0, s39, 98304
  v_add_u32 v150, 0, v148
  global_load_lds_dwordx4 v150, s[6:7]
  v_mfma_f32_32x32x16_bf16 v[64:79], a[16:19], v[92:95], v[64:79]
  ds_read_b128 v[88:91], v115 offset:8192
  ds_read_b128 v[92:95], v119 offset:8192
  v_mfma_f32_16x16x32_bf16 v[28:31], a[16:19], v[144:147], v[28:31]
  s_waitcnt lgkmcnt(5)
  v_mfma_f32_32x32x16_bf16 v[48:63], a[20:23], v[96:99], v[48:63]
  s_add_u32 m0, s39, 102400
  v_add_u32 v150, 98304, v148
  global_load_lds_dwordx4 v150, s[6:7]
  v_mfma_f32_32x32x16_bf16 v[64:79], a[20:23], v[100:103], v[64:79]
  ds_read_b128 v[96:99], v112 offset:16384
  ds_read_b128 v[100:103], v116 offset:16384
  v_mfma_f32_16x16x32_bf16 v[28:31], a[20:23], v[144:147], v[28:31]
  s_waitcnt lgkmcnt(4)
  v_dot2c_f32_bf16 v20, v108, v22
  v_dot2c_f32_bf16 v21, v108, v108
  v_dot2c_f32_bf16 v20, v109, v22
  v_dot2c_f32_bf16 v21, v109, v109
  v_dot2c_f32_bf16 v20, v110, v22
  v_dot2c_f32_bf16 v21, v110, v110
  v_dot2c_f32_bf16 v20, v111, v22
  v_dot2c_f32_bf16 v21, v111, v111
  v_mfma_f32_32x32x16_bf16 v[48:63], a[24:27], v[80:83], v[48:63]
  ds_read_b128 v[104:107], v24 offset:16384
  s_add_u32 m0, s39, 106496
  v_add_u32 v150, 196608, v148
  global_load_lds_dwordx4 v150, s[6:7]
  v_mfma_f32_32x32x16_bf16 v[64:79], a[24:27], v[84:87], v[64:79]
  ds_read_b128 v[80:83], v113 offset:16384
  ds_read_b128 v[84:87], v117 offset:16384
  v_mfma_f32_16x16x32_bf16 v[28:31], a[24:27], v[144:147], v[28:31]
  s_waitcnt lgkmcnt(5)
  v_mfma_f32_32x32x16_bf16 v[48:63], a[28:31], v[88:91], v[48:63]
  s_add_u32 m0, s39, 110592
  v_add_u32 v150, 294912, v148
  global_load_lds_dwordx4 v150, s[6:7]
  v_mfma_f32_32x32x16_bf16 v[64:79], a[28:31], v[92:95], v[64:79]
  ds_read_b128 v[88:91], v114 offset:16384
  ds_read_b128 v[92:95], v118 offset:16384
  v_mfma_f32_16x16x32_bf16 v[28:31], a[28:31], v[144:147], v[28:31]
  s_waitcnt lgkmcnt(4)
  v_dot2c_f32_bf16 v20, v104, v22
  v_dot2c_f32_bf16 v21, v104, v104
  v_dot2c_f32_bf16 v20, v105, v22
  v_dot2c_f32_bf16 v21, v105, v105
  v_dot2c_f32_bf16 v20, v106, v22
  v_dot2c_f32_bf16 v21, v106, v106
  v_dot2c_f32_bf16 v20, v107, v22
  v_dot2c_f32_bf16 v21, v107, v107
  s_waitcnt vmcnt(44)
  s_barrier
  v_mfma_f32_32x32x16_bf16 v[48:63], a[32:35], v[96:99], v[48:63]
  ds_read_b128 v[108:111], v25 offset:16384
  s_add_u32 m0, s39, 114688
  v_add_u32 v150, 393216, v148
  global_load_lds_dwordx4 v150, s[6:7]
  v_mfma_f32_32x32x16_bf16 v[64:79], a[32:35], v[100:103], v[64:79]
  ds_read_b128 v[96:99], v115 offset:16384
  ds_read_b128 v[100:103], v119 offset:16384
  v_mfma_f32_16x16x32_bf16 v[28:31], a[32:35], v[144:147], v[28:31]
  s_waitcnt lgkmcnt(5)
  v_mfma_f32_32x32x16_bf16 v[48:63], a[36:39], v[80:83], v[48:63]
  s_add_u32 m0, s39, 118784
  v_add_u32 v150, 491520, v148
  global_load_lds_dwordx4 v150, s[6:7]
  v_mfma_f32_32x32x16_bf16 v[64:79], a[36:39], v[84:87], v[64:79]
  ds_read_b128 v[80:83], v112 offset:24576
  ds_read_b128 v[84:87], v116 offset:24576
  v_mfma_f32_16x16x32_bf16 v[28:31], a[36:39], v[144:147], v[28:31]
  s_waitcnt lgkmcnt(4)
  v_dot2c_f32_bf16 v20, v108, v22
  v_dot2c_f32_bf16 v21, v108, v108
  v_dot2c_f32_bf16 v20, v109, v22
  v_dot2c_f32_bf16 v21, v109, v109
  v_dot2c_f32_bf16 v20, v110, v22
  v_dot2c_f32_bf16 v21, v110, v110
  v_dot2c_f32_bf16 v20, v111, v22
  v_dot2c_f32_bf16 v21, v111, v111
  v_mfma_f32_32x32x16_bf16 v[48:63], a[40:43], v[88:91], v[48:63]
  ds_read_b128 v[104:107], v24 offset:24576
  s_add_u32 m0, s39, 122880
  v_add_u32 v150, 589824, v148
  global_load_lds_dwordx4 v150, s[6:7]
  v_mfma_f32_32x32x16_bf16 v[64:79], a[40:43], v[92:95], v[64:79]
  ds_read_b128 v[88:91], v113 offset:24576
  ds_read_b128 v[92:95], v117 offset:24576
  v_mfma_f32_16x16x32_bf16 v[28:31], a[40:43], v[144:147], v[28:31]
  s_waitcnt lgkmcnt(5)
  v_mfma_f32_32x32x16_bf16 v[48:63], a[44:47], v[96:99], v[48:63]
  s_add_u32 m0, s39, 126976
  v_add_u32 v150, 688128, v148
  global_load_lds_dwordx4 v150, s[6:7]
  v_mfma_f32_32x32x16_bf16 v[64:79], a[44:47], v[100:103], v[64:79]
  ds_read_b128 v[96:99], v114 offset:24576
  ds_read_b128 v[100:103], v118 offset:24576
  v_mfma_f32_16x16x32_bf16 v[28:31], a[44:47], v[144:147], v[28:31]
  s_waitcnt lgkmcnt(4)
  v_dot2c_f32_bf16 v20, v104, v22
  v_dot2c_f32_bf16 v21, v104, v104
  v_dot2c_f32_bf16 v20, v105, v22
  v_dot2c_f32_bf16 v21, v105, v105
  v_dot2c_f32_bf16 v20, v106, v22
  v_dot2c_f32_bf16 v21, v106, v106
  v_dot2c_f32_bf16 v20, v107, v22
  v_dot2c_f32_bf16 v21, v107, v107
  v_mfma_f32_32x32x16_bf16 v[48:63], a[48:51], v[80:83], v[48:63]
  ds_read_b128 v[108:111], v25 offset:24576
  v_mfma_f32_32x32x16_bf16 v[64:79], a[48:51], v[84:87], v[64:79]
  ds_read_b128 v[80:83], v115 offset:24576
  ds_read_b128 v[84:87], v119 offset:24576
  v_mfma_f32_16x16x32_bf16 v[28:31], a[48:51], v[144:147], v[28:31]
  s_waitcnt lgkmcnt(5)
  v_mfma_f32_32x32x16_bf16 v[48:63], a[52:55], v[88:91], v[48:63]
  v_mfma_f32_32x32x16_bf16 v[64:79], a[52:55], v[92:95], v[64:79]
  v_mfma_f32_16x16x32_bf16 v[28:31], a[52:55], v[144:147], v[28:31]
  s_waitcnt lgkmcnt(2)
  v_dot2c_f32_bf16 v20, v108, v22
  v_dot2c_f32_bf16 v21, v108, v108
  v_dot2c_f32_bf16 v20, v109, v22
  v_dot2c_f32_bf16 v21, v109, v109
  v_dot2c_f32_bf16 v20, v110, v22
  v_dot2c_f32_bf16 v21, v110, v110
  v_dot2c_f32_bf16 v20, v111, v22
  v_dot2c_f32_bf16 v21, v111, v111
  v_mfma_f32_32x32x16_bf16 v[48:63], a[56:59], v[96:99], v[48:63]
  v_mfma_f32_32x32x16_bf16 v[64:79], a[56:59], v[100:103], v[64:79]
  v_mfma_f32_16x16x32_bf16 v[28:31], a[56:59], v[144:147], v[28:31]
  s_waitcnt lgkmcnt(0)
  v_mfma_f32_32x32x16_bf16 v[48:63], a[60:63], v[80:83], v[48:63]
  v_mfma_f32_32x32x16_bf16 v[64:79], a[60:63], v[84:87], v[64:79]
  v_mfma_f32_16x16x32_bf16 v[28:31], a[60:63], v[144:147], v[28:31]
  s_waitcnt vmcnt(16)
  v_lshl_or_b32 v4, v129, 16, v128
  v_lshl_or_b32 v5, v131, 16, v130
  v_lshl_or_b32 v6, v133, 16, v132
  v_lshl_or_b32 v7, v135, 16, v134
  v_lshl_or_b32 v8, v137, 16, v136
  v_lshl_or_b32 v9, v139, 16, v138
  v_lshl_or_b32 v10, v141, 16, v140
  v_lshl_or_b32 v11, v143, 16, v142
  v_bfe_u32 v156, v3, 2, 1
  v_mul_u32_u24 v156, 0x8000, v156
  v_lshl_or_b32 v156, v156, 16, v156
  v_xor_b32 v4, v4, v156
  v_xor_b32 v5, v5, v156
  v_xor_b32 v6, v6, v156
  v_xor_b32 v7, v7, v156
  v_xor_b32 v8, v8, v156
  v_xor_b32 v9, v9, v156
  v_xor_b32 v10, v10, v156
  v_xor_b32 v11, v11, v156
  s_waitcnt vmcnt(8)
  s_waitcnt lgkmcnt(0)
  s_barrier
  ds_read_b64_tr_b16 a[64:65], v45 offset:0
  ds_read_b64_tr_b16 a[66:67], v45 offset:512
  ds_read_b64_tr_b16 a[68:69], v45 offset:2048
  ds_read_b64_tr_b16 a[70:71], v45 offset:2560
  ds_read_b64_tr_b16 a[72:73], v45 offset:4096
  ds_read_b64_tr_b16 a[74:75], v45 offset:4608
  ds_read_b64_tr_b16 a[76:77], v45 offset:6144
  ds_read_b64_tr_b16 a[78:79], v45 offset:6656
  ds_read_b64_tr_b16 a[80:81], v45 offset:8192
  ds_read_b64_tr_b16 a[82:83], v45 offset:8704
  ds_read_b64_tr_b16 a[84:85], v45 offset:10240
  ds_read_b64_tr_b16 a[86:87], v45 offset:10752
  ds_read_b64_tr_b16 a[88:89], v45 offset:12288
  ds_read_b64_tr_b16 a[90:91], v45 offset:12800
  ds_read_b64_tr_b16 a[92:93], v45 offset:14336
  ds_read_b64_tr_b16 a[94:95], v45 offset:14848
  ds_read_b64_tr_b16 a[96:97], v45 offset:16384
  ds_read_b64_tr_b16 a[98:99], v45 offset:16896
  ds_read_b64_tr_b16 a[100:101], v45 offset:18432
  ds_read_b64_tr_b16 a[102:103], v45 offset:18944
  ds_read_b64_tr_b16 a[104:105], v45 offset:20480
  ds_read_b64_tr_b16 a[106:107], v45 offset:20992
  ds_read_b64_tr_b16 a[108:109], v45 offset:22528
  ds_read_b64_tr_b16 a[110:111], v45 offset:23040
  ds_read_b64_tr_b16 a[112:113], v45 offset:24576
  ds_read_b64_tr_b16 a[114:115], v45 offset:25088
  ds_read_b64_tr_b16 a[116:117], v45 offset:26624
  ds_read_b64_tr_b16 a[118:119], v45 offset:27136
  ds_read_b64_tr_b16 a[120:121], v45 offset:28672
  ds_read_b64_tr_b16 a[122:123], v45 offset:29184
  ds_read_b64_tr_b16 a[124:125], v45 offset:30720
  ds_read_b64_tr_b16 a[126:127], v45 offset:31232
  ds_read_b128 v[104:107], v24 offset:32768
  ds_read_b128 v[88:91], v112 offset:32768
  ds_read_b128 v[92:95], v116 offset:32768
  ds_read_b128 v[96:99], v113 offset:32768
  ds_read_b128 v[100:103], v117 offset:32768
  ds_read_b128 v[80:83], v114 offset:32768
  ds_read_b128 v[84:87], v118 offset:32768
  s_waitcnt lgkmcnt(0)
  s_waitcnt vmcnt(0)
  s_barrier
  v_mfma_f32_16x16x32_bf16 v[28:31], a[64:67], v[144:147], v[28:31]
  s_add_u32 m0, s39, 131072
  v_add_u32 v150, 786432, v148
  global_load_lds_dwordx4 v150, s[6:7]
  v_mfma_f32_16x16x32_bf16 v[28:31], a[68:71], v[144:147], v[28:31]
  v_mfma_f32_16x16x32_bf16 v[28:31], a[72:75], v[144:147], v[28:31]
  s_add_u32 m0, s39, 135168
  v_add_u32 v150, 884736, v148
  global_load_lds_dwordx4 v150, s[6:7]
  v_mfma_f32_16x16x32_bf16 v[28:31], a[76:79], v[144:147], v[28:31]
  v_mfma_f32_16x16x32_bf16 v[28:31], a[80:83], v[144:147], v[28:31]
  s_add_u32 m0, s39, 139264
  v_add_u32 v150, 983040, v148
  global_load_lds_dwordx4 v150, s[6:7]
  v_mfma_f32_16x16x32_bf16 v[28:31], a[84:87], v[144:147], v[28:31]
  v_mfma_f32_16x16x32_bf16 v[28:31], a[88:91], v[144:147], v[28:31]
  s_add_u32 m0, s39, 143360
  v_add_u32 v150, 1081344, v148
  global_load_lds_dwordx4 v150, s[6:7]
  v_mfma_f32_16x16x32_bf16 v[28:31], a[92:95], v[144:147], v[28:31]
  v_mfma_f32_16x16x32_bf16 v[28:31], a[96:99], v[144:147], v[28:31]
  s_add_u32 m0, s39, 147456
  v_add_u32 v150, 1179648, v148
  global_load_lds_dwordx4 v150, s[6:7]
  v_mfma_f32_16x16x32_bf16 v[28:31], a[100:103], v[144:147], v[28:31]
  v_mfma_f32_16x16x32_bf16 v[28:31], a[104:107], v[144:147], v[28:31]
  s_add_u32 m0, s39, 151552
  v_add_u32 v150, 1277952, v148
  global_load_lds_dwordx4 v150, s[6:7]
  v_mfma_f32_16x16x32_bf16 v[28:31], a[108:111], v[144:147], v[28:31]
  v_mfma_f32_16x16x32_bf16 v[28:31], a[112:115], v[144:147], v[28:31]
  s_add_u32 m0, s39, 155648
  v_add_u32 v150, 1376256, v148
  global_load_lds_dwordx4 v150, s[6:7]
  v_mfma_f32_16x16x32_bf16 v[28:31], a[116:119], v[144:147], v[28:31]
  v_mfma_f32_16x16x32_bf16 v[28:31], a[120:123], v[144:147], v[28:31]
  s_add_u32 m0, s39, 159744
  v_add_u32 v150, 1474560, v148
  global_load_lds_dwordx4 v150, s[6:7]
  v_mfma_f32_16x16x32_bf16 v[28:31], a[124:127], v[144:147], v[28:31]
  v_mfma_f32_32x32x16_bf16 v[48:63], a[64:67], v[88:91], v[48:63]
  ds_read_b128 v[108:111], v25 offset:32768
  ds_read_b64_tr_b16 a[128:129], v47 offset:0
  ds_read_b64_tr_b16 a[130:131], v47 offset:512
  v_mfma_f32_32x32x16_bf16 v[64:79], a[64:67], v[92:95], v[64:79]
  ds_read_b128 v[88:91], v115 offset:32768
  ds_read_b128 v[92:95], v119 offset:32768
  ds_read_b64_tr_b16 a[132:133], v47 offset:2048
  ds_read_b64_tr_b16 a[134:135], v47 offset:2560
  v_mfma_f32_32x32x16_bf16 v[48:63], a[68:71], v[96:99], v[48:63]
  ds_read_b64_tr_b16 a[136:137], v47 offset:4096
  ds_read_b64_tr_b16 a[138:139], v47 offset:4608
  v_mfma_f32_32x32x16_bf16 v[64:79], a[68:71], v[100:103], v[64:79]
  ds_read_b128 v[96:99], v112 offset:40960
  ds_read_b128 v[100:103], v116 offset:40960
  ds_read_b64_tr_b16 a[140:141], v47 offset:6144
  ds_read_b64_tr_b16 a[142:143], v47 offset:6656
  v_dot2c_f32_bf16 v20, v104, v22
  v_dot2c_f32_bf16 v21, v104, v104
  v_dot2c_f32_bf16 v20, v105, v22
  v_dot2c_f32_bf16 v21, v105, v105
  v_dot2c_f32_bf16 v20, v106, v22
  v_dot2c_f32_bf16 v21, v106, v106
  v_dot2c_f32_bf16 v20, v107, v22
  v_dot2c_f32_bf16 v21, v107, v107
  s_waitcnt lgkmcnt(12)
  v_dot2c_f32_bf16 v20, v108, v22
  v_dot2c_f32_bf16 v21, v108, v108
  v_dot2c_f32_bf16 v20, v109, v22
  v_dot2c_f32_bf16 v21, v109, v109
  v_dot2c_f32_bf16 v20, v110, v22
  v_dot2c_f32_bf16 v21, v110, v110
  v_dot2c_f32_bf16 v20, v111, v22
  v_dot2c_f32_bf16 v21, v111, v111
  v_mfma_f32_32x32x16_bf16 v[48:63], a[72:75], v[80:83], v[48:63]
  ds_read_b128 v[104:107], v24 offset:40960
  ds_read_b64_tr_b16 a[144:145], v47 offset:8192
  ds_read_b64_tr_b16 a[146:147], v47 offset:8704
  v_mfma_f32_32x32x16_bf16 v[64:79], a[72:75], v[84:87], v[64:79]
  ds_read_b128 v[80:83], v113 offset:40960
  ds_read_b128 v[84:87], v117 offset:40960
  ds_read_b64_tr_b16 a[148:149], v47 offset:10240
  ds_read_b64_tr_b16 a[150:151], v47 offset:10752
  s_waitcnt lgkmcnt(15)
  v_mfma_f32_32x32x16_bf16 v[48:63], a[76:79], v[88:91], v[48:63]
  ds_read_b64_tr_b16 a[152:153], v47 offset:12288
  ds_read_b64_tr_b16 a[154:155], v47 offset:12800
  v_mfma_f32_32x32x16_bf16 v[64:79], a[76:79], v[92:95], v[64:79]
  ds_read_b128 v[88:91], v114 offset:40960
  ds_read_b128 v[92:95], v118 offset:40960
  ds_read_b64_tr_b16 a[156:157], v47 offset:14336
  ds_read_b64_tr_b16 a[158:159], v47 offset:14848
  s_waitcnt lgkmcnt(12)
  v_dot2c_f32_bf16 v20, v104, v22
  v_dot2c_f32_bf16 v21, v104, v104
  v_dot2c_f32_bf16 v20, v105, v22
  v_dot2c_f32_bf16 v21, v105, v105
  v_dot2c_f32_bf16 v20, v106, v22
  v_dot2c_f32_bf16 v21, v106, v106
  v_dot2c_f32_bf16 v20, v107, v22
  v_dot2c_f32_bf16 v21, v107, v107
  v_mfma_f32_32x32x16_bf16 v[48:63], a[80:83], v[96:99], v[48:63]
  ds_read_b128 v[108:111], v25 offset:40960
  ds_read_b64_tr_b16 a[160:161], v47 offset:16384
  ds_read_b64_tr_b16 a[162:163], v47 offset:16896
  v_mfma_f32_32x32x16_bf16 v[64:79], a[80:83], v[100:103], v[64:79]
  ds_read_b128 v[96:99], v115 offset:40960
  ds_read_b128 v[100:103], v119 offset:40960
  ds_read_b64_tr_b16 a[164:165], v47 offset:18432
  ds_read_b64_tr_b16 a[166:167], v47 offset:18944
  s_waitcnt lgkmcnt(15)
  v_mfma_f32_32x32x16_bf16 v[48:63], a[84:87], v[80:83], v[48:63]
  ds_read_b64_tr_b16 a[168:169], v47 offset:20480
  ds_read_b64_tr_b16 a[170:171], v47 offset:20992
  v_mfma_f32_32x32x16_bf16 v[64:79], a[84:87], v[84:87], v[64:79]
  ds_read_b128 v[80:83], v112 offset:49152
  ds_read_b128 v[84:87], v116 offset:49152
  ds_read_b64_tr_b16 a[172:173], v47 offset:22528
  ds_read_b64_tr_b16 a[174:175], v47 offset:23040
  s_waitcnt lgkmcnt(12)
  v_dot2c_f32_bf16 v20, v108, v22
  v_dot2c_f32_bf16 v21, v108, v108
  v_dot2c_f32_bf16 v20, v109, v22
  v_dot2c_f32_bf16 v21, v109, v109
  v_dot2c_f32_bf16 v20, v110, v22
  v_dot2c_f32_bf16 v21, v110, v110
  v_dot2c_f32_bf16 v20, v111, v22
  v_dot2c_f32_bf16 v21, v111, v111
  v_mfma_f32_32x32x16_bf16 v[48:63], a[88:91], v[88:91], v[48:63]
  ds_read_b128 v[104:107], v24 offset:49152
  ds_read_b64_tr_b16 a[176:177], v47 offset:24576
  ds_read_b64_tr_b16 a[178:179], v47 offset:25088
  v_mfma_f32_32x32x16_bf16 v[64:79], a[88:91], v[92:95], v[64:79]
  ds_read_b128 v[88:91], v113 offset:49152
  ds_read_b128 v[92:95], v117 offset:49152
  ds_read_b64_tr_b16 a[180:181], v47 offset:26624
  ds_read_b64_tr_b16 a[182:183], v47 offset:27136
  s_waitcnt lgkmcnt(15)
  v_mfma_f32_32x32x16_bf16 v[48:63], a[92:95], v[96:99], v[48:63]
  ds_read_b64_tr_b16 a[184:185], v47 offset:28672
  ds_read_b64_tr_b16 a[186:187], v47 offset:29184
  v_mfma_f32_32x32x16_bf16 v[64:79], a[92:95], v[100:103], v[64:79]
  ds_read_b128 v[96:99], v114 offset:49152
  ds_read_b128 v[100:103], v118 offset:49152
  ds_read_b64_tr_b16 a[188:189], v47 offset:30720
  ds_read_b64_tr_b16 a[190:191], v47 offset:31232
  s_waitcnt lgkmcnt(12)
  v_dot2c_f32_bf16 v20, v104, v22
  v_dot2c_f32_bf16 v21, v104, v104
  v_dot2c_f32_bf16 v20, v105, v22
  v_dot2c_f32_bf16 v21, v105, v105
  v_dot2c_f32_bf16 v20, v106, v22
  v_dot2c_f32_bf16 v21, v106, v106
  v_dot2c_f32_bf16 v20, v107, v22
  v_dot2c_f32_bf16 v21, v107, v107
  v_mfma_f32_32x32x16_bf16 v[48:63], a[96:99], v[80:83], v[48:63]
  ds_read_b128 v[108:111], v25 offset:49152
  v_mfma_f32_32x32x16_bf16 v[64:79], a[96:99], v[84:87], v[64:79]
  ds_read_b128 v[80:83], v115 offset:49152
  ds_read_b128 v[84:87], v119 offset:49152
  s_waitcnt lgkmcnt(11)
  v_mfma_f32_32x32x16_bf16 v[48:63], a[100:103], v[88:91], v[48:63]
  v_mfma_f32_32x32x16_bf16 v[64:79], a[100:103], v[92:95], v[64:79]
  ds_read_b128 v[88:91], v112 offset:57344
  ds_read_b128 v[92:95], v116 offset:57344
  s_waitcnt lgkmcnt(4)
  v_dot2c_f32_bf16 v20, v108, v22
  v_dot2c_f32_bf16 v21, v108, v108
  v_dot2c_f32_bf16 v20, v109, v22
  v_dot2c_f32_bf16 v21, v109, v109
  v_dot2c_f32_bf16 v20, v110, v22
  v_dot2c_f32_bf16 v21, v110, v110
  v_dot2c_f32_bf16 v20, v111, v22
  v_dot2c_f32_bf16 v21, v111, v111
  v_mfma_f32_32x32x16_bf16 v[48:63], a[104:107], v[96:99], v[48:63]
  ds_read_b128 v[104:107], v24 offset:57344
  v_mfma_f32_32x32x16_bf16 v[64:79], a[104:107], v[100:103], v[64:79]
  ds_read_b128 v[96:99], v113 offset:57344
  ds_read_b128 v[100:103], v117 offset:57344
  s_waitcnt lgkmcnt(5)
  v_mfma_f32_32x32x16_bf16 v[48:63], a[108:111], v[80:83], v[48:63]
  v_mfma_f32_32x32x16_bf16 v[64:79], a[108:111], v[84:87], v[64:79]
  ds_read_b128 v[80:83], v114 offset:57344
  ds_read_b128 v[84:87], v118 offset:57344
  s_waitcnt lgkmcnt(4)
  v_dot2c_f32_bf16 v20, v104, v22
  v_dot2c_f32_bf16 v21, v104, v104
  v_dot2c_f32_bf16 v20, v105, v22
  v_dot2c_f32_bf16 v21, v105, v105
  v_dot2c_f32_bf16 v20, v106, v22
  v_dot2c_f32_bf16 v21, v106, v106
  v_dot2c_f32_bf16 v20, v107, v22
  v_dot2c_f32_bf16 v21, v107, v107
  v_mfma_f32_32x32x16_bf16 v[48:63], a[112:115], v[88:91], v[48:63]
  ds_read_b128 v[108:111], v25 offset:57344
  v_mfma_f32_32x32x16_bf16 v[64:79], a[112:115], v[92:95], v[64:79]
  ds_read_b128 v[88:91], v115 offset:57344
  ds_read_b128 v[92:95], v119 offset:57344
  s_waitcnt lgkmcnt(5)
  v_mfma_f32_32x32x16_bf16 v[48:63], a[116:119], v[96:99], v[48:63]
  v_mfma_f32_32x32x16_bf16 v[64:79], a[116:119], v[100:103], v[64:79]
  s_waitcnt lgkmcnt(2)
  v_dot2c_f32_bf16 v20, v108, v22
  v_dot2c_f32_bf16 v21, v108, v108
  v_dot2c_f32_bf16 v20, v109, v22
  v_dot2c_f32_bf16 v21, v109, v109
  v_dot2c_f32_bf16 v20, v110, v22
  v_dot2c_f32_bf16 v21, v110, v110
  v_dot2c_f32_bf16 v20, v111, v22
  v_dot2c_f32_bf16 v21, v111, v111
  s_nop 1
  v_mov_b32 v24, v20
  v_mov_b32 v25, v21
  s_nop 0
  v_permlane32_swap_b32 v20, v24
  v_permlane32_swap_b32 v21, v25
  v_add_f32 v20, v20, v24
  v_add_f32 v21, v21, v25
  ds_write_b64 v12, v[20:21]
  s_waitcnt lgkmcnt(0)
  s_barrier
  ds_read_b64 v[104:105], v13
  ds_read_b64 v[106:107], v13 offset:512
  ds_read_b64 v[108:109], v14
  ds_read_b64 v[110:111], v14 offset:512
  v_mfma_f32_32x32x16_bf16 v[48:63], a[120:123], v[80:83], v[48:63]
  v_mfma_f32_32x32x16_bf16 v[64:79], a[120:123], v[84:87], v[64:79]
  s_waitcnt lgkmcnt(0)
  v_add_f32 v104, v104, v106
  v_add_f32 v105, v105, v107
  v_add_f32 v108, v108, v110
  v_add_f32 v109, v109, v111
  v_mul_f32 v32, 0x3b000000, v104
  v_mul_f32 v34, 0x3b000000, v108
  v_mul_f32 v106, 0x3b000000, v105
  v_mul_f32 v110, 0x3b000000, v109
  v_fma_f32 v106, -v32, v32, v106
  v_fma_f32 v110, -v34, v34, v110
  v_max_f32 v106, 0, v106
  v_max_f32 v110, 0, v110
  v_cvt_pk_bf16_f32 v32, v32, v106
  v_cvt_pk_bf16_f32 v34, v34, v110
  v_and_b32 v106, 0xffff0000, v32
  v_and_b32 v110, 0xffff0000, v34
  v_lshlrev_b32 v32, 16, v32
  v_lshlrev_b32 v34, 16, v34
  v_add_f32 v106, 0x3727c5ac, v106
  v_add_f32 v110, 0x3727c5ac, v110
  v_cvt_pk_bf16_f32 v106, v106, v106
  v_cvt_pk_bf16_f32 v110, v110, v110
  v_lshlrev_b32 v106, 16, v106
  v_lshlrev_b32 v110, 16, v110
  v_sqrt_f32 v106, v106
  v_sqrt_f32 v110, v110
  v_cvt_pk_bf16_f32 v106, v106, v106
  v_cvt_pk_bf16_f32 v110, v110, v110
  v_lshlrev_b32 v106, 16, v106
  v_lshlrev_b32 v110, 16, v110
  v_rcp_f32 v33, v106
  v_rcp_f32 v35, v110
  v_mfma_f32_32x32x16_bf16 v[48:63], a[124:127], v[88:91], v[48:63]
  v_mfma_f32_32x32x16_bf16 v[64:79], a[124:127], v[92:95], v[64:79]
  s_waitcnt vmcnt(0)
  s_waitcnt lgkmcnt(0)
  s_barrier
  ds_read_b64_tr_b16 a[192:193], v47 offset:32768
  ds_read_b64_tr_b16 a[194:195], v47 offset:33280
  ds_read_b64_tr_b16 a[196:197], v47 offset:34816
  ds_read_b64_tr_b16 a[198:199], v47 offset:35328
  ds_read_b64_tr_b16 a[200:201], v47 offset:36864
  ds_read_b64_tr_b16 a[202:203], v47 offset:37376
  ds_read_b64_tr_b16 a[204:205], v47 offset:38912
  ds_read_b64_tr_b16 a[206:207], v47 offset:39424
  ds_read_b64_tr_b16 a[208:209], v47 offset:40960
  ds_read_b64_tr_b16 a[210:211], v47 offset:41472
  ds_read_b64_tr_b16 a[212:213], v47 offset:43008
  ds_read_b64_tr_b16 a[214:215], v47 offset:43520
  ds_read_b64_tr_b16 a[216:217], v47 offset:45056
  ds_read_b64_tr_b16 a[218:219], v47 offset:45568
  ds_read_b64_tr_b16 a[220:221], v47 offset:47104
  ds_read_b64_tr_b16 a[222:223], v47 offset:47616
  ds_read_b64_tr_b16 a[224:225], v47 offset:49152
  ds_read_b64_tr_b16 a[226:227], v47 offset:49664
  ds_read_b64_tr_b16 a[228:229], v47 offset:51200
  ds_read_b64_tr_b16 a[230:231], v47 offset:51712
  ds_read_b64_tr_b16 a[232:233], v47 offset:53248
  ds_read_b64_tr_b16 a[234:235], v47 offset:53760
  ds_read_b64_tr_b16 a[236:237], v47 offset:55296
  ds_read_b64_tr_b16 a[238:239], v47 offset:55808
  ds_read_b64_tr_b16 a[240:241], v47 offset:57344
  ds_read_b64_tr_b16 a[242:243], v47 offset:57856
  ds_read_b64_tr_b16 a[244:245], v47 offset:59392
  ds_read_b64_tr_b16 a[246:247], v47 offset:59904
  ds_read_b64_tr_b16 a[248:249], v47 offset:61440
  ds_read_b64_tr_b16 a[250:251], v47 offset:61952
  ds_read_b64_tr_b16 a[252:253], v47 offset:63488
  ds_read_b64_tr_b16 a[254:255], v47 offset:64000
  s_and_b32 s44, s33, 3
  s_lshl_b32 s44, s44, 1
  s_and_b32 s45, s34, 1
  s_add_u32 s44, s44, s45
  s_lshl_b32 s44, s44, 7
  v_and_b32 v251, 127, v0
  v_add_u32 v251, s44, v251
  v_and_b32 v252, 1, v251
  v_lshrrev_b32 v251, 1, v251
  v_lshlrev_b32 v251, 10, v251
  v_lshl_add_u32 v251, v252, 7, v251
  s_lshl_b32 s44, s36, 8
  v_add_u32 v251, s44, v251
  s_cmp_gt_u32 s30, 1
  s_cbranch_scc1 L_wopf_2
  global_load_dword v252, v251, s[10:11]
L_wopf_2:
  s_lshl_b32 s48, s30, 7
  v_and_b32 v96, 15, v1
  v_lshlrev_b32 v96, 6, v96
  v_lshrrev_b32 v97, 4, v1
  v_lshl_add_u32 v96, v97, 4, v96
  v_add_u32 v96, 107520, v96
  v_add_u32 v96, s48, v96
  s_mov_b32 exec_lo, 0x00030003
  s_mov_b32 exec_hi, 0x00030003
  ds_write_b128 v96, v[28:31]
  s_mov_b64 exec, -1
  ds_read_b128 v[80:83], v121 offset:0
  ds_read_b128 v[84:87], v121 offset:32
  ds_read_b128 v[88:91], v121 offset:64
  ds_read_b128 v[92:95], v121 offset:96
  s_waitcnt lgkmcnt(0)
  v_pk_fma_f32 v[48:49], v[80:81], v[32:33], v[48:49] op_sel_hi:[1,0,1] neg_lo:[0,1,0] neg_hi:[0,1,0]
  v_pk_fma_f32 v[50:51], v[82:83], v[32:33], v[50:51] op_sel_hi:[1,0,1] neg_lo:[0,1,0] neg_hi:[0,1,0]
  v_pk_fma_f32 v[52:53], v[84:85], v[32:33], v[52:53] op_sel_hi:[1,0,1] neg_lo:[0,1,0] neg_hi:[0,1,0]
  v_pk_fma_f32 v[54:55], v[86:87], v[32:33], v[54:55] op_sel_hi:[1,0,1] neg_lo:[0,1,0] neg_hi:[0,1,0]
  v_pk_fma_f32 v[56:57], v[88:89], v[32:33], v[56:57] op_sel_hi:[1,0,1] neg_lo:[0,1,0] neg_hi:[0,1,0]
  v_pk_fma_f32 v[58:59], v[90:91], v[32:33], v[58:59] op_sel_hi:[1,0,1] neg_lo:[0,1,0] neg_hi:[0,1,0]
  v_pk_fma_f32 v[60:61], v[92:93], v[32:33], v[60:61] op_sel_hi:[1,0,1] neg_lo:[0,1,0] neg_hi:[0,1,0]
  v_pk_fma_f32 v[62:63], v[94:95], v[32:33], v[62:63] op_sel_hi:[1,0,1] neg_lo:[0,1,0] neg_hi:[0,1,0]
  v_pk_mul_f32 v[48:49], v[48:49], v[32:33] op_sel:[0,1] op_sel_hi:[1,1]
  v_pk_mul_f32 v[50:51], v[50:51], v[32:33] op_sel:[0,1] op_sel_hi:[1,1]
  v_pk_mul_f32 v[52:53], v[52:53], v[32:33] op_sel:[0,1] op_sel_hi:[1,1]
  v_pk_mul_f32 v[54:55], v[54:55], v[32:33] op_sel:[0,1] op_sel_hi:[1,1]
  v_pk_mul_f32 v[56:57], v[56:57], v[32:33] op_sel:[0,1] op_sel_hi:[1,1]
  v_pk_mul_f32 v[58:59], v[58:59], v[32:33] op_sel:[0,1] op_sel_hi:[1,1]
  v_pk_mul_f32 v[60:61], v[60:61], v[32:33] op_sel:[0,1] op_sel_hi:[1,1]
  v_pk_mul_f32 v[62:63], v[62:63], v[32:33] op_sel:[0,1] op_sel_hi:[1,1]
  v_cvt_pk_bf16_f32 v96, v48, v49
  v_cvt_pk_bf16_f32 v97, v50, v51
  v_cvt_pk_bf16_f32 v98, v52, v53
  v_cvt_pk_bf16_f32 v99, v54, v55
  v_cvt_pk_bf16_f32 v100, v56, v57
  v_cvt_pk_bf16_f32 v101, v58, v59
  v_cvt_pk_bf16_f32 v102, v60, v61
  v_cvt_pk_bf16_f32 v103, v62, v63
  s_cmp_eq_u32 s40, 0
  s_cselect_b64 vcc, -1, 0
  v_cndmask_b32 v112, v8, v4, vcc
  v_cndmask_b32 v113, v9, v5, vcc
  v_cndmask_b32 v114, v10, v6, vcc
  v_cndmask_b32 v115, v11, v7, vcc
  s_nop 1
  v_mfma_f32_32x32x16_bf16 v[48:63], v[112:115], v[96:99], 0
  v_pk_fma_f32 v[64:65], v[80:81], v[34:35], v[64:65] op_sel_hi:[1,0,1] neg_lo:[0,1,0] neg_hi:[0,1,0]
  v_pk_fma_f32 v[66:67], v[82:83], v[34:35], v[66:67] op_sel_hi:[1,0,1] neg_lo:[0,1,0] neg_hi:[0,1,0]
  v_pk_fma_f32 v[68:69], v[84:85], v[34:35], v[68:69] op_sel_hi:[1,0,1] neg_lo:[0,1,0] neg_hi:[0,1,0]
  v_pk_fma_f32 v[70:71], v[86:87], v[34:35], v[70:71] op_sel_hi:[1,0,1] neg_lo:[0,1,0] neg_hi:[0,1,0]
  v_pk_fma_f32 v[72:73], v[88:89], v[34:35], v[72:73] op_sel_hi:[1,0,1] neg_lo:[0,1,0] neg_hi:[0,1,0]
  v_pk_fma_f32 v[74:75], v[90:91], v[34:35], v[74:75] op_sel_hi:[1,0,1] neg_lo:[0,1,0] neg_hi:[0,1,0]
  v_pk_fma_f32 v[76:77], v[92:93], v[34:35], v[76:77] op_sel_hi:[1,0,1] neg_lo:[0,1,0] neg_hi:[0,1,0]
  v_pk_fma_f32 v[78:79], v[94:95], v[34:35], v[78:79] op_sel_hi:[1,0,1] neg_lo:[0,1,0] neg_hi:[0,1,0]
  v_pk_mul_f32 v[64:65], v[64:65], v[34:35] op_sel:[0,1] op_sel_hi:[1,1]
  v_pk_mul_f32 v[66:67], v[66:67], v[34:35] op_sel:[0,1] op_sel_hi:[1,1]
  v_pk_mul_f32 v[68:69], v[68:69], v[34:35] op_sel:[0,1] op_sel_hi:[1,1]
  v_pk_mul_f32 v[70:71], v[70:71], v[34:35] op_sel:[0,1] op_sel_hi:[1,1]
  v_pk_mul_f32 v[72:73], v[72:73], v[34:35] op_sel:[0,1] op_sel_hi:[1,1]
  v_pk_mul_f32 v[74:75], v[74:75], v[34:35] op_sel:[0,1] op_sel_hi:[1,1]
  v_pk_mul_f32 v[76:77], v[76:77], v[34:35] op_sel:[0,1] op_sel_hi:[1,1]
  v_pk_mul_f32 v[78:79], v[78:79], v[34:35] op_sel:[0,1] op_sel_hi:[1,1]
  v_cvt_pk_bf16_f32 v104, v64, v65
  v_cvt_pk_bf16_f32 v105, v66, v67
  v_cvt_pk_bf16_f32 v106, v68, v69
  v_cvt_pk_bf16_f32 v107, v70, v71
  v_cvt_pk_bf16_f32 v108, v72, v73
  v_cvt_pk_bf16_f32 v109, v74, v75
  v_cvt_pk_bf16_f32 v110, v76, v77
  v_cvt_pk_bf16_f32 v111, v78, v79
  v_mfma_f32_32x32x16_bf16 v[64:79], v[112:115], v[104:107], 0
  ds_write_b64 v17, v[100:101]
  ds_write_b64 v17, v[102:103] offset:16
  ds_write_b64 v18, v[108:109]
  ds_write_b64 v18, v[110:111] offset:16
  v_max3_f32 v112, v48, v49, v50
  v_max3_f32 v113, v51, v52, v53
  v_max3_f32 v112, v112, v54, v55
  v_max3_f32 v113, v113, v56, v57
  v_max3_f32 v112, v112, v58, v59
  v_max3_f32 v113, v113, v60, v61
  v_max3_f32 v112, v112, v62, v63
  v_mov_b32 v114, 0x3fb8aa3b
  v_max_f32 v112, v112, v113
  v_mul_f32 v112, v114, v112
  v_max3_f32 v116, v64, v65, v66
  v_pk_fma_f32 v[48:49], v[48:49], v[114:115], v[112:113] op_sel_hi:[1,0,0] neg_lo:[0,0,1] neg_hi:[0,0,1]
  v_max3_f32 v117, v67, v68, v69
  v_pk_fma_f32 v[50:51], v[50:51], v[114:115], v[112:113] op_sel_hi:[1,0,0] neg_lo:[0,0,1] neg_hi:[0,0,1]
  v_max3_f32 v116, v116, v70, v71
  v_pk_fma_f32 v[52:53], v[52:53], v[114:115], v[112:113] op_sel_hi:[1,0,0] neg_lo:[0,0,1] neg_hi:[0,0,1]
  v_max3_f32 v117, v117, v72, v73
  v_pk_fma_f32 v[54:55], v[54:55], v[114:115], v[112:113] op_sel_hi:[1,0,0] neg_lo:[0,0,1] neg_hi:[0,0,1]
  v_max3_f32 v116, v116, v74, v75
  v_pk_fma_f32 v[56:57], v[56:57], v[114:115], v[112:113] op_sel_hi:[1,0,0] neg_lo:[0,0,1] neg_hi:[0,0,1]
  v_max3_f32 v117, v117, v76, v77
  v_pk_fma_f32 v[58:59], v[58:59], v[114:115], v[112:113] op_sel_hi:[1,0,0] neg_lo:[0,0,1] neg_hi:[0,0,1]
  v_max3_f32 v116, v116, v78, v79
  v_mov_b32 v118, 0x3fb8aa3b
  v_pk_fma_f32 v[60:61], v[60:61], v[114:115], v[112:113] op_sel_hi:[1,0,0] neg_lo:[0,0,1] neg_hi:[0,0,1]
  v_max_f32 v116, v116, v117
  v_pk_fma_f32 v[62:63], v[62:63], v[114:115], v[112:113] op_sel_hi:[1,0,0] neg_lo:[0,0,1] neg_hi:[0,0,1]
  v_mul_f32 v116, v118, v116
  v_exp_f32 v48, v48
  v_pk_fma_f32 v[64:65], v[64:65], v[118:119], v[116:117] op_sel_hi:[1,0,0] neg_lo:[0,0,1] neg_hi:[0,0,1]
  v_mfma_f32_16x16x32_bf16 v[28:31], a[128:131], v[144:147], 0
  v_pk_fma_f32 v[66:67], v[66:67], v[118:119], v[116:117] op_sel_hi:[1,0,0] neg_lo:[0,0,1] neg_hi:[0,0,1]
  v_exp_f32 v49, v49
  v_pk_fma_f32 v[68:69], v[68:69], v[118:119], v[116:117] op_sel_hi:[1,0,0] neg_lo:[0,0,1] neg_hi:[0,0,1]
  v_mfma_f32_16x16x32_bf16 v[28:31], a[132:135], v[144:147], v[28:31]
  v_pk_fma_f32 v[70:71], v[70:71], v[118:119], v[116:117] op_sel_hi:[1,0,0] neg_lo:[0,0,1] neg_hi:[0,0,1]
  v_exp_f32 v50, v50
  v_pk_fma_f32 v[72:73], v[72:73], v[118:119], v[116:117] op_sel_hi:[1,0,0] neg_lo:[0,0,1] neg_hi:[0,0,1]
  v_pk_fma_f32 v[74:75], v[74:75], v[118:119], v[116:117] op_sel_hi:[1,0,0] neg_lo:[0,0,1] neg_hi:[0,0,1]
  v_mfma_f32_16x16x32_bf16 v[28:31], a[136:139], v[144:147], v[28:31]
  v_pk_fma_f32 v[76:77], v[76:77], v[118:119], v[116:117] op_sel_hi:[1,0,0] neg_lo:[0,0,1] neg_hi:[0,0,1]
  v_exp_f32 v51, v51
  v_pk_fma_f32 v[78:79], v[78:79], v[118:119], v[116:117] op_sel_hi:[1,0,0] neg_lo:[0,0,1] neg_hi:[0,0,1]
  v_mfma_f32_16x16x32_bf16 v[28:31], a[140:143], v[144:147], v[28:31]
  v_exp_f32 v64, v64
  v_exp_f32 v52, v52
  v_mfma_f32_16x16x32_bf16 v[28:31], a[192:195], v[144:147], v[28:31]
  v_mfma_f32_16x16x32_bf16 v[28:31], a[144:147], v[144:147], v[28:31]
  v_exp_f32 v65, v65
  v_exp_f32 v53, v53
  v_mfma_f32_16x16x32_bf16 v[28:31], a[196:199], v[144:147], v[28:31]
  v_exp_f32 v66, v66
  v_mfma_f32_16x16x32_bf16 v[28:31], a[148:151], v[144:147], v[28:31]
  v_mfma_f32_16x16x32_bf16 v[28:31], a[200:203], v[144:147], v[28:31]
  v_exp_f32 v54, v54
  v_exp_f32 v67, v67
  v_mfma_f32_16x16x32_bf16 v[28:31], a[152:155], v[144:147], v[28:31]
  v_mfma_f32_16x16x32_bf16 v[28:31], a[204:207], v[144:147], v[28:31]
  v_exp_f32 v55, v55
  v_exp_f32 v68, v68
  v_mfma_f32_16x16x32_bf16 v[28:31], a[156:159], v[144:147], v[28:31]
  v_mfma_f32_16x16x32_bf16 v[28:31], a[208:211], v[144:147], v[28:31]
  v_exp_f32 v56, v56
  v_exp_f32 v69, v69
  v_mfma_f32_16x16x32_bf16 v[28:31], a[160:163], v[144:147], v[28:31]
  v_mfma_f32_16x16x32_bf16 v[28:31], a[212:215], v[144:147], v[28:31]
  v_exp_f32 v70, v70
  v_exp_f32 v57, v57
  v_mfma_f32_16x16x32_bf16 v[28:31], a[216:219], v[144:147], v[28:31]
  v_mfma_f32_16x16x32_bf16 v[28:31], a[164:167], v[144:147], v[28:31]
  v_exp_f32 v71, v71
  v_exp_f32 v58, v58
  v_mfma_f32_16x16x32_bf16 v[28:31], a[220:223], v[144:147], v[28:31]
  v_mfma_f32_16x16x32_bf16 v[28:31], a[168:171], v[144:147], v[28:31]
  v_exp_f32 v72, v72
  v_exp_f32 v59, v59
  v_mfma_f32_16x16x32_bf16 v[28:31], a[224:227], v[144:147], v[28:31]
  v_mfma_f32_16x16x32_bf16 v[28:31], a[172:175], v[144:147], v[28:31]
  v_exp_f32 v73, v73
  v_mfma_f32_16x16x32_bf16 v[28:31], a[228:231], v[144:147], v[28:31]
  v_exp_f32 v60, v60
  v_exp_f32 v74, v74
  v_mfma_f32_16x16x32_bf16 v[28:31], a[176:179], v[144:147], v[28:31]
  v_mfma_f32_16x16x32_bf16 v[28:31], a[232:235], v[144:147], v[28:31]
  v_exp_f32 v61, v61
  v_exp_f32 v75, v75
  v_mfma_f32_16x16x32_bf16 v[28:31], a[180:183], v[144:147], v[28:31]
  v_mfma_f32_16x16x32_bf16 v[28:31], a[236:239], v[144:147], v[28:31]
  v_exp_f32 v62, v62
  v_exp_f32 v76, v76
  v_mfma_f32_16x16x32_bf16 v[28:31], a[184:187], v[144:147], v[28:31]
  v_mfma_f32_16x16x32_bf16 v[28:31], a[240:243], v[144:147], v[28:31]
  v_exp_f32 v63, v63
  v_exp_f32 v77, v77
  v_mfma_f32_16x16x32_bf16 v[28:31], a[244:247], v[144:147], v[28:31]
  v_mfma_f32_16x16x32_bf16 v[28:31], a[188:191], v[144:147], v[28:31]
  v_exp_f32 v78, v78
  v_pk_add_f32 v[114:115], v[48:49], v[50:51]
  v_mfma_f32_16x16x32_bf16 v[28:31], a[248:251], v[144:147], v[28:31]
  v_pk_add_f32 v[112:113], v[52:53], v[54:55]
  v_exp_f32 v79, v79
  v_pk_add_f32 v[114:115], v[114:115], v[56:57]
  v_mfma_f32_16x16x32_bf16 v[28:31], a[252:255], v[144:147], v[28:31]
  v_pk_add_f32 v[112:113], v[112:113], v[58:59]
  v_pk_add_f32 v[118:119], v[64:65], v[66:67]
  v_pk_add_f32 v[114:115], v[114:115], v[60:61]
  v_pk_add_f32 v[116:117], v[68:69], v[70:71]
  v_pk_add_f32 v[118:119], v[118:119], v[72:73]
  v_pk_add_f32 v[112:113], v[112:113], v[62:63]
  v_pk_add_f32 v[116:117], v[116:117], v[74:75]
  v_pk_add_f32 v[114:115], v[114:115], v[112:113]
  v_pk_add_f32 v[118:119], v[118:119], v[76:77]
  v_add_f32 v114, v114, v115
  v_pk_add_f32 v[116:117], v[116:117], v[78:79]
  v_rcp_f32 v114, v114
  v_pk_add_f32 v[118:119], v[118:119], v[116:117]
  v_pk_mul_f32 v[48:49], v[48:49], v[114:115] op_sel_hi:[1,0]
  v_add_f32 v118, v118, v119
  v_pk_mul_f32 v[50:51], v[50:51], v[114:115] op_sel_hi:[1,0]
  v_rcp_f32 v118, v118
  v_pk_mul_f32 v[52:53], v[52:53], v[114:115] op_sel_hi:[1,0]
  v_pk_mul_f32 v[64:65], v[64:65], v[118:119] op_sel_hi:[1,0]
  v_pk_mul_f32 v[66:67], v[66:67], v[118:119] op_sel_hi:[1,0]
  v_pk_mul_f32 v[54:55], v[54:55], v[114:115] op_sel_hi:[1,0]
  v_pk_mul_f32 v[68:69], v[68:69], v[118:119] op_sel_hi:[1,0]
  v_pk_mul_f32 v[56:57], v[56:57], v[114:115] op_sel_hi:[1,0]
  v_pk_mul_f32 v[70:71], v[70:71], v[118:119] op_sel_hi:[1,0]
  v_pk_mul_f32 v[58:59], v[58:59], v[114:115] op_sel_hi:[1,0]
  v_pk_mul_f32 v[72:73], v[72:73], v[118:119] op_sel_hi:[1,0]
  v_pk_mul_f32 v[60:61], v[60:61], v[114:115] op_sel_hi:[1,0]
  v_pk_mul_f32 v[74:75], v[74:75], v[118:119] op_sel_hi:[1,0]
  v_pk_mul_f32 v[62:63], v[62:63], v[114:115] op_sel_hi:[1,0]
  v_pk_mul_f32 v[76:77], v[76:77], v[118:119] op_sel_hi:[1,0]
  v_cvt_pk_bf16_f32 v80, v48, v49
  v_pk_mul_f32 v[78:79], v[78:79], v[118:119] op_sel_hi:[1,0]
  v_cvt_pk_bf16_f32 v88, v64, v65
  v_cvt_pk_bf16_f32 v81, v50, v51
  v_cvt_pk_bf16_f32 v89, v66, v67
  v_cvt_pk_bf16_f32 v82, v52, v53
  v_cvt_pk_bf16_f32 v90, v68, v69
  v_cvt_pk_bf16_f32 v83, v54, v55
  v_cvt_pk_bf16_f32 v91, v70, v71
  v_cvt_pk_bf16_f32 v84, v56, v57
  v_cvt_pk_bf16_f32 v92, v72, v73
  v_cvt_pk_bf16_f32 v85, v58, v59
  v_cvt_pk_bf16_f32 v93, v74, v75
  v_cvt_pk_bf16_f32 v86, v60, v61
  v_cvt_pk_bf16_f32 v94, v76, v77
  v_cvt_pk_bf16_f32 v87, v62, v63
  v_cvt_pk_bf16_f32 v95, v78, v79
  ds_write_b128 v15, v[80:83]
  ds_write_b128 v15, v[84:87] offset:16
  ds_write_b128 v16, v[88:91]
  ds_write_b128 v16, v[92:95] offset:16
  ds_read_b64_tr_b16 v[64:65], v23 offset:0
  ds_read_b64_tr_b16 v[66:67], v26 offset:0
  ds_read_b64_tr_b16 v[68:69], v23 offset:1024
  ds_read_b64_tr_b16 v[70:71], v26 offset:1024
  v_mov_b32 v88, 0
  v_mov_b32 v89, 0
  v_mov_b32 v22, 0x3f803f80
  ds_read_b64_tr_b16 v[48:49], v19 offset:0
  ds_read_b64_tr_b16 v[50:51], v19 offset:320
  ds_read_b64_tr_b16 v[56:57], v19 offset:32
  ds_read_b64_tr_b16 v[58:59], v19 offset:352
  ds_read_b64_tr_b16 v[52:53], v19 offset:2560
  ds_read_b64_tr_b16 v[54:55], v19 offset:2880
  ds_read_b64_tr_b16 v[60:61], v19 offset:2592
  ds_read_b64_tr_b16 v[62:63], v19 offset:2912
  v_mov_b32 v97, s38
  v_mov_b32 v99, s38
  v_mov_b32 v101, s38
  v_mov_b32 v103, s38
  s_waitcnt lgkmcnt(4)
  v_mfma_f32_16x16x32_bf16 v[80:83], v[48:51], v[64:67], 0
  v_mfma_f32_16x16x32_bf16 v[84:87], v[56:59], v[64:67], 0
  s_waitcnt lgkmcnt(0)
  v_mfma_f32_16x16x32_bf16 v[80:83], v[52:55], v[68:71], v[80:83]
  v_mfma_f32_16x16x32_bf16 v[84:87], v[60:63], v[68:71], v[84:87]
  v_dot2c_f32_bf16 v88, v48, v22
  v_dot2c_f32_bf16 v89, v56, v22
  v_dot2c_f32_bf16 v88, v49, v22
  v_dot2c_f32_bf16 v89, v57, v22
  v_dot2c_f32_bf16 v88, v50, v22
  v_dot2c_f32_bf16 v89, v58, v22
  v_dot2c_f32_bf16 v88, v51, v22
  v_dot2c_f32_bf16 v89, v59, v22
  v_dot2c_f32_bf16 v88, v52, v22
  v_dot2c_f32_bf16 v89, v60, v22
  v_dot2c_f32_bf16 v88, v53, v22
  v_dot2c_f32_bf16 v89, v61, v22
  v_dot2c_f32_bf16 v88, v54, v22
  v_dot2c_f32_bf16 v89, v62, v22
  v_dot2c_f32_bf16 v88, v55, v22
  v_dot2c_f32_bf16 v89, v63, v22
  v_cvt_pk_bf16_f32 v96, v80, v81
  v_cvt_pk_bf16_f32 v98, v82, v83
  buffer_store_dwordx4 v[96:99], v27, s[88:91], 0 offen offset:0 sc1
  v_cvt_pk_bf16_f32 v100, v84, v85
  v_cvt_pk_bf16_f32 v102, v86, v87
  buffer_store_dwordx4 v[100:103], v27, s[88:91], 0 offen offset:64 sc1
  v_mov_b32 v90, v88
  s_nop 1
  v_permlane32_swap_b32 v88, v90
  v_add_f32 v88, v88, v90
  v_mov_b32 v90, v88
  s_nop 1
  v_permlane16_swap_b32 v88, v90
  v_add_f32 v88, v88, v90
  v_mov_b32 v90, v89
  s_nop 1
  v_permlane32_swap_b32 v89, v90
  v_add_f32 v89, v89, v90
  v_mov_b32 v90, v89
  s_nop 1
  v_permlane16_swap_b32 v89, v90
  v_add_f32 v89, v89, v90
  v_and_b32 v90, 16, v1
  v_cmp_eq_u32 vcc, 0, v90
  s_nop 1
  v_cndmask_b32 v88, v89, v88, vcc
  v_cvt_pk_bf16_f32 v88, v88, 0
  v_mov_b32 v89, s38
  s_mov_b32 exec_lo, -1
  s_mov_b32 exec_hi, 0
  buffer_store_dwordx2 v[88:89], v120, s[88:91], 0 offen sc1
  s_mov_b64 exec, -1
  s_xor_b32 s45, s40, 1
  v_bfe_u32 v24, v3, 1, 3
  v_lshlrev_b32 v25, 7, v3
  s_lshl_b32 s44, s40, 12
  s_lshl_b32 s45, s45, 12
  v_add_u32 v26, 0, v2
  v_xor_b32 v26, v26, v24
  v_lshl_add_u32 v26, v26, 4, v25
  v_add_u32 v112, s44, v26
  v_add_u32 v26, 2, v2
  v_xor_b32 v26, v26, v24
  v_lshl_add_u32 v26, v26, 4, v25
  v_add_u32 v113, s44, v26
  v_add_u32 v26, 4, v2
  v_xor_b32 v26, v26, v24
  v_lshl_add_u32 v26, v26, 4, v25
  v_add_u32 v114, s44, v26
  v_add_u32 v26, 6, v2
  v_xor_b32 v26, v26, v24
  v_lshl_add_u32 v26, v26, 4, v25
  v_add_u32 v115, s44, v26
  s_lshl_b32 s48, s41, 7
  v_and_b32 v104, 15, v1
  v_lshlrev_b32 v104, 6, v104
  v_lshrrev_b32 v105, 4, v1
  v_lshl_add_u32 v104, v105, 4, v104
  v_add_u32 v104, 108032, v104
  v_add_u32 v104, s48, v104
  s_mov_b32 exec_lo, 0x00030003
  s_mov_b32 exec_hi, 0x00030003
  ds_write_b128 v104, v[28:31]
  s_mov_b64 exec, -1
  s_barrier
  v_and_b32 v117, 7, v1
  v_lshlrev_b32 v117, 3, v117
  s_lshl_b32 s44, s33, 6
  s_add_u32 s44, s44, 491520
  v_add_u32 v250, s44, v117
  buffer_load_dwordx2 v[118:119], v250, s[88:91], 0 offen sc1
  v_lshrrev_b32 v214, 4, v1
  v_lshlrev_b32 v158, 2, v214
  v_and_b32 v159, 15, v1
  v_xor_b32 v158, v158, v159
  v_lshlrev_b32 v158, 4, v158
  s_lshl_b32 s44, s30, 2
  v_add_u32 v214, s44, v214
  v_lshl_add_u32 v214, v214, 10, v158
  s_lshl_b32 s44, s36, 8
  v_add_u32 v214, s44, v214
  ds_read_b128 v[80:83], v112 offset:0
  ds_read_b128 v[84:87], v113 offset:0
  ds_read_b128 v[88:91], v114 offset:0
  s_lshl_b32 s44, s34, 5
  s_lshl_b32 s45, s30, 3
  s_add_u32 s44, s44, s45
  s_mul_i32 s44, s44, 9216
  s_mul_i32 s45, s33, 288
  s_add_u32 s44, s44, s45
  s_add_u32 s44, s44, 1048576
  v_min_u32 v116, 35, v1
  v_lshlrev_b32 v116, 3, v116
  v_add_u32 v116, s44, v116
  s_lshl_b32 s48, s41, 7
  ds_read_b128 v[92:95], v115 offset:0
  s_waitcnt lgkmcnt(3)
  v_mfma_f32_32x32x16_bf16 v[48:63], a[128:131], v[80:83], 0
  s_add_u32 m0, s39, 65536
  v_add_u32 v215, 262144, v214
  global_load_lds_dwordx4 v215, s[10:11]
  ds_read_b128 v[80:83], v112 offset:8192
  s_waitcnt lgkmcnt(3)
  v_mfma_f32_32x32x16_bf16 v[48:63], a[132:135], v[84:87], v[48:63]
  ds_read_b128 v[84:87], v113 offset:8192
  s_waitcnt lgkmcnt(3)
  v_mfma_f32_32x32x16_bf16 v[48:63], a[136:139], v[88:91], v[48:63]
  s_and_b32 s44, s34, 1
  s_lshl_b32 s45, s36, 1
  s_add_u32 s45, s45, s41
  s_lshl_b32 s45, s45, 13
  s_lshl_b32 s44, s44, 12
  s_add_u32 s44, s44, s45
  v_lshlrev_b32 v104, 7, v3
  v_lshl_add_u32 v104, v2, 3, v104
  v_add_u32 v104, s44, v104
  v_bfe_u32 v105, v3, 1, 3
  s_lshl_b32 s45, s40, 2
  s_add_u32 s46, s45, 0
  v_xor_b32 v106, s46, v105
  v_lshl_add_u32 v106, v106, 4, v104
  ds_read_b64 v[12:13], v106
  s_add_u32 s46, s45, 1
  v_xor_b32 v106, s46, v105
  v_lshl_add_u32 v106, v106, 4, v104
  ds_read_b64 v[14:15], v106
  s_add_u32 s46, s45, 2
  v_xor_b32 v106, s46, v105
  v_lshl_add_u32 v106, v106, 4, v104
  ds_read_b64 v[16:17], v106
  s_add_u32 s46, s45, 3
  v_xor_b32 v106, s46, v105
  v_lshl_add_u32 v106, v106, 4, v104
  ds_read_b64 v[18:19], v106
  s_add_u32 m0, s39, 69632
  v_add_u32 v215, 278528, v214
  global_load_lds_dwordx4 v215, s[10:11]
  ds_read_b128 v[88:91], v114 offset:8192
  s_waitcnt lgkmcnt(7)
  v_mfma_f32_32x32x16_bf16 v[48:63], a[140:143], v[92:95], v[48:63]
  ds_read_b128 v[92:95], v115 offset:8192
  s_waitcnt lgkmcnt(7)
  v_mfma_f32_32x32x16_bf16 v[48:63], a[144:147], v[80:83], v[48:63]
  s_add_u32 m0, s39, 73728
  v_add_u32 v215, 294912, v214
  global_load_lds_dwordx4 v215, s[10:11]
  ds_read_b128 v[80:83], v112 offset:16384
  s_waitcnt lgkmcnt(7)
  v_mfma_f32_32x32x16_bf16 v[48:63], a[148:151], v[84:87], v[48:63]
  ds_read_b128 v[84:87], v113 offset:16384
  s_waitcnt lgkmcnt(3)
  v_mfma_f32_32x32x16_bf16 v[48:63], a[152:155], v[88:91], v[48:63]
  v_mov_b32 v100, 0
  v_mov_b32 v101, 0
  v_mov_b32 v102, 0
  v_mov_b32 v103, 0
  v_lshlrev_b32 v96, 4, v0
  v_add_u32 v96, 97280, v96
  ds_write_b128 v96, v[100:103]
  ds_write_b128 v96, v[100:103] offset:4096
  s_cmp_gt_u32 s30, 1
  s_cbranch_scc1 L_kz_3
  ds_write_b128 v96, v[100:103] offset:8192
L_kz_3:
  s_add_u32 m0, s39, 77824
  v_add_u32 v215, 311296, v214
  global_load_lds_dwordx4 v215, s[10:11]
  ds_read_b128 v[88:91], v114 offset:16384
  s_waitcnt lgkmcnt(5)
  v_mfma_f32_32x32x16_bf16 v[48:63], a[156:159], v[92:95], v[48:63]
  ds_read_b128 v[92:95], v115 offset:16384
  s_waitcnt lgkmcnt(5)
  v_mfma_f32_32x32x16_bf16 v[48:63], a[160:163], v[80:83], v[48:63]
  s_add_u32 m0, s39, 81920
  v_add_u32 v215, 327680, v214
  global_load_lds_dwordx4 v215, s[10:11]
  ds_read_b128 v[80:83], v112 offset:24576
  s_waitcnt lgkmcnt(5)
  v_mfma_f32_32x32x16_bf16 v[48:63], a[164:167], v[84:87], v[48:63]
  ds_read_b128 v[84:87], v113 offset:24576
  s_waitcnt lgkmcnt(3)
  v_mfma_f32_32x32x16_bf16 v[48:63], a[168:171], v[88:91], v[48:63]
  s_add_u32 m0, s39, 86016
  v_add_u32 v215, 344064, v214
  global_load_lds_dwordx4 v215, s[10:11]
  ds_read_b128 v[88:91], v114 offset:24576
  s_waitcnt lgkmcnt(3)
  v_mfma_f32_32x32x16_bf16 v[48:63], a[172:175], v[92:95], v[48:63]
  ds_read_b128 v[92:95], v115 offset:24576
  s_waitcnt lgkmcnt(3)
  v_mfma_f32_32x32x16_bf16 v[48:63], a[176:179], v[80:83], v[48:63]
  s_add_u32 m0, s39, 108544
  v_add_u32 v215, 360448, v214
  global_load_lds_dwordx4 v215, s[10:11]
  ds_read_b128 v[80:83], v112 offset:32768
  s_waitcnt lgkmcnt(3)
  v_mfma_f32_32x32x16_bf16 v[48:63], a[180:183], v[84:87], v[48:63]
  ds_read_b128 v[84:87], v113 offset:32768
  s_waitcnt lgkmcnt(3)
  v_mfma_f32_32x32x16_bf16 v[48:63], a[184:187], v[88:91], v[48:63]
  s_add_u32 m0, s39, 112640
  v_add_u32 v215, 376832, v214
  global_load_lds_dwordx4 v215, s[10:11]
  ds_read_b128 v[88:91], v114 offset:32768
  s_waitcnt lgkmcnt(3)
  v_mfma_f32_32x32x16_bf16 v[48:63], a[188:191], v[92:95], v[48:63]
  ds_read_b128 v[92:95], v115 offset:32768
  s_waitcnt lgkmcnt(3)
  v_mfma_f32_32x32x16_bf16 v[48:63], a[192:195], v[80:83], v[48:63]
  s_add_u32 m0, s39, 116736
  v_add_u32 v215, 393216, v214
  global_load_lds_dwordx4 v215, s[10:11]
  ds_read_b128 v[80:83], v112 offset:40960
  s_waitcnt lgkmcnt(3)
  v_mfma_f32_32x32x16_bf16 v[48:63], a[196:199], v[84:87], v[48:63]
  ds_read_b128 v[84:87], v113 offset:40960
  s_waitcnt lgkmcnt(3)
  v_mfma_f32_32x32x16_bf16 v[48:63], a[200:203], v[88:91], v[48:63]
  s_add_u32 m0, s39, 120832
  v_add_u32 v215, 409600, v214
  global_load_lds_dwordx4 v215, s[10:11]
  ds_read_b128 v[88:91], v114 offset:40960
  s_waitcnt lgkmcnt(3)
  v_mfma_f32_32x32x16_bf16 v[48:63], a[204:207], v[92:95], v[48:63]
  ds_read_b128 v[92:95], v115 offset:40960
  s_waitcnt lgkmcnt(3)
  v_mfma_f32_32x32x16_bf16 v[48:63], a[208:211], v[80:83], v[48:63]
  s_add_u32 m0, s39, 124928
  v_add_u32 v215, 425984, v214
  global_load_lds_dwordx4 v215, s[10:11]
  ds_read_b128 v[80:83], v112 offset:49152
  s_waitcnt lgkmcnt(3)
  v_mfma_f32_32x32x16_bf16 v[48:63], a[212:215], v[84:87], v[48:63]
  ds_read_b128 v[84:87], v113 offset:49152
  s_waitcnt lgkmcnt(3)
  v_mfma_f32_32x32x16_bf16 v[48:63], a[216:219], v[88:91], v[48:63]
  s_add_u32 m0, s39, 129024
  v_add_u32 v215, 442368, v214
  global_load_lds_dwordx4 v215, s[10:11]
  ds_read_b128 v[88:91], v114 offset:49152
  s_waitcnt lgkmcnt(3)
  v_mfma_f32_32x32x16_bf16 v[48:63], a[220:223], v[92:95], v[48:63]
  ds_read_b128 v[92:95], v115 offset:49152
  s_waitcnt lgkmcnt(3)
  v_mfma_f32_32x32x16_bf16 v[48:63], a[224:227], v[80:83], v[48:63]
  s_add_u32 m0, s39, 133120
  v_add_u32 v215, 458752, v214
  global_load_lds_dwordx4 v215, s[10:11]
  v_lshlrev_b32 v30, 4, v2
  v_add_u32 v30, 108032, v30
  v_add_u32 v30, s48, v30
  ds_read_b128 v[64:67], v30 offset:0
  ds_read_b128 v[68:71], v30 offset:32
  ds_read_b128 v[72:75], v30 offset:64
  ds_read_b128 v[76:79], v30 offset:96
  ds_read_b128 v[80:83], v112 offset:57344
  s_waitcnt lgkmcnt(7)
  v_mfma_f32_32x32x16_bf16 v[48:63], a[228:231], v[84:87], v[48:63]
  ds_read_b128 v[84:87], v113 offset:57344
  s_waitcnt lgkmcnt(7)
  v_mfma_f32_32x32x16_bf16 v[48:63], a[232:235], v[88:91], v[48:63]
  s_add_u32 m0, s39, 137216
  v_add_u32 v215, 475136, v214
  global_load_lds_dwordx4 v215, s[10:11]
  ds_read_b128 v[88:91], v114 offset:57344
  s_waitcnt lgkmcnt(7)
  v_mfma_f32_32x32x16_bf16 v[48:63], a[236:239], v[92:95], v[48:63]
  ds_read_b128 v[92:95], v115 offset:57344
  s_waitcnt lgkmcnt(3)
  v_mfma_f32_32x32x16_bf16 v[48:63], a[240:243], v[80:83], v[48:63]
  s_add_u32 m0, s39, 141312
  v_add_u32 v215, 491520, v214
  global_load_lds_dwordx4 v215, s[10:11]
  s_waitcnt lgkmcnt(2)
  v_mfma_f32_32x32x16_bf16 v[48:63], a[244:247], v[84:87], v[48:63]
  s_waitcnt lgkmcnt(1)
  v_mfma_f32_32x32x16_bf16 v[48:63], a[248:251], v[88:91], v[48:63]
  s_add_u32 m0, s39, 145408
  v_add_u32 v215, 507904, v214
  global_load_lds_dwordx4 v215, s[10:11]
  s_waitcnt lgkmcnt(0)
  v_mfma_f32_32x32x16_bf16 v[48:63], a[252:255], v[92:95], v[48:63]
  s_waitcnt lgkmcnt(0)
  s_nop 10
  v_pk_fma_f32 v[48:49], v[64:65], v[32:33], v[48:49] op_sel_hi:[1,0,1] neg_lo:[0,1,0] neg_hi:[0,1,0]
  v_pk_fma_f32 v[50:51], v[66:67], v[32:33], v[50:51] op_sel_hi:[1,0,1] neg_lo:[0,1,0] neg_hi:[0,1,0]
  v_pk_fma_f32 v[52:53], v[68:69], v[32:33], v[52:53] op_sel_hi:[1,0,1] neg_lo:[0,1,0] neg_hi:[0,1,0]
  v_pk_fma_f32 v[54:55], v[70:71], v[32:33], v[54:55] op_sel_hi:[1,0,1] neg_lo:[0,1,0] neg_hi:[0,1,0]
  v_pk_fma_f32 v[56:57], v[72:73], v[32:33], v[56:57] op_sel_hi:[1,0,1] neg_lo:[0,1,0] neg_hi:[0,1,0]
  v_pk_fma_f32 v[58:59], v[74:75], v[32:33], v[58:59] op_sel_hi:[1,0,1] neg_lo:[0,1,0] neg_hi:[0,1,0]
  v_pk_fma_f32 v[60:61], v[76:77], v[32:33], v[60:61] op_sel_hi:[1,0,1] neg_lo:[0,1,0] neg_hi:[0,1,0]
  v_pk_fma_f32 v[62:63], v[78:79], v[32:33], v[62:63] op_sel_hi:[1,0,1] neg_lo:[0,1,0] neg_hi:[0,1,0]
  v_pk_mul_f32 v[48:49], v[48:49], v[32:33] op_sel:[0,1] op_sel_hi:[1,1]
  v_pk_mul_f32 v[50:51], v[50:51], v[32:33] op_sel:[0,1] op_sel_hi:[1,1]
  v_pk_mul_f32 v[52:53], v[52:53], v[32:33] op_sel:[0,1] op_sel_hi:[1,1]
  v_pk_mul_f32 v[54:55], v[54:55], v[32:33] op_sel:[0,1] op_sel_hi:[1,1]
  v_pk_mul_f32 v[56:57], v[56:57], v[32:33] op_sel:[0,1] op_sel_hi:[1,1]
  v_pk_mul_f32 v[58:59], v[58:59], v[32:33] op_sel:[0,1] op_sel_hi:[1,1]
  v_pk_mul_f32 v[60:61], v[60:61], v[32:33] op_sel:[0,1] op_sel_hi:[1,1]
  v_pk_mul_f32 v[62:63], v[62:63], v[32:33] op_sel:[0,1] op_sel_hi:[1,1]
  v_cvt_pk_bf16_f32 v96, v48, v49
  v_cvt_pk_bf16_f32 v97, v50, v51
  v_cvt_pk_bf16_f32 v98, v52, v53
  v_cvt_pk_bf16_f32 v99, v54, v55
  v_cvt_pk_bf16_f32 v100, v56, v57
  v_cvt_pk_bf16_f32 v101, v58, v59
  v_cvt_pk_bf16_f32 v102, v60, v61
  v_cvt_pk_bf16_f32 v103, v62, v63
  v_mfma_f32_32x32x16_bf16 v[48:63], v[4:7], v[96:99], 0
  s_nop 0
  v_mfma_f32_32x32x16_bf16 v[64:79], v[8:11], v[100:103], 0
  v_add_u32 v117, 0, v116
  buffer_load_dwordx2 v[80:81], v117, s[88:91], 0 offen sc1
  v_add_u32 v117, 9216, v116
  buffer_load_dwordx2 v[82:83], v117, s[88:91], 0 offen sc1
  v_add_u32 v117, 18432, v116
  buffer_load_dwordx2 v[84:85], v117, s[88:91], 0 offen sc1
  v_add_u32 v117, 27648, v116
  buffer_load_dwordx2 v[86:87], v117, s[88:91], 0 offen sc1
  v_add_u32 v117, 36864, v116
  buffer_load_dwordx2 v[88:89], v117, s[88:91], 0 offen sc1
  v_add_u32 v117, 46080, v116
  buffer_load_dwordx2 v[90:91], v117, s[88:91], 0 offen sc1
  v_add_u32 v117, 55296, v116
  buffer_load_dwordx2 v[92:93], v117, s[88:91], 0 offen sc1
  v_add_u32 v117, 64512, v116
  buffer_load_dwordx2 v[94:95], v117, s[88:91], 0 offen sc1
  v_max3_f32 v104, v48, v49, v50
  v_max3_f32 v108, v64, v65, v66
  v_max3_f32 v105, v51, v52, v53
  v_max3_f32 v109, v67, v68, v69
  v_max3_f32 v104, v104, v54, v55
  v_max3_f32 v108, v108, v70, v71
  v_max3_f32 v105, v105, v56, v57
  v_max3_f32 v109, v109, v72, v73
  v_max3_f32 v104, v104, v58, v59
  v_max3_f32 v108, v108, v74, v75
  v_max3_f32 v105, v105, v60, v61
  v_max3_f32 v109, v109, v76, v77
  v_max3_f32 v104, v104, v62, v63
  v_max3_f32 v108, v108, v78, v79
  v_mov_b32 v106, 0x3fb8aa3b
  v_mov_b32 v110, 0x3fb8aa3b
  v_max_f32 v104, v104, v105
  v_max_f32 v108, v108, v109
  v_mul_f32 v104, v106, v104
  v_mul_f32 v108, v110, v108
  v_pk_fma_f32 v[48:49], v[48:49], v[106:107], v[104:105] op_sel_hi:[1,0,0] neg_lo:[0,0,1] neg_hi:[0,0,1]
  v_pk_fma_f32 v[64:65], v[64:65], v[110:111], v[108:109] op_sel_hi:[1,0,0] neg_lo:[0,0,1] neg_hi:[0,0,1]
  v_pk_fma_f32 v[50:51], v[50:51], v[106:107], v[104:105] op_sel_hi:[1,0,0] neg_lo:[0,0,1] neg_hi:[0,0,1]
  v_pk_fma_f32 v[66:67], v[66:67], v[110:111], v[108:109] op_sel_hi:[1,0,0] neg_lo:[0,0,1] neg_hi:[0,0,1]
  v_pk_fma_f32 v[52:53], v[52:53], v[106:107], v[104:105] op_sel_hi:[1,0,0] neg_lo:[0,0,1] neg_hi:[0,0,1]
  v_pk_fma_f32 v[68:69], v[68:69], v[110:111], v[108:109] op_sel_hi:[1,0,0] neg_lo:[0,0,1] neg_hi:[0,0,1]
  v_pk_fma_f32 v[54:55], v[54:55], v[106:107], v[104:105] op_sel_hi:[1,0,0] neg_lo:[0,0,1] neg_hi:[0,0,1]
  v_pk_fma_f32 v[70:71], v[70:71], v[110:111], v[108:109] op_sel_hi:[1,0,0] neg_lo:[0,0,1] neg_hi:[0,0,1]
  v_pk_fma_f32 v[56:57], v[56:57], v[106:107], v[104:105] op_sel_hi:[1,0,0] neg_lo:[0,0,1] neg_hi:[0,0,1]
  v_pk_fma_f32 v[72:73], v[72:73], v[110:111], v[108:109] op_sel_hi:[1,0,0] neg_lo:[0,0,1] neg_hi:[0,0,1]
  v_pk_fma_f32 v[58:59], v[58:59], v[106:107], v[104:105] op_sel_hi:[1,0,0] neg_lo:[0,0,1] neg_hi:[0,0,1]
  v_pk_fma_f32 v[74:75], v[74:75], v[110:111], v[108:109] op_sel_hi:[1,0,0] neg_lo:[0,0,1] neg_hi:[0,0,1]
  v_pk_fma_f32 v[60:61], v[60:61], v[106:107], v[104:105] op_sel_hi:[1,0,0] neg_lo:[0,0,1] neg_hi:[0,0,1]
  v_pk_fma_f32 v[76:77], v[76:77], v[110:111], v[108:109] op_sel_hi:[1,0,0] neg_lo:[0,0,1] neg_hi:[0,0,1]
  v_pk_fma_f32 v[62:63], v[62:63], v[106:107], v[104:105] op_sel_hi:[1,0,0] neg_lo:[0,0,1] neg_hi:[0,0,1]
  v_pk_fma_f32 v[78:79], v[78:79], v[110:111], v[108:109] op_sel_hi:[1,0,0] neg_lo:[0,0,1] neg_hi:[0,0,1]
  v_exp_f32 v48, v48
  v_exp_f32 v64, v64
  v_exp_f32 v49, v49
  v_exp_f32 v65, v65
  v_exp_f32 v50, v50
  v_exp_f32 v66, v66
  v_exp_f32 v51, v51
  v_exp_f32 v67, v67
  v_exp_f32 v52, v52
  v_exp_f32 v68, v68
  v_exp_f32 v53, v53
  v_exp_f32 v69, v69
  v_exp_f32 v54, v54
  v_exp_f32 v70, v70
  v_exp_f32 v55, v55
  v_exp_f32 v71, v71
  v_exp_f32 v56, v56
  v_exp_f32 v72, v72
  v_exp_f32 v57, v57
  v_exp_f32 v73, v73
  v_exp_f32 v58, v58
  v_exp_f32 v74, v74
  v_exp_f32 v59, v59
  v_exp_f32 v75, v75
  v_exp_f32 v60, v60
  v_exp_f32 v76, v76
  v_exp_f32 v61, v61
  v_exp_f32 v77, v77
  v_exp_f32 v62, v62
  v_exp_f32 v78, v78
  v_exp_f32 v63, v63
  v_exp_f32 v79, v79
  v_pk_add_f32 v[106:107], v[48:49], v[50:51]
  v_pk_add_f32 v[110:111], v[64:65], v[66:67]
  v_pk_add_f32 v[104:105], v[52:53], v[54:55]
  v_pk_add_f32 v[108:109], v[68:69], v[70:71]
  v_pk_add_f32 v[106:107], v[106:107], v[56:57]
  v_pk_add_f32 v[110:111], v[110:111], v[72:73]
  v_pk_add_f32 v[104:105], v[104:105], v[58:59]
  v_pk_add_f32 v[108:109], v[108:109], v[74:75]
  v_pk_add_f32 v[106:107], v[106:107], v[60:61]
  v_pk_add_f32 v[110:111], v[110:111], v[76:77]
  v_pk_add_f32 v[104:105], v[104:105], v[62:63]
  v_pk_add_f32 v[108:109], v[108:109], v[78:79]
  v_pk_add_f32 v[106:107], v[106:107], v[104:105]
  v_pk_add_f32 v[110:111], v[110:111], v[108:109]
  v_add_f32 v106, v106, v107
  v_add_f32 v110, v110, v111
  v_rcp_f32 v106, v106
  v_rcp_f32 v110, v110
  v_pk_mul_f32 v[48:49], v[48:49], v[106:107] op_sel_hi:[1,0]
  v_pk_mul_f32 v[64:65], v[64:65], v[110:111] op_sel_hi:[1,0]
  v_pk_mul_f32 v[50:51], v[50:51], v[106:107] op_sel_hi:[1,0]
  v_pk_mul_f32 v[66:67], v[66:67], v[110:111] op_sel_hi:[1,0]
  v_pk_mul_f32 v[52:53], v[52:53], v[106:107] op_sel_hi:[1,0]
  v_pk_mul_f32 v[68:69], v[68:69], v[110:111] op_sel_hi:[1,0]
  v_pk_mul_f32 v[54:55], v[54:55], v[106:107] op_sel_hi:[1,0]
  v_pk_mul_f32 v[70:71], v[70:71], v[110:111] op_sel_hi:[1,0]
  v_pk_mul_f32 v[56:57], v[56:57], v[106:107] op_sel_hi:[1,0]
  v_pk_mul_f32 v[72:73], v[72:73], v[110:111] op_sel_hi:[1,0]
  v_pk_mul_f32 v[58:59], v[58:59], v[106:107] op_sel_hi:[1,0]
  v_pk_mul_f32 v[74:75], v[74:75], v[110:111] op_sel_hi:[1,0]
  v_pk_mul_f32 v[60:61], v[60:61], v[106:107] op_sel_hi:[1,0]
  v_pk_mul_f32 v[76:77], v[76:77], v[110:111] op_sel_hi:[1,0]
  v_pk_mul_f32 v[62:63], v[62:63], v[106:107] op_sel_hi:[1,0]
  v_pk_mul_f32 v[78:79], v[78:79], v[110:111] op_sel_hi:[1,0]
  v_cvt_pk_bf16_f32 v20, v48, v49
  v_cvt_pk_bf16_f32 v28, v64, v65
  v_cvt_pk_bf16_f32 v21, v50, v51
  v_cvt_pk_bf16_f32 v29, v66, v67
  v_cvt_pk_bf16_f32 v22, v52, v53
  v_cvt_pk_bf16_f32 v30, v68, v69
  v_cvt_pk_bf16_f32 v23, v54, v55
  v_cvt_pk_bf16_f32 v31, v70, v71
  v_cvt_pk_bf16_f32 v24, v56, v57
  v_cvt_pk_bf16_f32 v32, v72, v73
  v_cvt_pk_bf16_f32 v25, v58, v59
  v_cvt_pk_bf16_f32 v33, v74, v75
  v_cvt_pk_bf16_f32 v26, v60, v61
  v_cvt_pk_bf16_f32 v34, v76, v77
  v_cvt_pk_bf16_f32 v27, v62, v63
  v_cvt_pk_bf16_f32 v35, v78, v79
  s_mov_b32 s46, 0
L_h1poll_4:
  s_waitcnt vmcnt(0)
  v_mov_b32 v48, 0
  v_sad_u32 v48, v81, s38, v48
  v_sad_u32 v48, v83, s38, v48
  v_sad_u32 v48, v85, s38, v48
  v_sad_u32 v48, v87, s38, v48
  v_sad_u32 v48, v89, s38, v48
  v_sad_u32 v48, v91, s38, v48
  v_sad_u32 v48, v93, s38, v48
  v_sad_u32 v48, v95, s38, v48
  s_add_u32 s46, s46, 1
  s_cmp_gt_u32 s46, 40000
  s_cbranch_scc1 L_h1done_5
  v_cmp_ne_u32 vcc, 0, v48
  s_nop 4
  s_cbranch_vccz L_h1done_5
  s_sleep 4
  v_add_u32 v117, 0, v116
  buffer_load_dwordx2 v[80:81], v117, s[88:91], 0 offen sc1
  v_add_u32 v117, 9216, v116
  buffer_load_dwordx2 v[82:83], v117, s[88:91], 0 offen sc1
  v_add_u32 v117, 18432, v116
  buffer_load_dwordx2 v[84:85], v117, s[88:91], 0 offen sc1
  v_add_u32 v117, 27648, v116
  buffer_load_dwordx2 v[86:87], v117, s[88:91], 0 offen sc1
  v_add_u32 v117, 36864, v116
  buffer_load_dwordx2 v[88:89], v117, s[88:91], 0 offen sc1
  v_add_u32 v117, 46080, v116
  buffer_load_dwordx2 v[90:91], v117, s[88:91], 0 offen sc1
  v_add_u32 v117, 55296, v116
  buffer_load_dwordx2 v[92:93], v117, s[88:91], 0 offen sc1
  v_add_u32 v117, 64512, v116
  buffer_load_dwordx2 v[94:95], v117, s[88:91], 0 offen sc1
  s_branch L_h1poll_4
L_h1done_5:
  s_mov_b32 s46, 0
  s_mov_b32 s68, 0
L_xtpoll_6:
  v_cmp_ne_u32 vcc, s38, v119
  s_nop 4
  s_cbranch_vccz L_xtdone_7
  s_add_u32 s46, s46, 1
  s_cmp_gt_u32 s46, 40000
  s_cbranch_scc1 L_xtdone_7x
  buffer_load_dwordx2 v[118:119], v250, s[88:91], 0 offen sc1
  s_waitcnt vmcnt(0)
  s_branch L_xtpoll_6
L_xtdone_7:
  v_cmp_ne_u32 vcc, s69, v118
  s_nop 2
  s_cmp_eq_u64 vcc, 0
  s_cselect_b32 s68, 1, 0
L_xtdone_7x:
  v_mov_b32 v60, 0x00003f80
  v_mov_b32 v61, 0x3f800000
  v_mov_b32 v48, 0
  v_mov_b32 v49, 0
  v_dot2c_f32_bf16 v48, v80, v60
  v_dot2c_f32_bf16 v49, v80, v61
  v_dot2c_f32_bf16 v48, v82, v60
  v_dot2c_f32_bf16 v49, v82, v61
  v_dot2c_f32_bf16 v48, v84, v60
  v_dot2c_f32_bf16 v49, v84, v61
  v_dot2c_f32_bf16 v48, v86, v60
  v_dot2c_f32_bf16 v49, v86, v61
  v_dot2c_f32_bf16 v48, v88, v60
  v_dot2c_f32_bf16 v49, v88, v61
  v_dot2c_f32_bf16 v48, v90, v60
  v_dot2c_f32_bf16 v49, v90, v61
  v_dot2c_f32_bf16 v48, v92, v60
  v_dot2c_f32_bf16 v49, v92, v61
  v_dot2c_f32_bf16 v48, v94, v60
  v_dot2c_f32_bf16 v49, v94, v61
  v_lshlrev_b32 v50, 3, v1
  s_lshl_b32 s44, s30, 9
  s_add_u32 s44, s44, 95232
  v_add_u32 v51, s44, v50
  ds_write_b64 v51, v[48:49]
  s_waitcnt lgkmcnt(0)
  s_barrier
  s_cmp_lg_u32 s30, 0
  s_cbranch_scc1 L_h1pub_8
  v_add_u32 v51, 95232, v50
  ds_read_b64 v[52:53], v51 offset:0
  ds_read_b64 v[54:55], v51 offset:512
  ds_read_b64 v[56:57], v51 offset:1024
  ds_read_b64 v[58:59], v51 offset:1536
  s_mul_i32 s44, s34, 9216
  s_mul_i32 s45, s33, 288
  s_add_u32 s44, s44, s45
  s_add_u32 s44, s44, 327680
  v_add_u32 v50, s44, v50
  s_waitcnt lgkmcnt(0)
  v_pk_add_f32 v[52:53], v[52:53], v[54:55]
  v_pk_add_f32 v[56:57], v[56:57], v[58:59]
  v_pk_add_f32 v[52:53], v[52:53], v[56:57]
  v_cvt_pk_bf16_f32 v52, v52, v53
  v_mov_b32 v53, s38
  s_mov_b32 exec_lo, -1
  s_mov_b32 exec_hi, 0xf
  buffer_store_dwordx2 v[52:53], v50, s[88:91], 0 offen sc1
  s_mov_b64 exec, -1
L_h1pub_8:
  v_lshrrev_b32 v48, 7, v0
  v_and_b32 v49, 127, v0
  v_lshlrev_b32 v49, 2, v49
  v_mul_u32_u24 v50, 16896, v48
  v_add_u32 v50, v50, v49
  v_mul_u32_u24 v51, 11088, v48
  v_add3_u32 v51, v51, v49, 0
  v_add_u32 v49, 0, v50
  ds_write2_b32 v49, v160, v161 offset0:0 offset1:132
  v_add_u32 v49, 1056, v50
  ds_write2_b32 v49, v162, v163 offset0:0 offset1:132
  v_add_u32 v49, 2112, v50
  ds_write2_b32 v49, v164, v165 offset0:0 offset1:132
  v_add_u32 v49, 3168, v50
  ds_write2_b32 v49, v166, v167 offset0:0 offset1:132
  v_add_u32 v49, 4224, v50
  ds_write2_b32 v49, v168, v169 offset0:0 offset1:132
  v_add_u32 v49, 5280, v50
  ds_write2_b32 v49, v170, v171 offset0:0 offset1:132
  v_add_u32 v49, 6336, v50
  ds_write2_b32 v49, v172, v173 offset0:0 offset1:132
  v_add_u32 v49, 7392, v50
  ds_write2_b32 v49, v174, v175 offset0:0 offset1:132
  v_add_u32 v49, 8448, v50
  ds_write2_b32 v49, v176, v177 offset0:0 offset1:132
  v_add_u32 v49, 9504, v50
  ds_write2_b32 v49, v178, v179 offset0:0 offset1:132
  v_add_u32 v49, 10560, v50
  ds_write2_b32 v49, v180, v181 offset0:0 offset1:132
  v_add_u32 v49, 11616, v50
  ds_write2_b32 v49, v182, v183 offset0:0 offset1:132
  v_add_u32 v49, 12672, v50
  ds_write2_b32 v49, v184, v185 offset0:0 offset1:132
  v_add_u32 v49, 13728, v50
  ds_write2_b32 v49, v186, v187 offset0:0 offset1:132
  v_add_u32 v49, 14784, v50
  ds_write2_b32 v49, v188, v189 offset0:0 offset1:132
  v_add_u32 v49, 15840, v50
  ds_write2_b32 v49, v190, v191 offset0:0 offset1:132
  v_add_u32 v49, 33792, v51
  ds_write2_b32 v49, v192, v193 offset0:0 offset1:132
  v_add_u32 v49, 34848, v51
  ds_write2_b32 v49, v194, v195 offset0:0 offset1:132
  v_add_u32 v49, 35904, v51
  ds_write2_b32 v49, v196, v197 offset0:0 offset1:132
  v_add_u32 v49, 36960, v51
  ds_write2_b32 v49, v198, v199 offset0:0 offset1:132
  v_add_u32 v49, 38016, v51
  ds_write2_b32 v49, v200, v201 offset0:0 offset1:132
  v_add_u32 v49, 39072, v51
  ds_write2_b32 v49, v202, v203 offset0:0 offset1:132
  v_add_u32 v49, 40128, v51
  ds_write2_b32 v49, v204, v205 offset0:0 offset1:132
  v_add_u32 v49, 41184, v51
  ds_write2_b32 v49, v206, v207 offset0:0 offset1:132
  v_add_u32 v49, 42240, v51
  ds_write2_b32 v49, v208, v209 offset0:0 offset1:132
  v_add_u32 v49, 43296, v51
  ds_write2_b32 v49, v210, v211 offset0:0 offset1:132
  ds_write_b32 v51, v212 offset:44352
  v_lshlrev_b32 v48, 2, v48
  ds_write_b32 v48, v213 offset:56000
  s_waitcnt lgkmcnt(0)
  s_barrier
  v_and_b32 v50, 15, v1
  v_lshrrev_b32 v51, 4, v1
  v_lshlrev_b32 v51, 4, v51
  v_mul_u32_u24 v48, 528, v50
  v_add_u32 v48, v48, v51
  s_mul_i32 s44, s40, 16896
  v_add_u32 v48, s44, v48
  s_lshl_b32 s45, s41, 4
  v_add_u32 v49, s45, v50
  v_min_u32 v49, 20, v49
  v_mul_u32_u24 v49, 528, v49
  v_add_u32 v49, v49, v51
  s_mul_i32 s44, s40, 11088
  s_add_u32 s44, s44, 33792
  v_add_u32 v49, s44, v49
  ds_read_b128 v[52:55], v48 offset:0
  ds_read_b128 v[56:59], v48 offset:8448
  ds_read_b128 v[84:87], v49 offset:0
  ds_read_b128 v[60:63], v48 offset:64
  ds_read_b128 v[64:67], v48 offset:8512
  ds_read_b128 v[88:91], v49 offset:64
  ds_read_b128 v[68:71], v48 offset:128
  ds_read_b128 v[72:75], v48 offset:8576
  ds_read_b128 v[92:95], v49 offset:128
  ds_read_b128 v[76:79], v48 offset:192
  ds_read_b128 v[80:83], v48 offset:8640
  ds_read_b128 v[96:99], v49 offset:192
  s_waitcnt lgkmcnt(9)
  v_mfma_f32_16x16x32_f16 v[104:107], v[52:55], v[84:87], 0
  v_mfma_f32_16x16x32_f16 v[108:111], v[56:59], v[84:87], 0
  ds_read_b128 v[52:55], v48 offset:256
  ds_read_b128 v[56:59], v48 offset:8704
  ds_read_b128 v[84:87], v49 offset:256
  s_waitcnt lgkmcnt(9)
  v_mfma_f32_16x16x32_f16 v[104:107], v[60:63], v[88:91], v[104:107]
  v_mfma_f32_16x16x32_f16 v[108:111], v[64:67], v[88:91], v[108:111]
  ds_read_b128 v[60:63], v48 offset:320
  ds_read_b128 v[64:67], v48 offset:8768
  ds_read_b128 v[88:91], v49 offset:320
  s_waitcnt lgkmcnt(9)
  v_mfma_f32_16x16x32_f16 v[104:107], v[68:71], v[92:95], v[104:107]
  v_mfma_f32_16x16x32_f16 v[108:111], v[72:75], v[92:95], v[108:111]
  ds_read_b128 v[68:71], v48 offset:384
  ds_read_b128 v[72:75], v48 offset:8832
  ds_read_b128 v[92:95], v49 offset:384
  s_waitcnt lgkmcnt(9)
  v_mfma_f32_16x16x32_f16 v[104:107], v[76:79], v[96:99], v[104:107]
  v_mfma_f32_16x16x32_f16 v[108:111], v[80:83], v[96:99], v[108:111]
  ds_read_b128 v[76:79], v48 offset:448
  ds_read_b128 v[80:83], v48 offset:8896
  ds_read_b128 v[96:99], v49 offset:448
  s_waitcnt lgkmcnt(9)
  v_mfma_f32_16x16x32_f16 v[104:107], v[52:55], v[84:87], v[104:107]
  v_mfma_f32_16x16x32_f16 v[108:111], v[56:59], v[84:87], v[108:111]
  s_waitcnt lgkmcnt(6)
  v_mfma_f32_16x16x32_f16 v[104:107], v[60:63], v[88:91], v[104:107]
  v_mfma_f32_16x16x32_f16 v[108:111], v[64:67], v[88:91], v[108:111]
  s_waitcnt lgkmcnt(3)
  v_mfma_f32_16x16x32_f16 v[104:107], v[68:71], v[92:95], v[104:107]
  v_mfma_f32_16x16x32_f16 v[108:111], v[72:75], v[92:95], v[108:111]
  s_waitcnt lgkmcnt(0)
  v_mfma_f32_16x16x32_f16 v[104:107], v[76:79], v[96:99], v[104:107]
  v_mfma_f32_16x16x32_f16 v[108:111], v[80:83], v[96:99], v[108:111]
  s_mul_i32 s44, s34, 9216
  s_add_u32 s44, s44, 327680
  v_lshlrev_b32 v120, 4, v0
  v_add_u32 v120, s44, v120
  v_min_u32 v121, 63, v0
  v_lshlrev_b32 v121, 4, v121
  v_add_u32 v121, s44, v121
  v_add_u32 v121, 8192, v121
  v_add_u32 v122, 4096, v120
  buffer_load_dwordx4 v[72:75], v120, s[88:91], 0 offen sc1
  buffer_load_dwordx4 v[76:79], v122, s[88:91], 0 offen sc1
  buffer_load_dwordx4 v[80:83], v121, s[88:91], 0 offen sc1
  v_and_b32 v48, 15, v1
  s_lshl_b32 s44, s41, 4
  v_add_u32 v48, s44, v48
  v_mov_b32 v49, v48
  v_lshlrev_b32 v50, 1, v48
  v_add_u32 v50, 240, v50
  v_cmp_le_u32 vcc, 8, v48
  s_nop 1
  v_cndmask_b32 v49, v49, v50, vcc
  v_and_b32 v50, 1, v48
  v_lshlrev_b32 v50, 2, v50
  v_bfe_u32 v51, v48, 1, 1
  v_lshlrev_b32 v51, 8, v51
  v_add3_u32 v50, v50, v51, 0
  v_add_u32 v50, 512, v50
  v_cmp_le_u32 vcc, 12, v48
  s_nop 1
  v_cndmask_b32 v49, v49, v50, vcc
  v_lshlrev_b32 v50, 8, v48
  v_add_u32 v50, 1045504, v50
  v_and_b32 v50, 0xfffff, v50
  v_cmp_le_u32 vcc, 16, v48
  s_nop 1
  v_cndmask_b32 v49, v49, v50, vcc
  v_lshrrev_b32 v50, 4, v1
  v_lshl_add_u32 v50, v50, 5, v49
  v_lshlrev_b32 v50, 1, v50
  s_mul_i32 s44, s40, 4112
  s_add_u32 s44, s44, 149504
  v_add_u32 v50, s44, v50
  v_mul_f32 v104, 0x42800000, v104
  v_cvt_f16_f32 v104, v104
  v_mul_f32 v105, 0x42800000, v105
  v_cvt_f16_f32 v105, v105
  v_mul_f32 v106, 0x42800000, v106
  v_cvt_f16_f32 v106, v106
  v_mul_f32 v107, 0x42800000, v107
  v_cvt_f16_f32 v107, v107
  v_mul_f32 v108, 0x42800000, v108
  v_cvt_f16_f32 v108, v108
  v_mul_f32 v109, 0x42800000, v109
  v_cvt_f16_f32 v109, v109
  v_mul_f32 v110, 0x42800000, v110
  v_cvt_f16_f32 v110, v110
  v_mul_f32 v111, 0x42800000, v111
  v_cvt_f16_f32 v111, v111
  v_cmp_gt_u32 vcc, 20, v48
  s_nop 2
  s_and_saveexec_b64 s[46:47], vcc
  ds_write_b16 v50, v104 offset:0
  ds_write_b16 v50, v105 offset:16
  ds_write_b16 v50, v106 offset:32
  ds_write_b16 v50, v107 offset:48
  ds_write_b16 v50, v108 offset:256
  ds_write_b16 v50, v109 offset:272
  ds_write_b16 v50, v110 offset:288
  ds_write_b16 v50, v111 offset:304
  s_mov_b64 exec, s[46:47]
  v_cmp_eq_u32 vcc, 20, v48
  v_lshrrev_b32 v51, 4, v1
  v_cmp_eq_u32 s[48:49], 0, v51
  s_nop 2
  s_and_b64 vcc, vcc, s[48:49]
  s_and_saveexec_b64 s[46:47], vcc
  ds_write_b16 v50, v104
  s_mov_b64 exec, s[46:47]
  v_mov_b32 v48, 56000
  ds_read_b64 v[50:51], v48
  s_waitcnt lgkmcnt(0)
  v_readfirstlane_b32 s64, v50
  v_readfirstlane_b32 s65, v51
  s_barrier
  v_lshrrev_b32 v60, 7, v0
  v_mul_u32_u24 v60, 2560, v60
  v_bfe_u32 v61, v0, 3, 4
  v_mul_u32_u24 v61, 80, v61
  v_and_b32 v62, 7, v0
  v_lshlrev_b32 v62, 3, v62
  v_add3_u32 v60, v60, v61, v62
  v_add_u32 v60, 97280, v60
  v_bfe_u32 v61, v0, 4, 2
  v_mul_u32_u24 v61, 2560, v61
  v_and_b32 v62, 15, v0
  v_lshl_add_u32 v61, v62, 2, v61
  v_add_u32 v61, 98560, v61
  v_mul_u32_u24 v62, 80, v3
  v_lshl_add_u32 v62, v2, 5, v62
  s_mul_i32 s45, s41, 5120
  s_add_u32 s45, s45, 97280
  v_add_u32 v62, s45, v62
  s_lshl_b32 s45, s33, 1
  s_add_u32 s45, s45, s40
  s_lshl_b32 s52, s45, 4
  s_lshl_b32 s47, s34, 1
  s_add_u32 s52, s52, s47
  s_add_u32 s52, s52, s41
  s_lshl_b32 s45, s45, 15
  s_lshl_b32 s47, s34, 12
  s_add_u32 s45, s45, s47
  s_lshl_b32 s47, s41, 11
  s_add_u32 s45, s45, s47
  s_add_u32 s45, s45, 6291456
  v_lshlrev_b32 v63, 4, v1
  v_add_u32 v63, s45, v63
  s_mov_b32 s46, 0
L_h2poll_9:
  s_waitcnt vmcnt(0)
  v_sad_u32 v123, v73, s38, 0
  v_sad_u32 v123, v75, s38, v123
  v_sad_u32 v123, v77, s38, v123
  v_sad_u32 v123, v79, s38, v123
  v_sad_u32 v123, v81, s38, v123
  v_sad_u32 v123, v83, s38, v123
  s_add_u32 s46, s46, 1
  s_cmp_gt_u32 s46, 40000
  s_cbranch_scc1 L_h2done_10
  v_cmp_ne_u32 vcc, 0, v123
  s_nop 4
  s_cbranch_vccz L_h2done_10
  s_sleep 4
  buffer_load_dwordx4 v[72:75], v120, s[88:91], 0 offen sc1
  buffer_load_dwordx4 v[76:79], v122, s[88:91], 0 offen sc1
  buffer_load_dwordx4 v[80:83], v121, s[88:91], 0 offen sc1
  s_branch L_h2poll_9
L_h2done_10:
  v_mov_b32 v73, v74
  v_mov_b32 v77, v78
  v_lshl_or_b32 v80, v82, 16, v80
  ds_write_b64 v60, v[72:73]
  ds_write_b64 v60, v[76:77] offset:5120
  s_cmp_lg_u32 s30, 0
  s_cbranch_scc1 L_zw_11
  ds_write_b32 v61, v80
  ds_write_b32 v61, v80 offset:320
L_zw_11:
  s_waitcnt lgkmcnt(0)
  s_barrier
  ds_read_b128 v[64:67], v62 offset:0
  ds_read_b128 v[68:71], v62 offset:16
  ds_read_b128 v[72:75], v62 offset:2560
  ds_read_b128 v[76:79], v62 offset:2576
  s_waitcnt lgkmcnt(2)
  v_mfma_f32_32x32x16_bf16 v[88:103], v[64:67], v[20:23], 0
  v_mfma_f32_32x32x16_bf16 v[88:103], v[68:71], v[24:27], v[88:103]
  s_waitcnt lgkmcnt(0)
  v_mfma_f32_32x32x16_bf16 v[104:119], v[72:75], v[28:31], 0
  v_mfma_f32_32x32x16_bf16 v[104:119], v[76:79], v[32:35], v[104:119]
  s_nop 8
  v_add_f32 v96, 0x358637bd, v96
  v_rcp_f32 v96, v96
  s_nop 0
  v_pk_mul_f32 v[88:89], v[88:89], v[96:97] op_sel_hi:[1,0]
  v_pk_mul_f32 v[90:91], v[90:91], v[96:97] op_sel_hi:[1,0]
  v_pk_mul_f32 v[92:93], v[92:93], v[96:97] op_sel_hi:[1,0]
  v_pk_mul_f32 v[94:95], v[94:95], v[96:97] op_sel_hi:[1,0]
  v_cvt_pk_bf16_f32 v48, v88, v89
  v_cvt_pk_bf16_f32 v49, v90, v91
  v_cvt_pk_bf16_f32 v50, v92, v93
  v_cvt_pk_bf16_f32 v51, v94, v95
  v_add_f32 v112, 0x358637bd, v112
  v_rcp_f32 v112, v112
  s_nop 0
  v_pk_mul_f32 v[104:105], v[104:105], v[112:113] op_sel_hi:[1,0]
  v_pk_mul_f32 v[106:107], v[106:107], v[112:113] op_sel_hi:[1,0]
  v_pk_mul_f32 v[108:109], v[108:109], v[112:113] op_sel_hi:[1,0]
  v_pk_mul_f32 v[110:111], v[110:111], v[112:113] op_sel_hi:[1,0]
  v_cvt_pk_bf16_f32 v52, v104, v105
  v_cvt_pk_bf16_f32 v53, v106, v107
  v_cvt_pk_bf16_f32 v54, v108, v109
  v_cvt_pk_bf16_f32 v55, v110, v111
  s_cmp_eq_u32 s68, 1
  s_cbranch_scc1 L_ofast_12
  buffer_store_dwordx4 v[48:51], v63, s[88:91], 0 offen offset:0 sc1
  buffer_store_dwordx4 v[52:55], v63, s[88:91], 0 offen offset:1024 sc1
  s_waitcnt vmcnt(0)
  s_lshl_b32 s44, s52, 4
  s_add_u32 s44, s44, 589824
  v_mov_b32 v126, s44
  v_mov_b32 v127, s38
  s_mov_b64 exec, 1
  buffer_store_dword v127, v126, s[88:91], 0 offen sc1
  s_mov_b64 exec, -1
  s_branch L_oend_13
L_ofast_12:
  buffer_store_dwordx4 v[48:51], v63, s[88:91], 0 offen offset:0
  buffer_store_dwordx4 v[52:55], v63, s[88:91], 0 offen offset:1024
  s_waitcnt vmcnt(0)
  s_lshl_b32 s44, s52, 4
  s_add_u32 s44, s44, 589824
  v_mov_b32 v126, s44
  v_mov_b32 v127, s38
  s_mov_b64 exec, 1
  buffer_store_dword v127, v126, s[88:91], 0 offen
  s_mov_b64 exec, -1
L_oend_13:
  v_lshrrev_b32 v52, 4, v1
  v_lshlrev_b32 v53, 2, v52
  v_and_b32 v54, 15, v1
  v_xor_b32 v53, v53, v54
  v_lshlrev_b32 v53, 4, v53
  s_lshl_b32 s44, s30, 2
  v_add_u32 v52, s44, v52
  v_lshl_add_u32 v52, v52, 10, v53
  s_lshl_b32 s44, s36, 8
  v_add_u32 v52, s44, v52
  s_add_u32 m0, s39, 0
  v_add_u32 v53, 0, v52
  global_load_lds_dwordx4 v53, s[10:11]
  s_add_u32 m0, s39, 4096
  v_add_u32 v53, 16384, v52
  global_load_lds_dwordx4 v53, s[10:11]
  s_add_u32 m0, s39, 8192
  v_add_u32 v53, 32768, v52
  global_load_lds_dwordx4 v53, s[10:11]
  s_add_u32 m0, s39, 12288
  v_add_u32 v53, 49152, v52
  global_load_lds_dwordx4 v53, s[10:11]
  s_add_u32 m0, s39, 16384
  v_add_u32 v53, 65536, v52
  global_load_lds_dwordx4 v53, s[10:11]
  s_add_u32 m0, s39, 20480
  v_add_u32 v53, 81920, v52
  global_load_lds_dwordx4 v53, s[10:11]
  s_add_u32 m0, s39, 24576
  v_add_u32 v53, 98304, v52
  global_load_lds_dwordx4 v53, s[10:11]
  s_add_u32 m0, s39, 28672
  v_add_u32 v53, 114688, v52
  global_load_lds_dwordx4 v53, s[10:11]
  s_add_u32 m0, s39, 32768
  v_add_u32 v53, 131072, v52
  global_load_lds_dwordx4 v53, s[10:11]
  s_add_u32 m0, s39, 36864
  v_add_u32 v53, 147456, v52
  global_load_lds_dwordx4 v53, s[10:11]
  s_add_u32 m0, s39, 40960
  v_add_u32 v53, 163840, v52
  global_load_lds_dwordx4 v53, s[10:11]
  s_add_u32 m0, s39, 45056
  v_add_u32 v53, 180224, v52
  global_load_lds_dwordx4 v53, s[10:11]
  s_add_u32 m0, s39, 49152
  v_add_u32 v53, 196608, v52
  global_load_lds_dwordx4 v53, s[10:11]
  s_add_u32 m0, s39, 53248
  v_add_u32 v53, 212992, v52
  global_load_lds_dwordx4 v53, s[10:11]
  s_add_u32 m0, s39, 57344
  v_add_u32 v53, 229376, v52
  global_load_lds_dwordx4 v53, s[10:11]
  s_add_u32 m0, s39, 61440
  v_add_u32 v53, 245760, v52
  global_load_lds_dwordx4 v53, s[10:11]
  s_lshl_b32 s53, s35, 4
  s_lshl_b32 s48, s35, 15
  s_add_u32 s48, s48, s39
  s_add_u32 s48, s48, 6291456
  v_lshlrev_b32 v50, 4, v1
  v_add_u32 v48, s48, v50
  v_add_u32 v50, 108544, v50
  v_mul_u32_u24 v52, 72, v3
  v_lshl_add_u32 v52, v2, 3, v52
  s_mul_i32 s44, s30, 2304
  s_add_u32 s44, s44, 65536
  v_add_u32 v52, s44, v52
  v_lshrrev_b32 v88, 4, v1
  v_bfe_u32 v53, v1, 2, 2
  v_lshl_add_u32 v53, v88, 3, v53
  v_mul_u32_u24 v53, 72, v53
  v_and_b32 v89, 3, v1
  v_lshl_add_u32 v53, v89, 3, v53
  v_add_u32 v53, s44, v53
  s_lshl_b32 s44, s36, 7
  s_lshl_b32 s45, s30, 5
  s_add_u32 s44, s44, s45
  s_lshl_b32 s44, s44, 12
  s_lshl_b32 s45, s35, 6
  s_add_u32 s44, s44, s45
  s_add_u32 s44, s44, 10485760
  v_and_b32 v54, 15, v1
  v_lshlrev_b32 v54, 12, v54
  v_lshl_add_u32 v54, v88, 4, v54
  v_add_u32 v54, s44, v54
  s_lshl_b32 s44, s35, 7
  s_add_u32 s44, s44, 262144
  v_lshlrev_b32 v55, 2, v3
  v_lshl_add_u32 v55, v2, 13, v55
  v_add_u32 v55, s44, v55
  v_bfe_u32 v115, v1, 2, 2
  v_lshl_add_u32 v112, v2, 2, v115
  v_lshlrev_b32 v112, 8, v112
  v_lshlrev_b32 v115, 2, v115
  v_bfe_u32 v116, v1, 4, 1
  v_lshlrev_b32 v116, 1, v116
  v_bfe_u32 v117, v1, 1, 1
  s_lshl_b32 s44, s30, 2
  v_add3_u32 v116, v116, v117, s44
  v_xor_b32 v116, v116, v115
  v_lshl_add_u32 v112, v116, 4, v112
  v_and_b32 v116, 1, v1
  v_lshl_add_u32 v112, v116, 3, v112
  v_add_u32 v113, 65536, v112
  v_add_u32 v114, 108544, v112
  ds_read_b64_tr_b16 v[192:193], v113 offset:0
  ds_read_b64_tr_b16 v[194:195], v113 offset:2048
  ds_read_b64_tr_b16 v[196:197], v113 offset:4096
  ds_read_b64_tr_b16 v[198:199], v113 offset:6144
  ds_read_b64_tr_b16 v[200:201], v113 offset:8192
  ds_read_b64_tr_b16 v[202:203], v113 offset:10240
  ds_read_b64_tr_b16 v[204:205], v113 offset:12288
  ds_read_b64_tr_b16 v[206:207], v113 offset:14336
  ds_read_b64_tr_b16 v[208:209], v113 offset:16384
  ds_read_b64_tr_b16 v[210:211], v113 offset:18432
  ds_read_b64_tr_b16 v[212:213], v113 offset:20480
  ds_read_b64_tr_b16 v[214:215], v113 offset:22528
  ds_read_b64_tr_b16 v[216:217], v114 offset:0
  ds_read_b64_tr_b16 v[218:219], v114 offset:2048
  ds_read_b64_tr_b16 v[220:221], v114 offset:4096
  ds_read_b64_tr_b16 v[222:223], v114 offset:6144
  ds_read_b64_tr_b16 v[224:225], v114 offset:8192
  ds_read_b64_tr_b16 v[226:227], v114 offset:10240
  ds_read_b64_tr_b16 v[228:229], v114 offset:12288
  ds_read_b64_tr_b16 v[230:231], v114 offset:14336
  ds_read_b64_tr_b16 v[232:233], v114 offset:16384
  ds_read_b64_tr_b16 v[234:235], v114 offset:18432
  ds_read_b64_tr_b16 v[236:237], v114 offset:20480
  ds_read_b64_tr_b16 v[238:239], v114 offset:22528
  ds_read_b64_tr_b16 v[240:241], v114 offset:24576
  ds_read_b64_tr_b16 v[242:243], v114 offset:26624
  ds_read_b64_tr_b16 v[244:245], v114 offset:28672
  ds_read_b64_tr_b16 v[246:247], v114 offset:30720
  ds_read_b64_tr_b16 v[248:249], v114 offset:32768
  ds_read_b64_tr_b16 v[250:251], v114 offset:34816
  ds_read_b64_tr_b16 v[252:253], v114 offset:36864
  ds_read_b64_tr_b16 v[254:255], v114 offset:38912
  s_waitcnt lgkmcnt(0)
  s_cmp_lg_u32 s30, 0
  s_cbranch_scc1 L_wait_14
  v_and_b32 v126, 15, v1
  v_lshlrev_b32 v126, 4, v126
  s_lshl_b32 s44, s53, 4
  s_add_u32 s44, s44, 589824
  v_add_u32 v126, s44, v126
  s_mov_b32 s45, 0
  s_waitcnt vmcnt(0)
L_poll_15:
  buffer_load_dword v127, v126, s[88:91], 0 offen sc1
  s_add_u32 s45, s45, 1
  s_cmp_gt_u32 s45, 40000
  s_cbranch_scc1 L_pdone_16
  s_waitcnt vmcnt(0)
  v_cmp_ne_u32 vcc, s38, v127
  s_nop 4
  s_cbranch_vccz L_pdone_16
  s_sleep 4
  s_branch L_poll_15
L_pdone_16:
  s_waitcnt vmcnt(0)
L_wait_14:
  s_barrier
  s_add_u32 m0, s39, 124928
  v_add_u32 v49, 16384, v48
  buffer_load_dwordx4 v49, s[88:91], 0 offen sc1 lds
  s_add_u32 m0, s39, 129024
  v_add_u32 v49, 20480, v48
  buffer_load_dwordx4 v49, s[88:91], 0 offen sc1 lds
  s_add_u32 m0, s39, 133120
  v_add_u32 v49, 24576, v48
  buffer_load_dwordx4 v49, s[88:91], 0 offen sc1 lds
  s_add_u32 m0, s39, 137216
  v_add_u32 v49, 28672, v48
  buffer_load_dwordx4 v49, s[88:91], 0 offen sc1 lds
  s_add_u32 m0, s39, 108544
  v_add_u32 v49, 0, v48
  buffer_load_dwordx4 v49, s[88:91], 0 offen sc1 lds
  s_add_u32 m0, s39, 112640
  v_add_u32 v49, 4096, v48
  buffer_load_dwordx4 v49, s[88:91], 0 offen sc1 lds
  s_add_u32 m0, s39, 116736
  v_add_u32 v49, 8192, v48
  buffer_load_dwordx4 v49, s[88:91], 0 offen sc1 lds
  s_add_u32 m0, s39, 120832
  v_add_u32 v49, 12288, v48
  buffer_load_dwordx4 v49, s[88:91], 0 offen sc1 lds
  s_waitcnt vmcnt(6)
  s_barrier
  ds_read_b128 v[56:59], v50 offset:16384
  ds_read_b128 v[60:63], v50 offset:17408
  ds_read_b128 v[64:67], v50 offset:18432
  ds_read_b128 v[68:71], v50 offset:19456
  s_waitcnt lgkmcnt(3)
  v_mfma_f32_32x32x16_bf16 v[72:87], v[192:195], v[56:59], 0
  ds_read_b128 v[56:59], v50 offset:20480
  s_waitcnt lgkmcnt(3)
  v_mfma_f32_32x32x16_bf16 v[72:87], v[196:199], v[60:63], v[72:87]
  ds_read_b128 v[60:63], v50 offset:21504
  s_waitcnt lgkmcnt(3)
  v_mfma_f32_32x32x16_bf16 v[72:87], v[200:203], v[64:67], v[72:87]
  ds_read_b128 v[64:67], v50 offset:22528
  s_waitcnt lgkmcnt(3)
  v_mfma_f32_32x32x16_bf16 v[72:87], v[204:207], v[68:71], v[72:87]
  ds_read_b128 v[68:71], v50 offset:23552
  s_waitcnt lgkmcnt(3)
  v_mfma_f32_32x32x16_bf16 v[72:87], v[208:211], v[56:59], v[72:87]
  s_waitcnt vmcnt(4)
  s_barrier
  ds_read_b128 v[56:59], v50 offset:24576
  s_waitcnt lgkmcnt(3)
  v_mfma_f32_32x32x16_bf16 v[72:87], v[212:215], v[60:63], v[72:87]
  ds_read_b128 v[60:63], v50 offset:25600
  ds_read_b64_tr_b16 v[128:129], v112 offset:0
  ds_read_b64_tr_b16 v[130:131], v112 offset:2048
  ds_read_b64_tr_b16 v[132:133], v112 offset:4096
  ds_read_b64_tr_b16 v[134:135], v112 offset:6144
  s_waitcnt lgkmcnt(7)
  v_mfma_f32_32x32x16_bf16 v[72:87], v[216:219], v[64:67], v[72:87]
  ds_read_b128 v[64:67], v50 offset:26624
  ds_read_b64_tr_b16 v[136:137], v112 offset:8192
  ds_read_b64_tr_b16 v[138:139], v112 offset:10240
  ds_read_b64_tr_b16 v[140:141], v112 offset:12288
  ds_read_b64_tr_b16 v[142:143], v112 offset:14336
  s_waitcnt lgkmcnt(11)
  v_mfma_f32_32x32x16_bf16 v[72:87], v[220:223], v[68:71], v[72:87]
  ds_read_b128 v[68:71], v50 offset:27648
  ds_read_b64_tr_b16 v[144:145], v112 offset:16384
  ds_read_b64_tr_b16 v[146:147], v112 offset:18432
  ds_read_b64_tr_b16 v[148:149], v112 offset:20480
  ds_read_b64_tr_b16 v[150:151], v112 offset:22528
  s_waitcnt lgkmcnt(15)
  v_mfma_f32_32x32x16_bf16 v[72:87], v[224:227], v[56:59], v[72:87]
  ds_read_b128 v[56:59], v50 offset:28672
  ds_read_b64_tr_b16 v[152:153], v112 offset:24576
  ds_read_b64_tr_b16 v[154:155], v112 offset:26624
  ds_read_b64_tr_b16 v[156:157], v112 offset:28672
  ds_read_b64_tr_b16 v[158:159], v112 offset:30720
  s_waitcnt lgkmcnt(15)
  v_mfma_f32_32x32x16_bf16 v[72:87], v[228:231], v[60:63], v[72:87]
  ds_read_b128 v[60:63], v50 offset:29696
  ds_read_b64_tr_b16 v[160:161], v112 offset:32768
  ds_read_b64_tr_b16 v[162:163], v112 offset:34816
  ds_read_b64_tr_b16 v[164:165], v112 offset:36864
  ds_read_b64_tr_b16 v[166:167], v112 offset:38912
  s_waitcnt lgkmcnt(15)
  v_mfma_f32_32x32x16_bf16 v[72:87], v[232:235], v[64:67], v[72:87]
  ds_read_b128 v[64:67], v50 offset:30720
  ds_read_b64_tr_b16 v[168:169], v112 offset:40960
  ds_read_b64_tr_b16 v[170:171], v112 offset:43008
  ds_read_b64_tr_b16 v[172:173], v112 offset:45056
  ds_read_b64_tr_b16 v[174:175], v112 offset:47104
  s_waitcnt lgkmcnt(15)
  v_mfma_f32_32x32x16_bf16 v[72:87], v[236:239], v[68:71], v[72:87]
  ds_read_b128 v[68:71], v50 offset:31744
  ds_read_b64_tr_b16 v[176:177], v112 offset:49152
  ds_read_b64_tr_b16 v[178:179], v112 offset:51200
  ds_read_b64_tr_b16 v[180:181], v112 offset:53248
  ds_read_b64_tr_b16 v[182:183], v112 offset:55296
  s_waitcnt lgkmcnt(15)
  v_mfma_f32_32x32x16_bf16 v[72:87], v[240:243], v[56:59], v[72:87]
  s_waitcnt vmcnt(2)
  s_barrier
  ds_read_b128 v[56:59], v50 offset:0
  ds_read_b64_tr_b16 v[184:185], v112 offset:57344
  ds_read_b64_tr_b16 v[186:187], v112 offset:59392
  ds_read_b64_tr_b16 v[188:189], v112 offset:61440
  ds_read_b64_tr_b16 v[190:191], v112 offset:63488
  s_waitcnt lgkmcnt(15)
  v_mfma_f32_32x32x16_bf16 v[72:87], v[244:247], v[60:63], v[72:87]
  ds_read_b128 v[60:63], v50 offset:1024
  s_waitcnt lgkmcnt(15)
  v_mfma_f32_32x32x16_bf16 v[72:87], v[248:251], v[64:67], v[72:87]
  ds_read_b128 v[64:67], v50 offset:2048
  s_waitcnt lgkmcnt(11)
  v_mfma_f32_32x32x16_bf16 v[72:87], v[252:255], v[68:71], v[72:87]
  ds_read_b128 v[68:71], v50 offset:3072
  s_waitcnt lgkmcnt(7)
  s_waitcnt lgkmcnt(3)
  v_mfma_f32_32x32x16_bf16 v[72:87], v[128:131], v[56:59], v[72:87]
  ds_read_b128 v[56:59], v50 offset:4096
  s_waitcnt lgkmcnt(3)
  v_mfma_f32_32x32x16_bf16 v[72:87], v[132:135], v[60:63], v[72:87]
  ds_read_b128 v[60:63], v50 offset:5120
  s_waitcnt lgkmcnt(3)
  v_mfma_f32_32x32x16_bf16 v[72:87], v[136:139], v[64:67], v[72:87]
  ds_read_b128 v[64:67], v50 offset:6144
  s_waitcnt lgkmcnt(3)
  v_mfma_f32_32x32x16_bf16 v[72:87], v[140:143], v[68:71], v[72:87]
  ds_read_b128 v[68:71], v50 offset:7168
  s_waitcnt lgkmcnt(3)
  v_mfma_f32_32x32x16_bf16 v[72:87], v[144:147], v[56:59], v[72:87]
  s_waitcnt vmcnt(0)
  s_barrier
  ds_read_b128 v[56:59], v50 offset:8192
  s_waitcnt lgkmcnt(3)
  v_mfma_f32_32x32x16_bf16 v[72:87], v[148:151], v[60:63], v[72:87]
  ds_read_b128 v[60:63], v50 offset:9216
  s_waitcnt lgkmcnt(3)
  v_mfma_f32_32x32x16_bf16 v[72:87], v[152:155], v[64:67], v[72:87]
  ds_read_b128 v[64:67], v50 offset:10240
  s_waitcnt lgkmcnt(3)
  v_mfma_f32_32x32x16_bf16 v[72:87], v[156:159], v[68:71], v[72:87]
  ds_read_b128 v[68:71], v50 offset:11264
  s_waitcnt lgkmcnt(3)
  v_mfma_f32_32x32x16_bf16 v[72:87], v[160:163], v[56:59], v[72:87]
  ds_read_b128 v[56:59], v50 offset:12288
  s_waitcnt lgkmcnt(3)
  v_mfma_f32_32x32x16_bf16 v[72:87], v[164:167], v[60:63], v[72:87]
  ds_read_b128 v[60:63], v50 offset:13312
  s_waitcnt lgkmcnt(3)
  v_mfma_f32_32x32x16_bf16 v[72:87], v[168:171], v[64:67], v[72:87]
  ds_read_b128 v[64:67], v50 offset:14336
  s_waitcnt lgkmcnt(3)
  v_mfma_f32_32x32x16_bf16 v[72:87], v[172:175], v[68:71], v[72:87]
  ds_read_b128 v[68:71], v50 offset:15360
  s_waitcnt lgkmcnt(3)
  v_mfma_f32_32x32x16_bf16 v[72:87], v[176:179], v[56:59], v[72:87]
  s_waitcnt lgkmcnt(2)
  v_mfma_f32_32x32x16_bf16 v[72:87], v[180:183], v[60:63], v[72:87]
  s_waitcnt lgkmcnt(1)
  v_mfma_f32_32x32x16_bf16 v[72:87], v[184:187], v[64:67], v[72:87]
  s_waitcnt lgkmcnt(0)
  v_mfma_f32_32x32x16_bf16 v[72:87], v[188:191], v[68:71], v[72:87]
  v_mov_b32 v116, 0
  v_mov_b32 v117, 0
  v_mov_b32 v118, 0x3f803f80
  v_lshlrev_b32 v96, 16, v12
  v_and_b32 v97, 0xffff0000, v12
  s_nop 6
  v_pk_add_f32 v[72:73], v[72:73], v[96:97]
  v_cvt_pk_bf16_f32 v88, v72, v73
  v_lshlrev_b32 v98, 16, v13
  v_and_b32 v99, 0xffff0000, v13
  v_pk_add_f32 v[74:75], v[74:75], v[98:99]
  v_cvt_pk_bf16_f32 v89, v74, v75
  ds_write_b64 v52, v[88:89] offset:0
  v_lshlrev_b32 v96, 16, v14
  v_and_b32 v97, 0xffff0000, v14
  v_pk_add_f32 v[76:77], v[76:77], v[96:97]
  v_cvt_pk_bf16_f32 v90, v76, v77
  v_lshlrev_b32 v98, 16, v15
  v_and_b32 v99, 0xffff0000, v15
  v_pk_add_f32 v[78:79], v[78:79], v[98:99]
  v_cvt_pk_bf16_f32 v91, v78, v79
  ds_write_b64 v52, v[90:91] offset:16
  v_lshlrev_b32 v96, 16, v16
  v_and_b32 v97, 0xffff0000, v16
  v_pk_add_f32 v[80:81], v[80:81], v[96:97]
  v_cvt_pk_bf16_f32 v92, v80, v81
  v_lshlrev_b32 v98, 16, v17
  v_and_b32 v99, 0xffff0000, v17
  v_pk_add_f32 v[82:83], v[82:83], v[98:99]
  v_cvt_pk_bf16_f32 v93, v82, v83
  ds_write_b64 v52, v[92:93] offset:32
  v_lshlrev_b32 v96, 16, v18
  v_and_b32 v97, 0xffff0000, v18
  v_pk_add_f32 v[84:85], v[84:85], v[96:97]
  v_cvt_pk_bf16_f32 v94, v84, v85
  v_lshlrev_b32 v98, 16, v19
  v_and_b32 v99, 0xffff0000, v19
  v_pk_add_f32 v[86:87], v[86:87], v[98:99]
  v_cvt_pk_bf16_f32 v95, v86, v87
  ds_write_b64 v52, v[94:95] offset:48
  v_dot2c_f32_bf16 v116, v88, v118
  v_dot2c_f32_bf16 v117, v88, v88
  v_dot2c_f32_bf16 v116, v89, v118
  v_dot2c_f32_bf16 v117, v89, v89
  v_dot2c_f32_bf16 v116, v90, v118
  v_dot2c_f32_bf16 v117, v90, v90
  v_dot2c_f32_bf16 v116, v91, v118
  v_dot2c_f32_bf16 v117, v91, v91
  v_dot2c_f32_bf16 v116, v92, v118
  v_dot2c_f32_bf16 v117, v92, v92
  v_dot2c_f32_bf16 v116, v93, v118
  v_dot2c_f32_bf16 v117, v93, v93
  v_dot2c_f32_bf16 v116, v94, v118
  v_dot2c_f32_bf16 v117, v94, v94
  v_dot2c_f32_bf16 v116, v95, v118
  v_dot2c_f32_bf16 v117, v95, v95
  s_nop 1
  v_mov_b32 v96, v116
  v_mov_b32 v97, v117
  s_nop 0
  v_permlane32_swap_b32 v116, v96
  v_permlane32_swap_b32 v117, v97
  v_add_f32 v116, v116, v96
  v_add_f32 v117, v117, v97
  v_cmp_eq_u32 vcc, 0, v2
  s_nop 1
  v_cndmask_b32 v116, v117, v116, vcc
  v_lshlrev_b32 v96, 2, v1
  s_lshl_b32 s44, s30, 8
  s_add_u32 s44, s44, 95232
  v_add_u32 v97, s44, v96
  ds_write_b32 v97, v116
  ds_read_b64_tr_b16 v[104:105], v53 offset:0
  ds_read_b64_tr_b16 v[106:107], v53 offset:288
  ds_read_b64_tr_b16 v[108:109], v53 offset:32
  ds_read_b64_tr_b16 v[110:111], v53 offset:320
  v_add_u32 v48, 65536, v54
  s_waitcnt lgkmcnt(4)
  s_barrier
  s_cmp_lg_u32 s30, 0
  s_cbranch_scc1 L_at_17
  v_add_u32 v96, 95232, v96
  ds_read_b32 v98, v96 offset:0
  ds_read_b32 v99, v96 offset:256
  ds_read_b32 v100, v96 offset:512
  ds_read_b32 v101, v96 offset:768
  s_waitcnt lgkmcnt(0)
  v_add_f32 v98, v98, v99
  v_add_f32 v100, v100, v101
  v_add_f32 v98, v98, v100
  buffer_atomic_add_f32 v98, v55, s[88:91], 0 offen
L_at_17:
  s_waitcnt lgkmcnt(0)
  buffer_store_dwordx4 v[104:107], v54, s[88:91], 0 offen sc1
  buffer_store_dwordx4 v[108:111], v48, s[88:91], 0 offen sc1
  s_waitcnt vmcnt(0)
  s_barrier
  s_cmp_lg_u32 s30, 0
  s_cbranch_scc1 L_sig_18
  s_lshl_b32 s44, s42, 4
  s_add_u32 s44, s44, 655360
  v_mov_b32 v126, s44
  v_mov_b32 v127, s38
  s_mov_b64 exec, 1
  buffer_store_dword v127, v126, s[88:91], 0 offen sc1
  s_mov_b64 exec, -1
L_sig_18:
  v_lshlrev_b32 v48, 3, v0
  v_subrev_u32 v48, 4, v48
  v_max_i32 v48, 0, v48
  v_cvt_f32_u32 v48, v48
  v_cvt_pk_bf16_f32 v48, v48, v48
  v_lshlrev_b32 v48, 16, v48
  v_cvt_u32_f32 v48, v48
  v_lshlrev_b32 v56, 1, v48
  v_add_u32 v56, 149504, v56
  v_lshlrev_b32 v48, 3, v0
  v_subrev_u32 v48, 3, v48
  v_max_i32 v48, 0, v48
  v_cvt_f32_u32 v48, v48
  v_cvt_pk_bf16_f32 v48, v48, v48
  v_lshlrev_b32 v48, 16, v48
  v_cvt_u32_f32 v48, v48
  v_lshlrev_b32 v57, 1, v48
  v_add_u32 v57, 149504, v57
  v_lshlrev_b32 v48, 3, v0
  v_subrev_u32 v48, 2, v48
  v_max_i32 v48, 0, v48
  v_cvt_f32_u32 v48, v48
  v_cvt_pk_bf16_f32 v48, v48, v48
  v_lshlrev_b32 v48, 16, v48
  v_cvt_u32_f32 v48, v48
  v_lshlrev_b32 v58, 1, v48
  v_add_u32 v58, 149504, v58
  v_lshlrev_b32 v48, 3, v0
  v_subrev_u32 v48, 1, v48
  v_max_i32 v48, 0, v48
  v_cvt_f32_u32 v48, v48
  v_cvt_pk_bf16_f32 v48, v48, v48
  v_lshlrev_b32 v48, 16, v48
  v_cvt_u32_f32 v48, v48
  v_lshlrev_b32 v59, 1, v48
  v_add_u32 v59, 149504, v59
  v_lshlrev_b32 v48, 3, v0
  v_add_u32 v48, 0, v48
  v_max_i32 v48, 0, v48
  v_cvt_f32_u32 v48, v48
  v_cvt_pk_bf16_f32 v48, v48, v48
  v_lshlrev_b32 v48, 16, v48
  v_cvt_u32_f32 v48, v48
  v_lshlrev_b32 v60, 1, v48
  v_add_u32 v60, 149504, v60
  v_lshlrev_b32 v48, 3, v0
  v_add_u32 v48, 1, v48
  v_max_i32 v48, 0, v48
  v_cvt_f32_u32 v48, v48
  v_cvt_pk_bf16_f32 v48, v48, v48
  v_lshlrev_b32 v48, 16, v48
  v_cvt_u32_f32 v48, v48
  v_lshlrev_b32 v61, 1, v48
  v_add_u32 v61, 149504, v61
  v_lshlrev_b32 v48, 3, v0
  v_add_u32 v48, 2, v48
  v_max_i32 v48, 0, v48
  v_cvt_f32_u32 v48, v48
  v_cvt_pk_bf16_f32 v48, v48, v48
  v_lshlrev_b32 v48, 16, v48
  v_cvt_u32_f32 v48, v48
  v_lshlrev_b32 v62, 1, v48
  v_add_u32 v62, 149504, v62
  v_lshlrev_b32 v48, 3, v0
  v_add_u32 v48, 3, v48
  v_max_i32 v48, 0, v48
  v_cvt_f32_u32 v48, v48
  v_cvt_pk_bf16_f32 v48, v48, v48
  v_lshlrev_b32 v48, 16, v48
  v_cvt_u32_f32 v48, v48
  v_lshlrev_b32 v63, 1, v48
  v_add_u32 v63, 149504, v63
  v_lshlrev_b32 v48, 3, v0
  v_add_u32 v48, 4, v48
  v_max_i32 v48, 0, v48
  v_cvt_f32_u32 v48, v48
  v_cvt_pk_bf16_f32 v48, v48, v48
  v_lshlrev_b32 v48, 16, v48
  v_cvt_u32_f32 v48, v48
  v_lshlrev_b32 v64, 1, v48
  v_add_u32 v64, 149504, v64
  v_lshlrev_b32 v48, 3, v0
  v_add_u32 v48, 5, v48
  v_max_i32 v48, 0, v48
  v_cvt_f32_u32 v48, v48
  v_cvt_pk_bf16_f32 v48, v48, v48
  v_lshlrev_b32 v48, 16, v48
  v_cvt_u32_f32 v48, v48
  v_lshlrev_b32 v65, 1, v48
  v_add_u32 v65, 149504, v65
  v_lshlrev_b32 v48, 3, v0
  v_add_u32 v48, 6, v48
  v_max_i32 v48, 0, v48
  v_cvt_f32_u32 v48, v48
  v_cvt_pk_bf16_f32 v48, v48, v48
  v_lshlrev_b32 v48, 16, v48
  v_cvt_u32_f32 v48, v48
  v_lshlrev_b32 v66, 1, v48
  v_add_u32 v66, 149504, v66
  v_lshlrev_b32 v48, 3, v0
  v_add_u32 v48, 7, v48
  v_max_i32 v48, 0, v48
  v_cvt_f32_u32 v48, v48
  v_cvt_pk_bf16_f32 v48, v48, v48
  v_lshlrev_b32 v48, 16, v48
  v_cvt_u32_f32 v48, v48
  v_lshlrev_b32 v67, 1, v48
  v_add_u32 v67, 149504, v67
  ds_read_u16 v72, v56 offset:0
  ds_read_u16 v73, v57 offset:0
  ds_read_u16 v74, v58 offset:0
  ds_read_u16 v75, v59 offset:0
  ds_read_u16 v76, v60 offset:0
  ds_read_u16 v77, v61 offset:0
  ds_read_u16 v78, v62 offset:0
  ds_read_u16 v79, v63 offset:0
  ds_read_u16 v80, v64 offset:0
  ds_read_u16 v81, v65 offset:0
  ds_read_u16 v82, v66 offset:0
  ds_read_u16 v83, v67 offset:0
  ds_read_u16 v84, v56 offset:4112
  ds_read_u16 v85, v57 offset:4112
  ds_read_u16 v86, v58 offset:4112
  ds_read_u16 v87, v59 offset:4112
  ds_read_u16 v88, v60 offset:4112
  ds_read_u16 v89, v61 offset:4112
  ds_read_u16 v90, v62 offset:4112
  ds_read_u16 v91, v63 offset:4112
  ds_read_u16 v92, v64 offset:4112
  ds_read_u16 v93, v65 offset:4112
  ds_read_u16 v94, v66 offset:4112
  ds_read_u16 v95, v67 offset:4112
  s_waitcnt lgkmcnt(0)
  v_lshl_or_b32 v36, v73, 16, v72
  v_lshl_or_b32 v37, v75, 16, v74
  v_lshl_or_b32 v38, v77, 16, v76
  v_lshl_or_b32 v39, v79, 16, v78
  v_lshl_or_b32 v40, v81, 16, v80
  v_lshl_or_b32 v41, v83, 16, v82
  v_lshl_or_b32 v42, v85, 16, v84
  v_lshl_or_b32 v43, v87, 16, v86
  v_lshl_or_b32 v44, v89, 16, v88
  v_lshl_or_b32 v45, v91, 16, v90
  v_lshl_or_b32 v46, v93, 16, v92
  v_lshl_or_b32 v47, v95, 16, v94
  v_cmp_eq_u32 vcc, 0, v0
  v_mov_b32 v119, 0
  s_nop 0
  v_cndmask_b32 v36, v36, v119, vcc
  v_mov_b32 v119, 0
  v_cndmask_b32 v37, v37, v119, vcc
  v_mov_b32 v119, 0
  v_cndmask_b32 v42, v42, v119, vcc
  v_mov_b32 v119, 0
  v_cndmask_b32 v43, v43, v119, vcc
  v_mov_b32 v56, 0
  v_mov_b32 v57, 0
  v_mov_b32 v58, 0
  v_mov_b32 v59, 0
  v_lshrrev_b32 v49, 5, v0
  v_mul_u32_u24 v49, 4608, v49
  v_and_b32 v50, 31, v0
  v_lshl_add_u32 v49, v50, 4, v49
  v_add_u32 v49, 512, v49
  s_cmp_lg_u32 s30, 0
  s_cbranch_scc1 L_up_19
  ds_write_b128 v49, v[56:59]
L_up_19:
  s_lshl_b32 s44, s37, 12
  s_add_u32 s44, s44, 10485760
  v_lshlrev_b32 v112, 4, v0
  v_add_u32 v112, s44, v112
  v_add_u32 v113, 4096, v112
  v_lshlrev_b32 v114, 5, v0
  v_add_u32 v114, 262144, v114
  v_add_u32 v115, 8192, v114
  v_bfe_u32 v50, v1, 2, 2
  v_mul_u32_u24 v24, 4160, v50
  v_lshrrev_b32 v50, 4, v1
  v_lshlrev_b32 v51, 4, v50
  v_sub_u32 v24, v24, v51
  v_and_b32 v52, 3, v1
  v_lshl_add_u32 v24, v52, 3, v24
  s_mul_i32 s44, s40, 16640
  s_lshl_b32 s45, s41, 8
  s_add_u32 s44, s44, s45
  s_add_u32 s44, s44, 108576
  v_add_u32 v24, s44, v24
  v_and_b32 v25, 15, v1
  v_lshlrev_b32 v25, 5, v25
  v_add_u32 v25, v25, v51
  s_mul_i32 s44, s40, 4608
  s_add_u32 s44, s44, 512
  s_lshl_b32 s45, s41, 8
  s_sub_u32 s44, s44, s45
  v_add_u32 v25, s44, v25
  v_lshlrev_b32 v50, 4, v1
  s_lshl_b32 s44, s30, 13
  s_add_u32 s44, s44, 17920
  v_add_u32 v26, s44, v50
  s_lshl_b32 s44, s30, 11
  s_add_u32 s44, s44, 17920
  v_add_u32 v27, s44, v50
  v_and_b32 v50, 15, v1
  v_lshlrev_b32 v50, 4, v50
  v_lshrrev_b32 v51, 4, v1
  v_lshl_add_u32 v50, v51, 2, v50
  s_lshl_b32 s44, s30, 9
  v_add_u32 v50, s44, v50
  v_lshlrev_b32 v28, 1, v50
  s_lshl_b32 s46, s37, 12
  s_add_u32 s46, s46, 14680064
  v_add_u32 v29, s46, v28
  v_add_u32 v30, 4096, v29
  v_mov_b32 v72, 0x3b000000
  v_mov_b32 v73, 0x3b000000
  v_mov_b32 v74, 0x3727c5ac
  v_mov_b32 v75, 0x3727c5ac
  s_waitcnt lgkmcnt(0)
  s_cmp_lg_u32 s30, 0
  s_cbranch_scc1 L_wait_20
  v_lshlrev_b32 v126, 4, v1
  v_add_u32 v126, 655360, v126
  v_add_u32 v125, 1024, v126
  v_add_u32 v124, 2048, v126
  v_add_u32 v123, 3072, v126
  s_mov_b32 s45, 0
  s_waitcnt vmcnt(0)
L_poll_21:
  buffer_load_dword v127, v126, s[88:91], 0 offen sc1
  buffer_load_dword v122, v125, s[88:91], 0 offen sc1
  buffer_load_dword v121, v124, s[88:91], 0 offen sc1
  buffer_load_dword v120, v123, s[88:91], 0 offen sc1
  s_add_u32 s45, s45, 1
  s_cmp_gt_u32 s45, 40000
  s_cbranch_scc1 L_pdone_22
  s_waitcnt vmcnt(0)
  v_sad_u32 v127, v127, s38, 0
  v_sad_u32 v127, v122, s38, v127
  v_sad_u32 v127, v121, s38, v127
  v_sad_u32 v127, v120, s38, v127
  v_cmp_ne_u32 vcc, 0, v127
  s_nop 4
  s_cbranch_vccz L_pdone_22
  s_sleep 4
  s_branch L_poll_21
L_pdone_22:
  s_waitcnt vmcnt(0)
L_wait_20:
  s_barrier
  buffer_load_dwordx4 v[56:59], v114, s[88:91], 0 offen sc1
  buffer_load_dwordx4 v[64:67], v115, s[88:91], 0 offen sc1
  buffer_load_dwordx4 v[60:63], v114, s[88:91], 0 offen offset:16 sc1
  buffer_load_dwordx4 v[68:71], v115, s[88:91], 0 offen offset:16 sc1
  buffer_load_dwordx4 v[48:51], v112, s[88:91], 0 offen sc1
  buffer_load_dwordx4 v[52:55], v113, s[88:91], 0 offen sc1
  v_lshlrev_b32 v96, 4, v0
  v_add_u32 v96, 108576, v96
  ds_write_b128 v96, v[38:41] offset:0
  v_mov_b32 v100, v37
  v_mov_b32 v101, v38
  v_mov_b32 v102, v39
  v_mov_b32 v103, v40
  ds_write_b128 v96, v[100:103] offset:8320
  v_alignbit_b32 v104, v37, v36, 16
  v_alignbit_b32 v105, v38, v37, 16
  v_alignbit_b32 v106, v39, v38, 16
  v_alignbit_b32 v107, v40, v39, 16
  v_alignbit_b32 v108, v41, v40, 16
  ds_write_b128 v96, v[104:107] offset:12480
  v_mov_b32 v110, v105
  v_mov_b32 v111, v106
  v_mov_b32 v112, v107
  v_mov_b32 v113, v108
  ds_write_b128 v96, v[110:113] offset:4160
  ds_write_b128 v96, v[44:47] offset:16640
  v_mov_b32 v100, v43
  v_mov_b32 v101, v44
  v_mov_b32 v102, v45
  v_mov_b32 v103, v46
  ds_write_b128 v96, v[100:103] offset:24960
  v_alignbit_b32 v104, v43, v42, 16
  v_alignbit_b32 v105, v44, v43, 16
  v_alignbit_b32 v106, v45, v44, 16
  v_alignbit_b32 v107, v46, v45, 16
  v_alignbit_b32 v108, v47, v46, 16
  ds_write_b128 v96, v[104:107] offset:29120
  v_mov_b32 v110, v105
  v_mov_b32 v111, v106
  v_mov_b32 v112, v107
  v_mov_b32 v113, v108
  ds_write_b128 v96, v[110:113] offset:20800
  v_mov_b32 v100, 0
  v_mov_b32 v101, 0
  v_mov_b32 v102, 0
  v_mov_b32 v103, 0
  v_lshrrev_b32 v97, 1, v0
  v_mul_u32_u24 v97, 4160, v97
  v_and_b32 v98, 1, v0
  v_lshl_add_u32 v97, v98, 4, v97
  v_add_u32 v97, 108544, v97
  v_cmp_gt_u32 vcc, 16, v0
  s_nop 2
  s_and_saveexec_b64 s[46:47], vcc
  ds_write_b128 v97, v[100:103]
  s_mov_b64 exec, s[46:47]
  s_add_u32 s44, s42, s30
  s_cmp_lg_u32 s44, 0
  s_cbranch_scc1 L_nonce_23
  v_mov_b32 v126, 0
  v_mov_b32 v127, s38
  s_mov_b64 exec, 1
  buffer_store_dword v127, v126, s[88:91], 0 offen sc1
  s_mov_b64 exec, -1
L_nonce_23:
  s_waitcnt vmcnt(4)
  v_pk_mul_f32 v[56:57], v[56:57], v[72:73]
  v_pk_mul_f32 v[58:59], v[58:59], v[72:73]
  v_pk_mul_f32 v[64:65], v[64:65], v[72:73]
  v_pk_mul_f32 v[66:67], v[66:67], v[72:73]
  v_pk_fma_f32 v[64:65], v[56:57], v[56:57], v[64:65] neg_lo:[1,0,0] neg_hi:[1,0,0]
  v_pk_fma_f32 v[66:67], v[58:59], v[58:59], v[66:67] neg_lo:[1,0,0] neg_hi:[1,0,0]
  v_max_f32 v64, 0, v64
  v_max_f32 v66, 0, v66
  v_max_f32 v65, 0, v65
  v_max_f32 v67, 0, v67
  v_cvt_pk_bf16_f32 v76, v56, v57
  v_cvt_pk_bf16_f32 v77, v58, v59
  v_lshlrev_b32 v56, 16, v76
  v_lshlrev_b32 v58, 16, v77
  v_and_b32 v57, 0xffff0000, v76
  v_and_b32 v59, 0xffff0000, v77
  v_cvt_pk_bf16_f32 v76, v64, v65
  v_cvt_pk_bf16_f32 v77, v66, v67
  v_lshlrev_b32 v64, 16, v76
  v_lshlrev_b32 v66, 16, v77
  v_and_b32 v65, 0xffff0000, v76
  v_and_b32 v67, 0xffff0000, v77
  v_pk_add_f32 v[64:65], v[64:65], v[74:75]
  v_pk_add_f32 v[66:67], v[66:67], v[74:75]
  v_cvt_pk_bf16_f32 v76, v64, v65
  v_cvt_pk_bf16_f32 v77, v66, v67
  v_lshlrev_b32 v64, 16, v76
  v_lshlrev_b32 v66, 16, v77
  v_and_b32 v65, 0xffff0000, v76
  v_and_b32 v67, 0xffff0000, v77
  v_sqrt_f32 v64, v64
  v_sqrt_f32 v66, v66
  v_sqrt_f32 v65, v65
  v_sqrt_f32 v67, v67
  v_cvt_pk_bf16_f32 v76, v64, v65
  v_cvt_pk_bf16_f32 v77, v66, v67
  v_lshlrev_b32 v64, 16, v76
  v_lshlrev_b32 v66, 16, v77
  v_and_b32 v65, 0xffff0000, v76
  v_and_b32 v67, 0xffff0000, v77
  v_rcp_f32 v64, v64
  v_rcp_f32 v66, v66
  v_rcp_f32 v65, v65
  v_rcp_f32 v67, v67
  s_waitcnt vmcnt(0)
  v_pk_mul_f32 v[60:61], v[60:61], v[72:73]
  v_pk_mul_f32 v[62:63], v[62:63], v[72:73]
  v_pk_mul_f32 v[68:69], v[68:69], v[72:73]
  v_pk_mul_f32 v[70:71], v[70:71], v[72:73]
  v_pk_fma_f32 v[68:69], v[60:61], v[60:61], v[68:69] neg_lo:[1,0,0] neg_hi:[1,0,0]
  v_pk_fma_f32 v[70:71], v[62:63], v[62:63], v[70:71] neg_lo:[1,0,0] neg_hi:[1,0,0]
  v_max_f32 v68, 0, v68
  v_max_f32 v70, 0, v70
  v_max_f32 v69, 0, v69
  v_max_f32 v71, 0, v71
  v_cvt_pk_bf16_f32 v76, v60, v61
  v_cvt_pk_bf16_f32 v77, v62, v63
  v_lshlrev_b32 v60, 16, v76
  v_lshlrev_b32 v62, 16, v77
  v_and_b32 v61, 0xffff0000, v76
  v_and_b32 v63, 0xffff0000, v77
  v_cvt_pk_bf16_f32 v76, v68, v69
  v_cvt_pk_bf16_f32 v77, v70, v71
  v_lshlrev_b32 v68, 16, v76
  v_lshlrev_b32 v70, 16, v77
  v_and_b32 v69, 0xffff0000, v76
  v_and_b32 v71, 0xffff0000, v77
  v_pk_add_f32 v[68:69], v[68:69], v[74:75]
  v_pk_add_f32 v[70:71], v[70:71], v[74:75]
  v_cvt_pk_bf16_f32 v76, v68, v69
  v_cvt_pk_bf16_f32 v77, v70, v71
  v_lshlrev_b32 v68, 16, v76
  v_lshlrev_b32 v70, 16, v77
  v_and_b32 v69, 0xffff0000, v76
  v_and_b32 v71, 0xffff0000, v77
  v_sqrt_f32 v68, v68
  v_sqrt_f32 v70, v70
  v_sqrt_f32 v69, v69
  v_sqrt_f32 v71, v71
  v_cvt_pk_bf16_f32 v76, v68, v69
  v_cvt_pk_bf16_f32 v77, v70, v71
  v_lshlrev_b32 v68, 16, v76
  v_lshlrev_b32 v70, 16, v77
  v_and_b32 v69, 0xffff0000, v76
  v_and_b32 v71, 0xffff0000, v77
  v_rcp_f32 v68, v68
  v_rcp_f32 v70, v70
  v_rcp_f32 v69, v69
  v_rcp_f32 v71, v71
  s_waitcnt vmcnt(0)
  v_lshlrev_b32 v112, 4, v0
  ds_write_b128 v112, v[48:51] offset:9728
  ds_write_b128 v112, v[52:55] offset:13824
  v_lshlrev_b32 v88, 16, v48
  v_lshlrev_b32 v90, 16, v49
  v_and_b32 v89, 0xffff0000, v48
  v_and_b32 v91, 0xffff0000, v49
  v_pk_add_f32 v[88:89], v[88:89], v[56:57] neg_lo:[0,1] neg_hi:[0,1]
  v_pk_add_f32 v[90:91], v[90:91], v[58:59] neg_lo:[0,1] neg_hi:[0,1]
  v_pk_mul_f32 v[88:89], v[88:89], v[64:65]
  v_pk_mul_f32 v[90:91], v[90:91], v[66:67]
  v_cvt_f16_f32 v88, v88
  v_cvt_f16_f32 v90, v90
  v_cvt_f16_f32 v89, v89
  v_cvt_f16_f32 v91, v91
  v_lshl_or_b32 v80, v89, 16, v88
  v_lshl_or_b32 v81, v91, 16, v90
  v_lshlrev_b32 v88, 16, v50
  v_lshlrev_b32 v90, 16, v51
  v_and_b32 v89, 0xffff0000, v50
  v_and_b32 v91, 0xffff0000, v51
  v_pk_add_f32 v[88:89], v[88:89], v[60:61] neg_lo:[0,1] neg_hi:[0,1]
  v_pk_add_f32 v[90:91], v[90:91], v[62:63] neg_lo:[0,1] neg_hi:[0,1]
  v_pk_mul_f32 v[88:89], v[88:89], v[68:69]
  v_pk_mul_f32 v[90:91], v[90:91], v[70:71]
  v_cvt_f16_f32 v88, v88
  v_cvt_f16_f32 v90, v90
  v_cvt_f16_f32 v89, v89
  v_cvt_f16_f32 v91, v91
  v_lshl_or_b32 v82, v89, 16, v88
  v_lshl_or_b32 v83, v91, 16, v90
  ds_write_b128 v112, v[80:83] offset:1024
  v_lshlrev_b32 v88, 16, v52
  v_lshlrev_b32 v90, 16, v53
  v_and_b32 v89, 0xffff0000, v52
  v_and_b32 v91, 0xffff0000, v53
  v_pk_add_f32 v[88:89], v[88:89], v[56:57] neg_lo:[0,1] neg_hi:[0,1]
  v_pk_add_f32 v[90:91], v[90:91], v[58:59] neg_lo:[0,1] neg_hi:[0,1]
  v_pk_mul_f32 v[88:89], v[88:89], v[64:65]
  v_pk_mul_f32 v[90:91], v[90:91], v[66:67]
  v_cvt_f16_f32 v88, v88
  v_cvt_f16_f32 v90, v90
  v_cvt_f16_f32 v89, v89
  v_cvt_f16_f32 v91, v91
  v_lshl_or_b32 v84, v89, 16, v88
  v_lshl_or_b32 v85, v91, 16, v90
  v_lshlrev_b32 v88, 16, v54
  v_lshlrev_b32 v90, 16, v55
  v_and_b32 v89, 0xffff0000, v54
  v_and_b32 v91, 0xffff0000, v55
  v_pk_add_f32 v[88:89], v[88:89], v[60:61] neg_lo:[0,1] neg_hi:[0,1]
  v_pk_add_f32 v[90:91], v[90:91], v[62:63] neg_lo:[0,1] neg_hi:[0,1]
  v_pk_mul_f32 v[88:89], v[88:89], v[68:69]
  v_pk_mul_f32 v[90:91], v[90:91], v[70:71]
  v_cvt_f16_f32 v88, v88
  v_cvt_f16_f32 v90, v90
  v_cvt_f16_f32 v89, v89
  v_cvt_f16_f32 v91, v91
  v_lshl_or_b32 v86, v89, 16, v88
  v_lshl_or_b32 v87, v91, 16, v90
  ds_write_b128 v112, v[84:87] offset:5632
  s_waitcnt lgkmcnt(0)
  s_barrier
  ds_read_b64_tr_b16 v[12:13], v24 offset:32
  ds_read_b64_tr_b16 v[14:15], v24 offset:24
  ds_read_b128 v[108:111], v25 offset:4064
  ds_read_b128 v[104:107], v25 offset:3552
  ds_read_b128 v[100:103], v25 offset:3040
  ds_read_b128 v[96:99], v25 offset:2528
  ds_read_b128 v[92:95], v25 offset:2016
  ds_read_b128 v[88:91], v25 offset:1504
  ds_read_b128 v[84:87], v25 offset:992
  ds_read_b128 v[80:83], v25 offset:480
  ds_read_b64_tr_b16 v[16:17], v24 offset:544
  ds_read_b64_tr_b16 v[18:19], v24 offset:536
  ds_read_b64_tr_b16 v[20:21], v24 offset:1056
  ds_read_b64_tr_b16 v[22:23], v24 offset:1048
  ds_read_b64_tr_b16 v[112:113], v24 offset:1568
  ds_read_b64_tr_b16 v[114:115], v24 offset:1560
  ds_read_b64_tr_b16 v[116:117], v24 offset:2080
  ds_read_b64_tr_b16 v[118:119], v24 offset:2072
  s_waitcnt lgkmcnt(15)
  v_mfma_f32_16x16x32_f16 v[76:79], v[12:15], v[108:111], 0
  ds_read_b128 v[108:111], v25 offset:4000
  s_waitcnt lgkmcnt(15)
  v_mfma_f32_16x16x32_f16 v[72:75], v[12:15], v[104:107], 0
  s_waitcnt lgkmcnt(14)
  v_mfma_f32_16x16x32_f16 v[68:71], v[12:15], v[100:103], 0
  s_waitcnt lgkmcnt(13)
  v_mfma_f32_16x16x32_f16 v[64:67], v[12:15], v[96:99], 0
  s_waitcnt lgkmcnt(12)
  v_mfma_f32_16x16x32_f16 v[60:63], v[12:15], v[92:95], 0
  s_waitcnt lgkmcnt(11)
  v_mfma_f32_16x16x32_f16 v[56:59], v[12:15], v[88:91], 0
  s_waitcnt lgkmcnt(10)
  v_mfma_f32_16x16x32_f16 v[52:55], v[12:15], v[84:87], 0
  s_waitcnt lgkmcnt(9)
  v_mfma_f32_16x16x32_f16 v[48:51], v[12:15], v[80:83], 0
  ds_read_b64_tr_b16 v[12:13], v24 offset:2592
  ds_read_b64_tr_b16 v[14:15], v24 offset:2584
  s_waitcnt lgkmcnt(9)
  v_mfma_f32_16x16x32_f16 v[76:79], v[16:19], v[104:107], v[76:79]
  ds_read_b128 v[104:107], v25 offset:3488
  v_mfma_f32_16x16x32_f16 v[72:75], v[16:19], v[100:103], v[72:75]
  v_mfma_f32_16x16x32_f16 v[68:71], v[16:19], v[96:99], v[68:71]
  v_mfma_f32_16x16x32_f16 v[64:67], v[16:19], v[92:95], v[64:67]
  v_mfma_f32_16x16x32_f16 v[60:63], v[16:19], v[88:91], v[60:63]
  v_mfma_f32_16x16x32_f16 v[56:59], v[16:19], v[84:87], v[56:59]
  v_mfma_f32_16x16x32_f16 v[52:55], v[16:19], v[80:83], v[52:55]
  ds_read_b64_tr_b16 v[16:17], v24 offset:3104
  ds_read_b64_tr_b16 v[18:19], v24 offset:3096
  s_waitcnt lgkmcnt(10)
  v_mfma_f32_16x16x32_f16 v[76:79], v[20:23], v[100:103], v[76:79]
  ds_read_b128 v[100:103], v25 offset:2976
  v_mfma_f32_16x16x32_f16 v[72:75], v[20:23], v[96:99], v[72:75]
  v_mfma_f32_16x16x32_f16 v[68:71], v[20:23], v[92:95], v[68:71]
  v_mfma_f32_16x16x32_f16 v[64:67], v[20:23], v[88:91], v[64:67]
  v_mfma_f32_16x16x32_f16 v[60:63], v[20:23], v[84:87], v[60:63]
  v_mfma_f32_16x16x32_f16 v[56:59], v[20:23], v[80:83], v[56:59]
  ds_read_b64_tr_b16 v[20:21], v24 offset:3616
  ds_read_b64_tr_b16 v[22:23], v24 offset:3608
  s_waitcnt lgkmcnt(11)
  v_mfma_f32_16x16x32_f16 v[76:79], v[112:115], v[96:99], v[76:79]
  ds_read_b128 v[96:99], v25 offset:2464
  v_mfma_f32_16x16x32_f16 v[72:75], v[112:115], v[92:95], v[72:75]
  v_mfma_f32_16x16x32_f16 v[68:71], v[112:115], v[88:91], v[68:71]
  v_mfma_f32_16x16x32_f16 v[64:67], v[112:115], v[84:87], v[64:67]
  v_mfma_f32_16x16x32_f16 v[60:63], v[112:115], v[80:83], v[60:63]
  ds_read_b64_tr_b16 v[112:113], v24 offset:96
  ds_read_b64_tr_b16 v[114:115], v24 offset:88
  s_waitcnt lgkmcnt(12)
  v_mfma_f32_16x16x32_f16 v[76:79], v[116:119], v[92:95], v[76:79]
  ds_read_b128 v[92:95], v25 offset:1952
  v_mfma_f32_16x16x32_f16 v[72:75], v[116:119], v[88:91], v[72:75]
  v_mfma_f32_16x16x32_f16 v[68:71], v[116:119], v[84:87], v[68:71]
  v_mfma_f32_16x16x32_f16 v[64:67], v[116:119], v[80:83], v[64:67]
  ds_read_b64_tr_b16 v[116:117], v24 offset:608
  ds_read_b64_tr_b16 v[118:119], v24 offset:600
  s_waitcnt lgkmcnt(12)
  v_mfma_f32_16x16x32_f16 v[76:79], v[12:15], v[88:91], v[76:79]
  ds_read_b128 v[88:91], v25 offset:1440
  v_mfma_f32_16x16x32_f16 v[72:75], v[12:15], v[84:87], v[72:75]
  v_mfma_f32_16x16x32_f16 v[68:71], v[12:15], v[80:83], v[68:71]
  ds_read_b64_tr_b16 v[12:13], v24 offset:1120
  ds_read_b64_tr_b16 v[14:15], v24 offset:1112
  s_waitcnt lgkmcnt(12)
  v_mfma_f32_16x16x32_f16 v[76:79], v[16:19], v[84:87], v[76:79]
  ds_read_b128 v[84:87], v25 offset:928
  v_mfma_f32_16x16x32_f16 v[72:75], v[16:19], v[80:83], v[72:75]
  ds_read_b64_tr_b16 v[16:17], v24 offset:1632
  ds_read_b64_tr_b16 v[18:19], v24 offset:1624
  s_waitcnt lgkmcnt(12)
  v_mfma_f32_16x16x32_f16 v[76:79], v[20:23], v[80:83], v[76:79]
  ds_read_b128 v[80:83], v25 offset:416
  ds_read_b64_tr_b16 v[20:21], v24 offset:2144
  ds_read_b64_tr_b16 v[22:23], v24 offset:2136
  s_waitcnt lgkmcnt(12)
  v_mfma_f32_16x16x32_f16 v[76:79], v[112:115], v[108:111], v[76:79]
  ds_read_b128 v[108:111], v25 offset:3936
  v_mfma_f32_16x16x32_f16 v[72:75], v[112:115], v[104:107], v[72:75]
  v_mfma_f32_16x16x32_f16 v[68:71], v[112:115], v[100:103], v[68:71]
  v_mfma_f32_16x16x32_f16 v[64:67], v[112:115], v[96:99], v[64:67]
  s_waitcnt lgkmcnt(12)
  v_mfma_f32_16x16x32_f16 v[60:63], v[112:115], v[92:95], v[60:63]
  s_waitcnt lgkmcnt(9)
  v_mfma_f32_16x16x32_f16 v[56:59], v[112:115], v[88:91], v[56:59]
  s_waitcnt lgkmcnt(6)
  v_mfma_f32_16x16x32_f16 v[52:55], v[112:115], v[84:87], v[52:55]
  s_waitcnt lgkmcnt(3)
  v_mfma_f32_16x16x32_f16 v[48:51], v[112:115], v[80:83], v[48:51]
  ds_read_b64_tr_b16 v[112:113], v24 offset:2656
  ds_read_b64_tr_b16 v[114:115], v24 offset:2648
  v_mfma_f32_16x16x32_f16 v[76:79], v[116:119], v[104:107], v[76:79]
  ds_read_b128 v[104:107], v25 offset:3424
  v_mfma_f32_16x16x32_f16 v[72:75], v[116:119], v[100:103], v[72:75]
  v_mfma_f32_16x16x32_f16 v[68:71], v[116:119], v[96:99], v[68:71]
  v_mfma_f32_16x16x32_f16 v[64:67], v[116:119], v[92:95], v[64:67]
  v_mfma_f32_16x16x32_f16 v[60:63], v[116:119], v[88:91], v[60:63]
  v_mfma_f32_16x16x32_f16 v[56:59], v[116:119], v[84:87], v[56:59]
  v_mfma_f32_16x16x32_f16 v[52:55], v[116:119], v[80:83], v[52:55]
  ds_read_b64_tr_b16 v[116:117], v24 offset:3168
  ds_read_b64_tr_b16 v[118:119], v24 offset:3160
  v_mfma_f32_16x16x32_f16 v[76:79], v[12:15], v[100:103], v[76:79]
  ds_read_b128 v[100:103], v25 offset:2912
  v_mfma_f32_16x16x32_f16 v[72:75], v[12:15], v[96:99], v[72:75]
  v_mfma_f32_16x16x32_f16 v[68:71], v[12:15], v[92:95], v[68:71]
  v_mfma_f32_16x16x32_f16 v[64:67], v[12:15], v[88:91], v[64:67]
  v_mfma_f32_16x16x32_f16 v[60:63], v[12:15], v[84:87], v[60:63]
  v_mfma_f32_16x16x32_f16 v[56:59], v[12:15], v[80:83], v[56:59]
  ds_read_b64_tr_b16 v[12:13], v24 offset:3680
  ds_read_b64_tr_b16 v[14:15], v24 offset:3672
  v_mfma_f32_16x16x32_f16 v[76:79], v[16:19], v[96:99], v[76:79]
  ds_read_b128 v[96:99], v25 offset:2400
  v_mfma_f32_16x16x32_f16 v[72:75], v[16:19], v[92:95], v[72:75]
  v_mfma_f32_16x16x32_f16 v[68:71], v[16:19], v[88:91], v[68:71]
  v_mfma_f32_16x16x32_f16 v[64:67], v[16:19], v[84:87], v[64:67]
  v_mfma_f32_16x16x32_f16 v[60:63], v[16:19], v[80:83], v[60:63]
  ds_read_b64_tr_b16 v[16:17], v24 offset:160
  ds_read_b64_tr_b16 v[18:19], v24 offset:152
  s_waitcnt lgkmcnt(12)
  v_mfma_f32_16x16x32_f16 v[76:79], v[20:23], v[92:95], v[76:79]
  ds_read_b128 v[92:95], v25 offset:1888
  v_mfma_f32_16x16x32_f16 v[72:75], v[20:23], v[88:91], v[72:75]
  v_mfma_f32_16x16x32_f16 v[68:71], v[20:23], v[84:87], v[68:71]
  v_mfma_f32_16x16x32_f16 v[64:67], v[20:23], v[80:83], v[64:67]
  ds_read_b64_tr_b16 v[20:21], v24 offset:672
  ds_read_b64_tr_b16 v[22:23], v24 offset:664
  s_waitcnt lgkmcnt(12)
  v_mfma_f32_16x16x32_f16 v[76:79], v[112:115], v[88:91], v[76:79]
  ds_read_b128 v[88:91], v25 offset:1376
  v_mfma_f32_16x16x32_f16 v[72:75], v[112:115], v[84:87], v[72:75]
  v_mfma_f32_16x16x32_f16 v[68:71], v[112:115], v[80:83], v[68:71]
  ds_read_b64_tr_b16 v[112:113], v24 offset:1184
  ds_read_b64_tr_b16 v[114:115], v24 offset:1176
  s_waitcnt lgkmcnt(12)
  v_mfma_f32_16x16x32_f16 v[76:79], v[116:119], v[84:87], v[76:79]
  ds_read_b128 v[84:87], v25 offset:864
  v_mfma_f32_16x16x32_f16 v[72:75], v[116:119], v[80:83], v[72:75]
  ds_read_b64_tr_b16 v[116:117], v24 offset:1696
  ds_read_b64_tr_b16 v[118:119], v24 offset:1688
  s_waitcnt lgkmcnt(12)
  v_mfma_f32_16x16x32_f16 v[76:79], v[12:15], v[80:83], v[76:79]
  ds_read_b128 v[80:83], v25 offset:352
  ds_read_b64_tr_b16 v[12:13], v24 offset:2208
  ds_read_b64_tr_b16 v[14:15], v24 offset:2200
  s_waitcnt lgkmcnt(12)
  v_mfma_f32_16x16x32_f16 v[76:79], v[16:19], v[108:111], v[76:79]
  ds_read_b128 v[108:111], v25 offset:3872
  v_mfma_f32_16x16x32_f16 v[72:75], v[16:19], v[104:107], v[72:75]
  v_mfma_f32_16x16x32_f16 v[68:71], v[16:19], v[100:103], v[68:71]
  v_mfma_f32_16x16x32_f16 v[64:67], v[16:19], v[96:99], v[64:67]
  s_waitcnt lgkmcnt(12)
  v_mfma_f32_16x16x32_f16 v[60:63], v[16:19], v[92:95], v[60:63]
  s_waitcnt lgkmcnt(9)
  v_mfma_f32_16x16x32_f16 v[56:59], v[16:19], v[88:91], v[56:59]
  s_waitcnt lgkmcnt(6)
  v_mfma_f32_16x16x32_f16 v[52:55], v[16:19], v[84:87], v[52:55]
  s_waitcnt lgkmcnt(3)
  v_mfma_f32_16x16x32_f16 v[48:51], v[16:19], v[80:83], v[48:51]
  ds_read_b64_tr_b16 v[16:17], v24 offset:2720
  ds_read_b64_tr_b16 v[18:19], v24 offset:2712
  v_mfma_f32_16x16x32_f16 v[76:79], v[20:23], v[104:107], v[76:79]
  ds_read_b128 v[104:107], v25 offset:3360
  v_mfma_f32_16x16x32_f16 v[72:75], v[20:23], v[100:103], v[72:75]
  v_mfma_f32_16x16x32_f16 v[68:71], v[20:23], v[96:99], v[68:71]
  v_mfma_f32_16x16x32_f16 v[64:67], v[20:23], v[92:95], v[64:67]
  v_mfma_f32_16x16x32_f16 v[60:63], v[20:23], v[88:91], v[60:63]
  v_mfma_f32_16x16x32_f16 v[56:59], v[20:23], v[84:87], v[56:59]
  v_mfma_f32_16x16x32_f16 v[52:55], v[20:23], v[80:83], v[52:55]
  ds_read_b64_tr_b16 v[20:21], v24 offset:3232
  ds_read_b64_tr_b16 v[22:23], v24 offset:3224
  v_mfma_f32_16x16x32_f16 v[76:79], v[112:115], v[100:103], v[76:79]
  ds_read_b128 v[100:103], v25 offset:2848
  v_mfma_f32_16x16x32_f16 v[72:75], v[112:115], v[96:99], v[72:75]
  v_mfma_f32_16x16x32_f16 v[68:71], v[112:115], v[92:95], v[68:71]
  v_mfma_f32_16x16x32_f16 v[64:67], v[112:115], v[88:91], v[64:67]
  v_mfma_f32_16x16x32_f16 v[60:63], v[112:115], v[84:87], v[60:63]
  v_mfma_f32_16x16x32_f16 v[56:59], v[112:115], v[80:83], v[56:59]
  ds_read_b64_tr_b16 v[112:113], v24 offset:3744
  ds_read_b64_tr_b16 v[114:115], v24 offset:3736
  v_mfma_f32_16x16x32_f16 v[76:79], v[116:119], v[96:99], v[76:79]
  ds_read_b128 v[96:99], v25 offset:2336
  v_mfma_f32_16x16x32_f16 v[72:75], v[116:119], v[92:95], v[72:75]
  v_mfma_f32_16x16x32_f16 v[68:71], v[116:119], v[88:91], v[68:71]
  v_mfma_f32_16x16x32_f16 v[64:67], v[116:119], v[84:87], v[64:67]
  v_mfma_f32_16x16x32_f16 v[60:63], v[116:119], v[80:83], v[60:63]
  ds_read_b64_tr_b16 v[116:117], v24 offset:224
  ds_read_b64_tr_b16 v[118:119], v24 offset:216
  s_waitcnt lgkmcnt(12)
  v_mfma_f32_16x16x32_f16 v[76:79], v[12:15], v[92:95], v[76:79]
  ds_read_b128 v[92:95], v25 offset:1824
  v_mfma_f32_16x16x32_f16 v[72:75], v[12:15], v[88:91], v[72:75]
  v_mfma_f32_16x16x32_f16 v[68:71], v[12:15], v[84:87], v[68:71]
  v_mfma_f32_16x16x32_f16 v[64:67], v[12:15], v[80:83], v[64:67]
  ds_read_b64_tr_b16 v[12:13], v24 offset:736
  ds_read_b64_tr_b16 v[14:15], v24 offset:728
  s_waitcnt lgkmcnt(12)
  v_mfma_f32_16x16x32_f16 v[76:79], v[16:19], v[88:91], v[76:79]
  ds_read_b128 v[88:91], v25 offset:1312
  v_mfma_f32_16x16x32_f16 v[72:75], v[16:19], v[84:87], v[72:75]
  v_mfma_f32_16x16x32_f16 v[68:71], v[16:19], v[80:83], v[68:71]
  ds_read_b64_tr_b16 v[16:17], v24 offset:1248
  ds_read_b64_tr_b16 v[18:19], v24 offset:1240
  s_waitcnt lgkmcnt(12)
  v_mfma_f32_16x16x32_f16 v[76:79], v[20:23], v[84:87], v[76:79]
  ds_read_b128 v[84:87], v25 offset:800
  v_mfma_f32_16x16x32_f16 v[72:75], v[20:23], v[80:83], v[72:75]
  ds_read_b64_tr_b16 v[20:21], v24 offset:1760
  ds_read_b64_tr_b16 v[22:23], v24 offset:1752
  s_waitcnt lgkmcnt(12)
  v_mfma_f32_16x16x32_f16 v[76:79], v[112:115], v[80:83], v[76:79]
  ds_read_b128 v[80:83], v25 offset:288
  ds_read_b64_tr_b16 v[112:113], v24 offset:2272
  ds_read_b64_tr_b16 v[114:115], v24 offset:2264
  s_waitcnt lgkmcnt(12)
  v_mfma_f32_16x16x32_f16 v[76:79], v[116:119], v[108:111], v[76:79]
  v_mfma_f32_16x16x32_f16 v[72:75], v[116:119], v[104:107], v[72:75]
  v_mfma_f32_16x16x32_f16 v[68:71], v[116:119], v[100:103], v[68:71]
  v_mfma_f32_16x16x32_f16 v[64:67], v[116:119], v[96:99], v[64:67]
  s_waitcnt lgkmcnt(11)
  v_mfma_f32_16x16x32_f16 v[60:63], v[116:119], v[92:95], v[60:63]
  s_waitcnt lgkmcnt(8)
  v_mfma_f32_16x16x32_f16 v[56:59], v[116:119], v[88:91], v[56:59]
  s_waitcnt lgkmcnt(5)
  v_mfma_f32_16x16x32_f16 v[52:55], v[116:119], v[84:87], v[52:55]
  s_waitcnt lgkmcnt(2)
  v_mfma_f32_16x16x32_f16 v[48:51], v[116:119], v[80:83], v[48:51]
  ds_read_b64_tr_b16 v[116:117], v24 offset:2784
  ds_read_b64_tr_b16 v[118:119], v24 offset:2776
  v_mfma_f32_16x16x32_f16 v[76:79], v[12:15], v[104:107], v[76:79]
  v_mfma_f32_16x16x32_f16 v[72:75], v[12:15], v[100:103], v[72:75]
  v_mfma_f32_16x16x32_f16 v[68:71], v[12:15], v[96:99], v[68:71]
  v_mfma_f32_16x16x32_f16 v[64:67], v[12:15], v[92:95], v[64:67]
  v_mfma_f32_16x16x32_f16 v[60:63], v[12:15], v[88:91], v[60:63]
  v_mfma_f32_16x16x32_f16 v[56:59], v[12:15], v[84:87], v[56:59]
  v_mfma_f32_16x16x32_f16 v[52:55], v[12:15], v[80:83], v[52:55]
  ds_read_b64_tr_b16 v[12:13], v24 offset:3296
  ds_read_b64_tr_b16 v[14:15], v24 offset:3288
  v_mfma_f32_16x16x32_f16 v[76:79], v[16:19], v[100:103], v[76:79]
  v_mfma_f32_16x16x32_f16 v[72:75], v[16:19], v[96:99], v[72:75]
  v_mfma_f32_16x16x32_f16 v[68:71], v[16:19], v[92:95], v[68:71]
  v_mfma_f32_16x16x32_f16 v[64:67], v[16:19], v[88:91], v[64:67]
  v_mfma_f32_16x16x32_f16 v[60:63], v[16:19], v[84:87], v[60:63]
  v_mfma_f32_16x16x32_f16 v[56:59], v[16:19], v[80:83], v[56:59]
  ds_read_b64_tr_b16 v[16:17], v24 offset:3808
  ds_read_b64_tr_b16 v[18:19], v24 offset:3800
  v_mfma_f32_16x16x32_f16 v[76:79], v[20:23], v[96:99], v[76:79]
  v_mfma_f32_16x16x32_f16 v[72:75], v[20:23], v[92:95], v[72:75]
  v_mfma_f32_16x16x32_f16 v[68:71], v[20:23], v[88:91], v[68:71]
  v_mfma_f32_16x16x32_f16 v[64:67], v[20:23], v[84:87], v[64:67]
  v_mfma_f32_16x16x32_f16 v[60:63], v[20:23], v[80:83], v[60:63]
  s_waitcnt lgkmcnt(6)
  v_mfma_f32_16x16x32_f16 v[76:79], v[112:115], v[92:95], v[76:79]
  v_mfma_f32_16x16x32_f16 v[72:75], v[112:115], v[88:91], v[72:75]
  v_mfma_f32_16x16x32_f16 v[68:71], v[112:115], v[84:87], v[68:71]
  v_mfma_f32_16x16x32_f16 v[64:67], v[112:115], v[80:83], v[64:67]
  s_waitcnt lgkmcnt(4)
  v_mfma_f32_16x16x32_f16 v[76:79], v[116:119], v[88:91], v[76:79]
  v_mfma_f32_16x16x32_f16 v[72:75], v[116:119], v[84:87], v[72:75]
  v_mfma_f32_16x16x32_f16 v[68:71], v[116:119], v[80:83], v[68:71]
  s_waitcnt lgkmcnt(2)
  v_mfma_f32_16x16x32_f16 v[76:79], v[12:15], v[84:87], v[76:79]
  v_mfma_f32_16x16x32_f16 v[72:75], v[12:15], v[80:83], v[72:75]
  s_waitcnt lgkmcnt(0)
  v_mfma_f32_16x16x32_f16 v[76:79], v[16:19], v[80:83], v[76:79]
  s_nop 7
  ds_write_b128 v26, v[76:79] offset:7168
  ds_write_b128 v26, v[72:75] offset:6144
  ds_write_b128 v26, v[68:71] offset:5120
  ds_write_b128 v26, v[64:67] offset:4096
  ds_write_b128 v26, v[60:63] offset:3072
  ds_write_b128 v26, v[56:59] offset:2048
  ds_write_b128 v26, v[52:55] offset:1024
  ds_write_b128 v26, v[48:51] offset:0
  ds_read_b64 v[80:81], v28 offset:9728
  ds_read_b64 v[88:89], v28 offset:1024
  ds_read_b64 v[82:83], v28 offset:13824
  ds_read_b64 v[90:91], v28 offset:5632
  ds_read_b64 v[84:85], v28 offset:10240
  ds_read_b64 v[92:93], v28 offset:1536
  ds_read_b64 v[86:87], v28 offset:14336
  ds_read_b64 v[94:95], v28 offset:6144
  s_lshl_b32 s44, s66, 16
  s_and_b32 s45, s66, 0xffff0000
  s_waitcnt lgkmcnt(0)
  s_barrier
  ds_read_b128 v[48:51], v27 offset:0
  ds_read_b128 v[52:55], v27 offset:16384
  ds_read_b128 v[56:59], v27 offset:8192
  ds_read_b128 v[60:63], v27 offset:24576
  ds_read_b128 v[64:67], v27 offset:1024
  ds_read_b128 v[68:71], v27 offset:17408
  ds_read_b128 v[72:75], v27 offset:9216
  ds_read_b128 v[76:79], v27 offset:25600
  v_cvt_f32_f16 v112, v88
  v_cvt_f32_f16 v114, v89
  v_cvt_f32_f16_sdwa v113, v88 dst_sel:DWORD dst_unused:UNUSED_PAD src0_sel:WORD_1
  v_cvt_f32_f16_sdwa v115, v89 dst_sel:DWORD dst_unused:UNUSED_PAD src0_sel:WORD_1
  v_lshlrev_b32 v96, 16, v80
  v_lshlrev_b32 v98, 16, v81
  v_and_b32 v97, 0xffff0000, v80
  v_and_b32 v99, 0xffff0000, v81
  v_fmac_f32 v96, s44, v112
  v_fmac_f32 v98, s44, v114
  v_fmac_f32 v97, s44, v113
  v_fmac_f32 v99, s44, v115
  v_cvt_f32_f16 v112, v90
  v_cvt_f32_f16 v114, v91
  v_cvt_f32_f16_sdwa v113, v90 dst_sel:DWORD dst_unused:UNUSED_PAD src0_sel:WORD_1
  v_cvt_f32_f16_sdwa v115, v91 dst_sel:DWORD dst_unused:UNUSED_PAD src0_sel:WORD_1
  v_lshlrev_b32 v100, 16, v82
  v_lshlrev_b32 v102, 16, v83
  v_and_b32 v101, 0xffff0000, v82
  v_and_b32 v103, 0xffff0000, v83
  v_fmac_f32 v100, s45, v112
  v_fmac_f32 v102, s45, v114
  v_fmac_f32 v101, s45, v113
  v_fmac_f32 v103, s45, v115
  v_cvt_f32_f16 v112, v92
  v_cvt_f32_f16 v114, v93
  v_cvt_f32_f16_sdwa v113, v92 dst_sel:DWORD dst_unused:UNUSED_PAD src0_sel:WORD_1
  v_cvt_f32_f16_sdwa v115, v93 dst_sel:DWORD dst_unused:UNUSED_PAD src0_sel:WORD_1
  v_lshlrev_b32 v104, 16, v84
  v_lshlrev_b32 v106, 16, v85
  v_and_b32 v105, 0xffff0000, v84
  v_and_b32 v107, 0xffff0000, v85
  v_fmac_f32 v104, s44, v112
  v_fmac_f32 v106, s44, v114
  v_fmac_f32 v105, s44, v113
  v_fmac_f32 v107, s44, v115
  v_cvt_f32_f16 v112, v94
  v_cvt_f32_f16 v114, v95
  v_cvt_f32_f16_sdwa v113, v94 dst_sel:DWORD dst_unused:UNUSED_PAD src0_sel:WORD_1
  v_cvt_f32_f16_sdwa v115, v95 dst_sel:DWORD dst_unused:UNUSED_PAD src0_sel:WORD_1
  v_lshlrev_b32 v108, 16, v86
  v_lshlrev_b32 v110, 16, v87
  v_and_b32 v109, 0xffff0000, v86
  v_and_b32 v111, 0xffff0000, v87
  v_fmac_f32 v108, s45, v112
  v_fmac_f32 v110, s45, v114
  v_fmac_f32 v109, s45, v113
  v_fmac_f32 v111, s45, v115
  s_waitcnt lgkmcnt(4)
  v_pk_add_f32 v[48:49], v[48:49], v[52:53]
  v_pk_add_f32 v[50:51], v[50:51], v[54:55]
  v_fmac_f32 v96, s64, v48
  v_fmac_f32 v97, s64, v49
  v_fmac_f32 v98, s64, v50
  v_fmac_f32 v99, s64, v51
  v_cvt_pk_bf16_f32 v116, v96, v97
  v_cvt_pk_bf16_f32 v117, v98, v99
  buffer_store_dwordx2 v[116:117], v29, s[88:91], 0 offen offset:0 sc1
  v_pk_add_f32 v[56:57], v[56:57], v[60:61]
  v_pk_add_f32 v[58:59], v[58:59], v[62:63]
  v_fmac_f32 v100, s65, v56
  v_fmac_f32 v101, s65, v57
  v_fmac_f32 v102, s65, v58
  v_fmac_f32 v103, s65, v59
  v_cvt_pk_bf16_f32 v118, v100, v101
  v_cvt_pk_bf16_f32 v119, v102, v103
  buffer_store_dwordx2 v[118:119], v30, s[88:91], 0 offen offset:0 sc1
  s_waitcnt lgkmcnt(0)
  v_pk_add_f32 v[64:65], v[64:65], v[68:69]
  v_pk_add_f32 v[66:67], v[66:67], v[70:71]
  v_fmac_f32 v104, s64, v64
  v_fmac_f32 v105, s64, v65
  v_fmac_f32 v106, s64, v66
  v_fmac_f32 v107, s64, v67
  v_cvt_pk_bf16_f32 v116, v104, v105
  v_cvt_pk_bf16_f32 v117, v106, v107
  buffer_store_dwordx2 v[116:117], v29, s[88:91], 0 offen offset:512 sc1
  v_pk_add_f32 v[72:73], v[72:73], v[76:77]
  v_pk_add_f32 v[74:75], v[74:75], v[78:79]
  v_fmac_f32 v108, s65, v72
  v_fmac_f32 v109, s65, v73
  v_fmac_f32 v110, s65, v74
  v_fmac_f32 v111, s65, v75
  v_cvt_pk_bf16_f32 v118, v108, v109
  v_cvt_pk_bf16_f32 v119, v110, v111
  buffer_store_dwordx2 v[118:119], v30, s[88:91], 0 offen offset:512 sc1
  s_waitcnt vmcnt(0)
  s_barrier
  s_cmp_lg_u32 s30, 0
  s_cbranch_scc1 L_sig_24
  s_lshl_b32 s44, s42, 4
  s_add_u32 s44, s44, 720896
  v_mov_b32 v126, s44
  v_mov_b32 v127, s38
  s_mov_b64 exec, 1
  buffer_store_dword v127, v126, s[88:91], 0 offen sc1
  s_mov_b64 exec, -1
L_sig_24:
  v_bfe_u32 v28, v1, 2, 2
  v_lshl_add_u32 v28, v2, 2, v28
  s_lshl_b32 s44, s30, 3
  v_add_u32 v28, s44, v28
  v_lshlrev_b32 v28, 12, v28
  v_bfe_u32 v29, v1, 4, 1
  v_lshlrev_b32 v29, 6, v29
  v_and_b32 v30, 3, v1
  v_lshlrev_b32 v30, 4, v30
  v_add3_u32 v28, v28, v29, v30
  s_lshl_b32 s44, s33, 7
  s_add_u32 s44, s44, 14680064
  v_add_u32 v28, s44, v28
  s_xor_b32 s45, s40, 1
  v_bfe_u32 v24, v1, 2, 2
  v_lshlrev_b32 v24, 6, v24
  v_lshl_add_u32 v24, v2, 10, v24
  v_bfe_u32 v25, v1, 4, 1
  v_lshl_add_u32 v24, v25, 5, v24
  v_and_b32 v25, 3, v1
  v_lshl_add_u32 v24, v25, 3, v24
  s_lshl_b32 s44, s40, 8
  s_lshl_b32 s45, s45, 8
  v_add_u32 v112, s44, v24
  v_add_u32 v116, s45, v24
  s_lshl_b32 s44, s41, 11
  v_add_u32 v24, s44, v112
  s_cmp_lg_u32 s30, 0
  s_cbranch_scc1 L_wait_25
  v_lshlrev_b32 v126, 4, v1
  v_add_u32 v126, 720896, v126
  v_add_u32 v125, 1024, v126
  v_add_u32 v124, 2048, v126
  v_add_u32 v123, 3072, v126
  s_mov_b32 s45, 0
  s_waitcnt vmcnt(0)
  s_sleep 16
L_poll_26:
  buffer_load_dword v127, v126, s[88:91], 0 offen sc1
  buffer_load_dword v122, v125, s[88:91], 0 offen sc1
  buffer_load_dword v121, v124, s[88:91], 0 offen sc1
  buffer_load_dword v120, v123, s[88:91], 0 offen sc1
  s_add_u32 s45, s45, 1
  s_cmp_gt_u32 s45, 40000
  s_cbranch_scc1 L_pdone_27
  s_waitcnt vmcnt(0)
  v_sad_u32 v127, v127, s38, 0
  v_sad_u32 v127, v122, s38, v127
  v_sad_u32 v127, v121, s38, v127
  v_sad_u32 v127, v120, s38, v127
  v_cmp_ne_u32 vcc, 0, v127
  s_nop 4
  s_cbranch_vccz L_pdone_27
  s_sleep 4
  s_branch L_poll_26
L_pdone_27:
  s_waitcnt vmcnt(0)
L_wait_25:
  s_barrier
  s_add_u32 m0, s39, 0
  v_add_u32 v29, 0, v28
  buffer_load_dwordx4 v29, s[88:91], 0 offen sc1 lds
  s_add_u32 m0, s39, 4096
  v_add_u32 v29, 131072, v28
  buffer_load_dwordx4 v29, s[88:91], 0 offen sc1 lds
  s_add_u32 m0, s39, 8192
  v_add_u32 v29, 262144, v28
  buffer_load_dwordx4 v29, s[88:91], 0 offen sc1 lds
  s_add_u32 m0, s39, 12288
  v_add_u32 v29, 393216, v28
  buffer_load_dwordx4 v29, s[88:91], 0 offen sc1 lds
  s_add_u32 m0, s39, 16384
  v_add_u32 v29, 524288, v28
  buffer_load_dwordx4 v29, s[88:91], 0 offen sc1 lds
  s_add_u32 m0, s39, 20480
  v_add_u32 v29, 655360, v28
  buffer_load_dwordx4 v29, s[88:91], 0 offen sc1 lds
  s_add_u32 m0, s39, 24576
  v_add_u32 v29, 786432, v28
  buffer_load_dwordx4 v29, s[88:91], 0 offen sc1 lds
  s_add_u32 m0, s39, 28672
  v_add_u32 v29, 917504, v28
  buffer_load_dwordx4 v29, s[88:91], 0 offen sc1 lds
  v_lshlrev_b32 v96, 3, v3
  s_lshl_b32 s44, s30, 8
  s_add_u32 s44, s44, 94208
  v_add_u32 v12, s44, v96
  s_lshl_b32 s44, s40, 8
  s_add_u32 s45, s44, 94208
  s_xor_b32 s44, s44, 256
  s_add_u32 s44, s44, 94208
  v_add_u32 v13, s45, v96
  v_add_u32 v14, s44, v96
  v_mul_u32_u24 v97, 80, v3
  v_lshl_add_u32 v97, v2, 5, v97
  s_mul_i32 s44, s30, 5120
  s_add_u32 s44, s44, 65536
  s_mul_i32 s45, s40, 2560
  s_xor_b32 s46, s40, 1
  s_mul_i32 s47, s46, 2560
  s_add_u32 s45, s45, s44
  s_add_u32 s47, s47, s44
  v_add_u32 v15, s45, v97
  v_add_u32 v16, s47, v97
  v_bfe_u32 v97, v3, 3, 1
  v_lshlrev_b32 v97, 2, v97
  v_xor_b32 v97, v3, v97
  v_lshlrev_b32 v97, 5, v97
  v_lshl_add_u32 v97, v2, 3, v97
  s_lshl_b32 s44, s30, 11
  s_add_u32 s44, s44, 86016
  s_lshl_b32 s45, s40, 10
  s_lshl_b32 s46, s46, 10
  s_add_u32 s45, s45, s44
  s_add_u32 s46, s46, s44
  v_add_u32 v17, s45, v97
  v_add_u32 v18, s46, v97
  v_lshrrev_b32 v96, 4, v1
  v_bfe_u32 v97, v1, 2, 2
  v_lshl_add_u32 v98, v96, 3, v97
  v_mul_u32_u24 v19, 80, v98
  v_and_b32 v99, 3, v1
  v_lshl_add_u32 v19, v99, 3, v19
  s_mul_i32 s44, s30, 5120
  s_add_u32 s44, s44, 65536
  v_add_u32 v19, s44, v19
  v_and_b32 v100, 1, v96
  v_lshlrev_b32 v100, 2, v100
  v_xor_b32 v97, v98, v100
  v_xor_b32 v98, 4, v97
  v_lshlrev_b32 v97, 5, v97
  v_lshlrev_b32 v98, 5, v98
  v_lshl_add_u32 v97, v99, 3, v97
  v_lshl_add_u32 v98, v99, 3, v98
  s_lshl_b32 s44, s30, 11
  s_add_u32 s44, s44, 86016
  v_add_u32 v23, s44, v97
  v_add_u32 v26, s44, v98
  s_mul_i32 s45, s67, 9216
  s_add_u32 s45, s45, 3407872
  s_lshl_b32 s46, s30, 11
  s_add_u32 s46, s46, s45
  v_and_b32 v97, 15, v1
  v_lshlrev_b32 v97, 7, v97
  v_lshl_add_u32 v97, v96, 4, v97
  v_add_u32 v27, s46, v97
  s_lshl_b32 s46, s30, 8
  s_add_u32 s46, s46, s45
  s_add_u32 s46, s46, 8192
  v_lshlrev_b32 v97, 3, v1
  v_add_u32 v120, s46, v97
  v_lshlrev_b32 v97, 4, v2
  s_lshl_b32 s44, s30, 7
  s_add_u32 s44, s44, 107520
  v_add_u32 v121, s44, v97
  v_mov_b32 v20, 0
  v_mov_b32 v21, 0
  v_mov_b32 v22, 0x3f803f80
  s_waitcnt vmcnt(6)
  s_barrier
  ds_read_b64_tr_b16 v[104:105], v24 offset:0
  ds_read_b64_tr_b16 v[106:107], v24 offset:512
  ds_read_b64_tr_b16 v[80:81], v112 offset:0
  ds_read_b64_tr_b16 v[82:83], v112 offset:512
  ds_read_b64_tr_b16 v[84:85], v116 offset:0
  ds_read_b64_tr_b16 v[86:87], v116 offset:512
  ds_read_b64_tr_b16 v[88:89], v112 offset:2048
  ds_read_b64_tr_b16 v[90:91], v112 offset:2560
  ds_read_b64_tr_b16 v[92:93], v116 offset:2048
  ds_read_b64_tr_b16 v[94:95], v116 offset:2560
  ds_read_b64_tr_b16 v[96:97], v112 offset:4096
  ds_read_b64_tr_b16 v[98:99], v112 offset:4608
  ds_read_b64_tr_b16 v[100:101], v116 offset:4096
  ds_read_b64_tr_b16 v[102:103], v116 offset:4608
  s_waitcnt vmcnt(4)
  s_barrier
  s_waitcnt lgkmcnt(8)
  v_mfma_f32_32x32x16_bf16 v[48:63], a[0:3], v[80:83], 0
  ds_read_b64_tr_b16 v[108:109], v24 offset:4096
  ds_read_b64_tr_b16 v[110:111], v24 offset:4608
  s_add_u32 m0, s39, 32768
  v_add_u32 v29, 1048576, v28
  buffer_load_dwordx4 v29, s[88:91], 0 offen sc1 lds
  v_mfma_f32_32x32x16_bf16 v[64:79], a[0:3], v[84:87], 0
  ds_read_b64_tr_b16 v[80:81], v112 offset:6144
  ds_read_b64_tr_b16 v[82:83], v112 offset:6656
  ds_read_b64_tr_b16 v[84:85], v116 offset:6144
  ds_read_b64_tr_b16 v[86:87], v116 offset:6656
  s_waitcnt lgkmcnt(10)
  v_mfma_f32_32x32x16_bf16 v[48:63], a[4:7], v[88:91], v[48:63]
  v_mfma_f32_32x32x16_bf16 v[64:79], a[4:7], v[92:95], v[64:79]
  ds_read_b64_tr_b16 v[88:89], v112 offset:8192
  ds_read_b64_tr_b16 v[90:91], v112 offset:8704
  ds_read_b64_tr_b16 v[92:93], v116 offset:8192
  ds_read_b64_tr_b16 v[94:95], v116 offset:8704
  v_dot2c_f32_bf16 v20, v104, v22
  v_dot2c_f32_bf16 v21, v104, v104
  v_dot2c_f32_bf16 v20, v105, v22
  v_dot2c_f32_bf16 v21, v105, v105
  v_dot2c_f32_bf16 v20, v106, v22
  v_dot2c_f32_bf16 v21, v106, v106
  v_dot2c_f32_bf16 v20, v107, v22
  v_dot2c_f32_bf16 v21, v107, v107
  s_waitcnt lgkmcnt(8)
  v_dot2c_f32_bf16 v20, v108, v22
  v_dot2c_f32_bf16 v21, v108, v108
  v_dot2c_f32_bf16 v20, v109, v22
  v_dot2c_f32_bf16 v21, v109, v109
  v_dot2c_f32_bf16 v20, v110, v22
  v_dot2c_f32_bf16 v21, v110, v110
  v_dot2c_f32_bf16 v20, v111, v22
  v_dot2c_f32_bf16 v21, v111, v111
  v_mfma_f32_32x32x16_bf16 v[48:63], a[8:11], v[96:99], v[48:63]
  ds_read_b64_tr_b16 v[104:105], v24 offset:8192
  ds_read_b64_tr_b16 v[106:107], v24 offset:8704
  s_add_u32 m0, s39, 36864
  v_add_u32 v29, 1179648, v28
  buffer_load_dwordx4 v29, s[88:91], 0 offen sc1 lds
  v_mfma_f32_32x32x16_bf16 v[64:79], a[8:11], v[100:103], v[64:79]
  ds_read_b64_tr_b16 v[96:97], v112 offset:10240
  ds_read_b64_tr_b16 v[98:99], v112 offset:10752
  ds_read_b64_tr_b16 v[100:101], v116 offset:10240
  ds_read_b64_tr_b16 v[102:103], v116 offset:10752
  s_waitcnt lgkmcnt(10)
  v_mfma_f32_32x32x16_bf16 v[48:63], a[12:15], v[80:83], v[48:63]
  v_mfma_f32_32x32x16_bf16 v[64:79], a[12:15], v[84:87], v[64:79]
  ds_read_b64_tr_b16 v[80:81], v112 offset:12288
  ds_read_b64_tr_b16 v[82:83], v112 offset:12800
  ds_read_b64_tr_b16 v[84:85], v116 offset:12288
  ds_read_b64_tr_b16 v[86:87], v116 offset:12800
  s_waitcnt lgkmcnt(8)
  v_dot2c_f32_bf16 v20, v104, v22
  v_dot2c_f32_bf16 v21, v104, v104
  v_dot2c_f32_bf16 v20, v105, v22
  v_dot2c_f32_bf16 v21, v105, v105
  v_dot2c_f32_bf16 v20, v106, v22
  v_dot2c_f32_bf16 v21, v106, v106
  v_dot2c_f32_bf16 v20, v107, v22
  v_dot2c_f32_bf16 v21, v107, v107
  s_waitcnt vmcnt(4)
  s_barrier
  v_mfma_f32_32x32x16_bf16 v[48:63], a[16:19], v[88:91], v[48:63]
  ds_read_b64_tr_b16 v[108:109], v24 offset:12288
  ds_read_b64_tr_b16 v[110:111], v24 offset:12800
  s_add_u32 m0, s39, 40960
  v_add_u32 v29, 1310720, v28
  buffer_load_dwordx4 v29, s[88:91], 0 offen sc1 lds
  v_mfma_f32_32x32x16_bf16 v[64:79], a[16:19], v[92:95], v[64:79]
  ds_read_b64_tr_b16 v[88:89], v112 offset:14336
  ds_read_b64_tr_b16 v[90:91], v112 offset:14848
  ds_read_b64_tr_b16 v[92:93], v116 offset:14336
  ds_read_b64_tr_b16 v[94:95], v116 offset:14848
  s_waitcnt lgkmcnt(10)
  v_mfma_f32_32x32x16_bf16 v[48:63], a[20:23], v[96:99], v[48:63]
  v_mfma_f32_32x32x16_bf16 v[64:79], a[20:23], v[100:103], v[64:79]
  ds_read_b64_tr_b16 v[96:97], v112 offset:16384
  ds_read_b64_tr_b16 v[98:99], v112 offset:16896
  ds_read_b64_tr_b16 v[100:101], v116 offset:16384
  ds_read_b64_tr_b16 v[102:103], v116 offset:16896
  s_waitcnt lgkmcnt(8)
  v_dot2c_f32_bf16 v20, v108, v22
  v_dot2c_f32_bf16 v21, v108, v108
  v_dot2c_f32_bf16 v20, v109, v22
  v_dot2c_f32_bf16 v21, v109, v109
  v_dot2c_f32_bf16 v20, v110, v22
  v_dot2c_f32_bf16 v21, v110, v110
  v_dot2c_f32_bf16 v20, v111, v22
  v_dot2c_f32_bf16 v21, v111, v111
  v_mfma_f32_32x32x16_bf16 v[48:63], a[24:27], v[80:83], v[48:63]
  ds_read_b64_tr_b16 v[104:105], v24 offset:16384
  ds_read_b64_tr_b16 v[106:107], v24 offset:16896
  s_add_u32 m0, s39, 45056
  v_add_u32 v29, 1441792, v28
  buffer_load_dwordx4 v29, s[88:91], 0 offen sc1 lds
  v_mfma_f32_32x32x16_bf16 v[64:79], a[24:27], v[84:87], v[64:79]
  ds_read_b64_tr_b16 v[80:81], v112 offset:18432
  ds_read_b64_tr_b16 v[82:83], v112 offset:18944
  ds_read_b64_tr_b16 v[84:85], v116 offset:18432
  ds_read_b64_tr_b16 v[86:87], v116 offset:18944
  s_waitcnt lgkmcnt(10)
  v_mfma_f32_32x32x16_bf16 v[48:63], a[28:31], v[88:91], v[48:63]
  v_mfma_f32_32x32x16_bf16 v[64:79], a[28:31], v[92:95], v[64:79]
  ds_read_b64_tr_b16 v[88:89], v112 offset:20480
  ds_read_b64_tr_b16 v[90:91], v112 offset:20992
  ds_read_b64_tr_b16 v[92:93], v116 offset:20480
  ds_read_b64_tr_b16 v[94:95], v116 offset:20992
  s_waitcnt lgkmcnt(8)
  v_dot2c_f32_bf16 v20, v104, v22
  v_dot2c_f32_bf16 v21, v104, v104
  v_dot2c_f32_bf16 v20, v105, v22
  v_dot2c_f32_bf16 v21, v105, v105
  v_dot2c_f32_bf16 v20, v106, v22
  v_dot2c_f32_bf16 v21, v106, v106
  v_dot2c_f32_bf16 v20, v107, v22
  v_dot2c_f32_bf16 v21, v107, v107
  s_waitcnt vmcnt(4)
  s_barrier
  v_mfma_f32_32x32x16_bf16 v[48:63], a[32:35], v[96:99], v[48:63]
  ds_read_b64_tr_b16 v[108:109], v24 offset:20480
  ds_read_b64_tr_b16 v[110:111], v24 offset:20992
  s_add_u32 m0, s39, 49152
  v_add_u32 v29, 1572864, v28
  buffer_load_dwordx4 v29, s[88:91], 0 offen sc1 lds
  v_mfma_f32_32x32x16_bf16 v[64:79], a[32:35], v[100:103], v[64:79]
  ds_read_b64_tr_b16 v[96:97], v112 offset:22528
  ds_read_b64_tr_b16 v[98:99], v112 offset:23040
  ds_read_b64_tr_b16 v[100:101], v116 offset:22528
  ds_read_b64_tr_b16 v[102:103], v116 offset:23040
  s_waitcnt lgkmcnt(10)
  v_mfma_f32_32x32x16_bf16 v[48:63], a[36:39], v[80:83], v[48:63]
  v_mfma_f32_32x32x16_bf16 v[64:79], a[36:39], v[84:87], v[64:79]
  ds_read_b64_tr_b16 v[80:81], v112 offset:24576
  ds_read_b64_tr_b16 v[82:83], v112 offset:25088
  ds_read_b64_tr_b16 v[84:85], v116 offset:24576
  ds_read_b64_tr_b16 v[86:87], v116 offset:25088
  s_waitcnt lgkmcnt(8)
  v_dot2c_f32_bf16 v20, v108, v22
  v_dot2c_f32_bf16 v21, v108, v108
  v_dot2c_f32_bf16 v20, v109, v22
  v_dot2c_f32_bf16 v21, v109, v109
  v_dot2c_f32_bf16 v20, v110, v22
  v_dot2c_f32_bf16 v21, v110, v110
  v_dot2c_f32_bf16 v20, v111, v22
  v_dot2c_f32_bf16 v21, v111, v111
  v_mfma_f32_32x32x16_bf16 v[48:63], a[40:43], v[88:91], v[48:63]
  ds_read_b64_tr_b16 v[104:105], v24 offset:24576
  ds_read_b64_tr_b16 v[106:107], v24 offset:25088
  s_add_u32 m0, s39, 53248
  v_add_u32 v29, 1703936, v28
  buffer_load_dwordx4 v29, s[88:91], 0 offen sc1 lds
  v_mfma_f32_32x32x16_bf16 v[64:79], a[40:43], v[92:95], v[64:79]
  ds_read_b64_tr_b16 v[88:89], v112 offset:26624
  ds_read_b64_tr_b16 v[90:91], v112 offset:27136
  ds_read_b64_tr_b16 v[92:93], v116 offset:26624
  ds_read_b64_tr_b16 v[94:95], v116 offset:27136
  s_waitcnt lgkmcnt(10)
  v_mfma_f32_32x32x16_bf16 v[48:63], a[44:47], v[96:99], v[48:63]
  v_mfma_f32_32x32x16_bf16 v[64:79], a[44:47], v[100:103], v[64:79]
  ds_read_b64_tr_b16 v[96:97], v112 offset:28672
  ds_read_b64_tr_b16 v[98:99], v112 offset:29184
  ds_read_b64_tr_b16 v[100:101], v116 offset:28672
  ds_read_b64_tr_b16 v[102:103], v116 offset:29184
  s_waitcnt lgkmcnt(8)
  v_dot2c_f32_bf16 v20, v104, v22
  v_dot2c_f32_bf16 v21, v104, v104
  v_dot2c_f32_bf16 v20, v105, v22
  v_dot2c_f32_bf16 v21, v105, v105
  v_dot2c_f32_bf16 v20, v106, v22
  v_dot2c_f32_bf16 v21, v106, v106
  v_dot2c_f32_bf16 v20, v107, v22
  v_dot2c_f32_bf16 v21, v107, v107
  s_waitcnt vmcnt(4)
  s_barrier
  v_mfma_f32_32x32x16_bf16 v[48:63], a[48:51], v[80:83], v[48:63]
  ds_read_b64_tr_b16 v[108:109], v24 offset:28672
  ds_read_b64_tr_b16 v[110:111], v24 offset:29184
  s_add_u32 m0, s39, 57344
  v_add_u32 v29, 1835008, v28
  buffer_load_dwordx4 v29, s[88:91], 0 offen sc1 lds
  v_mfma_f32_32x32x16_bf16 v[64:79], a[48:51], v[84:87], v[64:79]
  ds_read_b64_tr_b16 v[80:81], v112 offset:30720
  ds_read_b64_tr_b16 v[82:83], v112 offset:31232
  ds_read_b64_tr_b16 v[84:85], v116 offset:30720
  ds_read_b64_tr_b16 v[86:87], v116 offset:31232
  s_waitcnt lgkmcnt(10)
  v_mfma_f32_32x32x16_bf16 v[48:63], a[52:55], v[88:91], v[48:63]
  v_mfma_f32_32x32x16_bf16 v[64:79], a[52:55], v[92:95], v[64:79]
  ds_read_b64_tr_b16 v[88:89], v112 offset:32768
  ds_read_b64_tr_b16 v[90:91], v112 offset:33280
  ds_read_b64_tr_b16 v[92:93], v116 offset:32768
  ds_read_b64_tr_b16 v[94:95], v116 offset:33280
  s_waitcnt lgkmcnt(8)
  v_dot2c_f32_bf16 v20, v108, v22
  v_dot2c_f32_bf16 v21, v108, v108
  v_dot2c_f32_bf16 v20, v109, v22
  v_dot2c_f32_bf16 v21, v109, v109
  v_dot2c_f32_bf16 v20, v110, v22
  v_dot2c_f32_bf16 v21, v110, v110
  v_dot2c_f32_bf16 v20, v111, v22
  v_dot2c_f32_bf16 v21, v111, v111
  v_mfma_f32_32x32x16_bf16 v[48:63], a[56:59], v[96:99], v[48:63]
  ds_read_b64_tr_b16 v[104:105], v24 offset:32768
  ds_read_b64_tr_b16 v[106:107], v24 offset:33280
  s_add_u32 m0, s39, 61440
  v_add_u32 v29, 1966080, v28
  buffer_load_dwordx4 v29, s[88:91], 0 offen sc1 lds
  v_mfma_f32_32x32x16_bf16 v[64:79], a[56:59], v[100:103], v[64:79]
  ds_read_b64_tr_b16 v[96:97], v112 offset:34816
  ds_read_b64_tr_b16 v[98:99], v112 offset:35328
  ds_read_b64_tr_b16 v[100:101], v116 offset:34816
  ds_read_b64_tr_b16 v[102:103], v116 offset:35328
  s_waitcnt lgkmcnt(10)
  v_mfma_f32_32x32x16_bf16 v[48:63], a[60:63], v[80:83], v[48:63]
  v_mfma_f32_32x32x16_bf16 v[64:79], a[60:63], v[84:87], v[64:79]
  ds_read_b64_tr_b16 v[80:81], v112 offset:36864
  ds_read_b64_tr_b16 v[82:83], v112 offset:37376
  ds_read_b64_tr_b16 v[84:85], v116 offset:36864
  ds_read_b64_tr_b16 v[86:87], v116 offset:37376
  s_waitcnt lgkmcnt(8)
  v_dot2c_f32_bf16 v20, v104, v22
  v_dot2c_f32_bf16 v21, v104, v104
  v_dot2c_f32_bf16 v20, v105, v22
  v_dot2c_f32_bf16 v21, v105, v105
  v_dot2c_f32_bf16 v20, v106, v22
  v_dot2c_f32_bf16 v21, v106, v106
  v_dot2c_f32_bf16 v20, v107, v22
  v_dot2c_f32_bf16 v21, v107, v107
  s_waitcnt vmcnt(4)
  s_barrier
  v_mfma_f32_32x32x16_bf16 v[48:63], a[64:67], v[88:91], v[48:63]
  ds_read_b64_tr_b16 v[108:109], v24 offset:36864
  ds_read_b64_tr_b16 v[110:111], v24 offset:37376
  v_mfma_f32_32x32x16_bf16 v[64:79], a[64:67], v[92:95], v[64:79]
  ds_read_b64_tr_b16 v[88:89], v112 offset:38912
  ds_read_b64_tr_b16 v[90:91], v112 offset:39424
  ds_read_b64_tr_b16 v[92:93], v116 offset:38912
  ds_read_b64_tr_b16 v[94:95], v116 offset:39424
  s_waitcnt lgkmcnt(10)
  v_mfma_f32_32x32x16_bf16 v[48:63], a[68:71], v[96:99], v[48:63]
  v_mfma_f32_32x32x16_bf16 v[64:79], a[68:71], v[100:103], v[64:79]
  ds_read_b64_tr_b16 v[96:97], v112 offset:40960
  ds_read_b64_tr_b16 v[98:99], v112 offset:41472
  ds_read_b64_tr_b16 v[100:101], v116 offset:40960
  ds_read_b64_tr_b16 v[102:103], v116 offset:41472
  s_waitcnt lgkmcnt(8)
  v_dot2c_f32_bf16 v20, v108, v22
  v_dot2c_f32_bf16 v21, v108, v108
  v_dot2c_f32_bf16 v20, v109, v22
  v_dot2c_f32_bf16 v21, v109, v109
  v_dot2c_f32_bf16 v20, v110, v22
  v_dot2c_f32_bf16 v21, v110, v110
  v_dot2c_f32_bf16 v20, v111, v22
  v_dot2c_f32_bf16 v21, v111, v111
  v_mfma_f32_32x32x16_bf16 v[48:63], a[72:75], v[80:83], v[48:63]
  ds_read_b64_tr_b16 v[104:105], v24 offset:40960
  ds_read_b64_tr_b16 v[106:107], v24 offset:41472
  v_mfma_f32_32x32x16_bf16 v[64:79], a[72:75], v[84:87], v[64:79]
  ds_read_b64_tr_b16 v[80:81], v112 offset:43008
  ds_read_b64_tr_b16 v[82:83], v112 offset:43520
  ds_read_b64_tr_b16 v[84:85], v116 offset:43008
  ds_read_b64_tr_b16 v[86:87], v116 offset:43520
  s_waitcnt lgkmcnt(10)
  v_mfma_f32_32x32x16_bf16 v[48:63], a[76:79], v[88:91], v[48:63]
  v_mfma_f32_32x32x16_bf16 v[64:79], a[76:79], v[92:95], v[64:79]
  ds_read_b64_tr_b16 v[88:89], v112 offset:45056
  ds_read_b64_tr_b16 v[90:91], v112 offset:45568
  ds_read_b64_tr_b16 v[92:93], v116 offset:45056
  ds_read_b64_tr_b16 v[94:95], v116 offset:45568
  s_waitcnt lgkmcnt(8)
  v_dot2c_f32_bf16 v20, v104, v22
  v_dot2c_f32_bf16 v21, v104, v104
  v_dot2c_f32_bf16 v20, v105, v22
  v_dot2c_f32_bf16 v21, v105, v105
  v_dot2c_f32_bf16 v20, v106, v22
  v_dot2c_f32_bf16 v21, v106, v106
  v_dot2c_f32_bf16 v20, v107, v22
  v_dot2c_f32_bf16 v21, v107, v107
  s_waitcnt vmcnt(2)
  s_barrier
  v_mfma_f32_32x32x16_bf16 v[48:63], a[80:83], v[96:99], v[48:63]
  ds_read_b64_tr_b16 v[108:109], v24 offset:45056
  ds_read_b64_tr_b16 v[110:111], v24 offset:45568
  v_mfma_f32_32x32x16_bf16 v[64:79], a[80:83], v[100:103], v[64:79]
  ds_read_b64_tr_b16 v[96:97], v112 offset:47104
  ds_read_b64_tr_b16 v[98:99], v112 offset:47616
  ds_read_b64_tr_b16 v[100:101], v116 offset:47104
  ds_read_b64_tr_b16 v[102:103], v116 offset:47616
  s_waitcnt lgkmcnt(10)
  v_mfma_f32_32x32x16_bf16 v[48:63], a[84:87], v[80:83], v[48:63]
  v_mfma_f32_32x32x16_bf16 v[64:79], a[84:87], v[84:87], v[64:79]
  ds_read_b64_tr_b16 v[80:81], v112 offset:49152
  ds_read_b64_tr_b16 v[82:83], v112 offset:49664
  ds_read_b64_tr_b16 v[84:85], v116 offset:49152
  ds_read_b64_tr_b16 v[86:87], v116 offset:49664
  s_waitcnt lgkmcnt(8)
  v_dot2c_f32_bf16 v20, v108, v22
  v_dot2c_f32_bf16 v21, v108, v108
  v_dot2c_f32_bf16 v20, v109, v22
  v_dot2c_f32_bf16 v21, v109, v109
  v_dot2c_f32_bf16 v20, v110, v22
  v_dot2c_f32_bf16 v21, v110, v110
  v_dot2c_f32_bf16 v20, v111, v22
  v_dot2c_f32_bf16 v21, v111, v111
  v_mfma_f32_32x32x16_bf16 v[48:63], a[88:91], v[88:91], v[48:63]
  ds_read_b64_tr_b16 v[104:105], v24 offset:49152
  ds_read_b64_tr_b16 v[106:107], v24 offset:49664
  v_mfma_f32_32x32x16_bf16 v[64:79], a[88:91], v[92:95], v[64:79]
  ds_read_b64_tr_b16 v[88:89], v112 offset:51200
  ds_read_b64_tr_b16 v[90:91], v112 offset:51712
  ds_read_b64_tr_b16 v[92:93], v116 offset:51200
  ds_read_b64_tr_b16 v[94:95], v116 offset:51712
  s_waitcnt lgkmcnt(10)
  v_mfma_f32_32x32x16_bf16 v[48:63], a[92:95], v[96:99], v[48:63]
  v_mfma_f32_32x32x16_bf16 v[64:79], a[92:95], v[100:103], v[64:79]
  ds_read_b64_tr_b16 v[96:97], v112 offset:53248
  ds_read_b64_tr_b16 v[98:99], v112 offset:53760
  ds_read_b64_tr_b16 v[100:101], v116 offset:53248
  ds_read_b64_tr_b16 v[102:103], v116 offset:53760
  s_waitcnt lgkmcnt(8)
  v_dot2c_f32_bf16 v20, v104, v22
  v_dot2c_f32_bf16 v21, v104, v104
  v_dot2c_f32_bf16 v20, v105, v22
  v_dot2c_f32_bf16 v21, v105, v105
  v_dot2c_f32_bf16 v20, v106, v22
  v_dot2c_f32_bf16 v21, v106, v106
  v_dot2c_f32_bf16 v20, v107, v22
  v_dot2c_f32_bf16 v21, v107, v107
  s_waitcnt vmcnt(0)
  s_barrier
  v_mfma_f32_32x32x16_bf16 v[48:63], a[96:99], v[80:83], v[48:63]
  ds_read_b64_tr_b16 v[108:109], v24 offset:53248
  ds_read_b64_tr_b16 v[110:111], v24 offset:53760
  v_mfma_f32_32x32x16_bf16 v[64:79], a[96:99], v[84:87], v[64:79]
  ds_read_b64_tr_b16 v[80:81], v112 offset:55296
  ds_read_b64_tr_b16 v[82:83], v112 offset:55808
  ds_read_b64_tr_b16 v[84:85], v116 offset:55296
  ds_read_b64_tr_b16 v[86:87], v116 offset:55808
  s_waitcnt lgkmcnt(10)
  v_mfma_f32_32x32x16_bf16 v[48:63], a[100:103], v[88:91], v[48:63]
  v_mfma_f32_32x32x16_bf16 v[64:79], a[100:103], v[92:95], v[64:79]
  ds_read_b64_tr_b16 v[88:89], v112 offset:57344
  ds_read_b64_tr_b16 v[90:91], v112 offset:57856
  ds_read_b64_tr_b16 v[92:93], v116 offset:57344
  ds_read_b64_tr_b16 v[94:95], v116 offset:57856
  s_waitcnt lgkmcnt(8)
  v_dot2c_f32_bf16 v20, v108, v22
  v_dot2c_f32_bf16 v21, v108, v108
  v_dot2c_f32_bf16 v20, v109, v22
  v_dot2c_f32_bf16 v21, v109, v109
  v_dot2c_f32_bf16 v20, v110, v22
  v_dot2c_f32_bf16 v21, v110, v110
  v_dot2c_f32_bf16 v20, v111, v22
  v_dot2c_f32_bf16 v21, v111, v111
  v_mfma_f32_32x32x16_bf16 v[48:63], a[104:107], v[96:99], v[48:63]
  ds_read_b64_tr_b16 v[104:105], v24 offset:57344
  ds_read_b64_tr_b16 v[106:107], v24 offset:57856
  v_mfma_f32_32x32x16_bf16 v[64:79], a[104:107], v[100:103], v[64:79]
  ds_read_b64_tr_b16 v[96:97], v112 offset:59392
  ds_read_b64_tr_b16 v[98:99], v112 offset:59904
  ds_read_b64_tr_b16 v[100:101], v116 offset:59392
  ds_read_b64_tr_b16 v[102:103], v116 offset:59904
  s_waitcnt lgkmcnt(10)
  v_mfma_f32_32x32x16_bf16 v[48:63], a[108:111], v[80:83], v[48:63]
  v_mfma_f32_32x32x16_bf16 v[64:79], a[108:111], v[84:87], v[64:79]
  ds_read_b64_tr_b16 v[80:81], v112 offset:61440
  ds_read_b64_tr_b16 v[82:83], v112 offset:61952
  ds_read_b64_tr_b16 v[84:85], v116 offset:61440
  ds_read_b64_tr_b16 v[86:87], v116 offset:61952
  s_waitcnt lgkmcnt(8)
  v_dot2c_f32_bf16 v20, v104, v22
  v_dot2c_f32_bf16 v21, v104, v104
  v_dot2c_f32_bf16 v20, v105, v22
  v_dot2c_f32_bf16 v21, v105, v105
  v_dot2c_f32_bf16 v20, v106, v22
  v_dot2c_f32_bf16 v21, v106, v106
  v_dot2c_f32_bf16 v20, v107, v22
  v_dot2c_f32_bf16 v21, v107, v107
  v_mfma_f32_32x32x16_bf16 v[48:63], a[112:115], v[88:91], v[48:63]
  ds_read_b64_tr_b16 v[108:109], v24 offset:61440
  ds_read_b64_tr_b16 v[110:111], v24 offset:61952
  v_mfma_f32_32x32x16_bf16 v[64:79], a[112:115], v[92:95], v[64:79]
  ds_read_b64_tr_b16 v[88:89], v112 offset:63488
  ds_read_b64_tr_b16 v[90:91], v112 offset:64000
  ds_read_b64_tr_b16 v[92:93], v116 offset:63488
  ds_read_b64_tr_b16 v[94:95], v116 offset:64000
  s_waitcnt lgkmcnt(10)
  v_mfma_f32_32x32x16_bf16 v[48:63], a[116:119], v[96:99], v[48:63]
  v_mfma_f32_32x32x16_bf16 v[64:79], a[116:119], v[100:103], v[64:79]
  s_waitcnt lgkmcnt(4)
  v_dot2c_f32_bf16 v20, v108, v22
  v_dot2c_f32_bf16 v21, v108, v108
  v_dot2c_f32_bf16 v20, v109, v22
  v_dot2c_f32_bf16 v21, v109, v109
  v_dot2c_f32_bf16 v20, v110, v22
  v_dot2c_f32_bf16 v21, v110, v110
  v_dot2c_f32_bf16 v20, v111, v22
  v_dot2c_f32_bf16 v21, v111, v111
  s_nop 1
  v_mov_b32 v24, v20
  v_mov_b32 v25, v21
  s_nop 0
  v_permlane32_swap_b32 v20, v24
  v_permlane32_swap_b32 v21, v25
  v_add_f32 v20, v20, v24
  v_add_f32 v21, v21, v25
  ds_write_b64 v12, v[20:21]
  s_waitcnt lgkmcnt(0)
  s_barrier
  ds_read_b64 v[104:105], v13
  ds_read_b64 v[106:107], v13 offset:512
  ds_read_b64 v[108:109], v14
  ds_read_b64 v[110:111], v14 offset:512
  v_mfma_f32_32x32x16_bf16 v[48:63], a[120:123], v[80:83], v[48:63]
  v_mfma_f32_32x32x16_bf16 v[64:79], a[120:123], v[84:87], v[64:79]
  s_waitcnt lgkmcnt(0)
  v_add_f32 v104, v104, v106
  v_add_f32 v105, v105, v107
  v_add_f32 v108, v108, v110
  v_add_f32 v109, v109, v111
  v_mul_f32 v32, 0x3b000000, v104
  v_mul_f32 v34, 0x3b000000, v108
  v_mul_f32 v106, 0x3b000000, v105
  v_mul_f32 v110, 0x3b000000, v109
  v_fma_f32 v106, -v32, v32, v106
  v_fma_f32 v110, -v34, v34, v110
  v_max_f32 v106, 0, v106
  v_max_f32 v110, 0, v110
  v_cvt_pk_bf16_f32 v32, v32, v106
  v_cvt_pk_bf16_f32 v34, v34, v110
  v_and_b32 v106, 0xffff0000, v32
  v_and_b32 v110, 0xffff0000, v34
  v_lshlrev_b32 v32, 16, v32
  v_lshlrev_b32 v34, 16, v34
  v_add_f32 v106, 0x3727c5ac, v106
  v_add_f32 v110, 0x3727c5ac, v110
  v_cvt_pk_bf16_f32 v106, v106, v106
  v_cvt_pk_bf16_f32 v110, v110, v110
  v_lshlrev_b32 v106, 16, v106
  v_lshlrev_b32 v110, 16, v110
  v_sqrt_f32 v106, v106
  v_sqrt_f32 v110, v110
  v_cvt_pk_bf16_f32 v106, v106, v106
  v_cvt_pk_bf16_f32 v110, v110, v110
  v_lshlrev_b32 v106, 16, v106
  v_lshlrev_b32 v110, 16, v110
  v_rcp_f32 v33, v106
  v_rcp_f32 v35, v110
  v_mfma_f32_32x32x16_bf16 v[48:63], a[124:127], v[88:91], v[48:63]
  v_mfma_f32_32x32x16_bf16 v[64:79], a[124:127], v[92:95], v[64:79]
  ds_read_b128 v[80:83], v121 offset:0
  ds_read_b128 v[84:87], v121 offset:32
  ds_read_b128 v[88:91], v121 offset:64
  ds_read_b128 v[92:95], v121 offset:96
  s_waitcnt lgkmcnt(0)
  s_nop 5
  v_pk_fma_f32 v[48:49], v[80:81], v[32:33], v[48:49] op_sel_hi:[1,0,1] neg_lo:[0,1,0] neg_hi:[0,1,0]
  v_pk_fma_f32 v[50:51], v[82:83], v[32:33], v[50:51] op_sel_hi:[1,0,1] neg_lo:[0,1,0] neg_hi:[0,1,0]
  v_pk_fma_f32 v[52:53], v[84:85], v[32:33], v[52:53] op_sel_hi:[1,0,1] neg_lo:[0,1,0] neg_hi:[0,1,0]
  v_pk_fma_f32 v[54:55], v[86:87], v[32:33], v[54:55] op_sel_hi:[1,0,1] neg_lo:[0,1,0] neg_hi:[0,1,0]
  v_pk_fma_f32 v[56:57], v[88:89], v[32:33], v[56:57] op_sel_hi:[1,0,1] neg_lo:[0,1,0] neg_hi:[0,1,0]
  v_pk_fma_f32 v[58:59], v[90:91], v[32:33], v[58:59] op_sel_hi:[1,0,1] neg_lo:[0,1,0] neg_hi:[0,1,0]
  v_pk_fma_f32 v[60:61], v[92:93], v[32:33], v[60:61] op_sel_hi:[1,0,1] neg_lo:[0,1,0] neg_hi:[0,1,0]
  v_pk_fma_f32 v[62:63], v[94:95], v[32:33], v[62:63] op_sel_hi:[1,0,1] neg_lo:[0,1,0] neg_hi:[0,1,0]
  v_pk_mul_f32 v[48:49], v[48:49], v[32:33] op_sel:[0,1] op_sel_hi:[1,1]
  v_pk_mul_f32 v[50:51], v[50:51], v[32:33] op_sel:[0,1] op_sel_hi:[1,1]
  v_pk_mul_f32 v[52:53], v[52:53], v[32:33] op_sel:[0,1] op_sel_hi:[1,1]
  v_pk_mul_f32 v[54:55], v[54:55], v[32:33] op_sel:[0,1] op_sel_hi:[1,1]
  v_pk_mul_f32 v[56:57], v[56:57], v[32:33] op_sel:[0,1] op_sel_hi:[1,1]
  v_pk_mul_f32 v[58:59], v[58:59], v[32:33] op_sel:[0,1] op_sel_hi:[1,1]
  v_pk_mul_f32 v[60:61], v[60:61], v[32:33] op_sel:[0,1] op_sel_hi:[1,1]
  v_pk_mul_f32 v[62:63], v[62:63], v[32:33] op_sel:[0,1] op_sel_hi:[1,1]
  v_cvt_pk_bf16_f32 v96, v48, v49
  v_cvt_pk_bf16_f32 v97, v50, v51
  v_cvt_pk_bf16_f32 v98, v52, v53
  v_cvt_pk_bf16_f32 v99, v54, v55
  v_cvt_pk_bf16_f32 v100, v56, v57
  v_cvt_pk_bf16_f32 v101, v58, v59
  v_cvt_pk_bf16_f32 v102, v60, v61
  v_cvt_pk_bf16_f32 v103, v62, v63
  s_cmp_eq_u32 s40, 0
  s_cselect_b64 vcc, -1, 0
  v_cndmask_b32 v112, v8, v4, vcc
  v_cndmask_b32 v113, v9, v5, vcc
  v_cndmask_b32 v114, v10, v6, vcc
  v_cndmask_b32 v115, v11, v7, vcc
  s_nop 1
  v_mfma_f32_32x32x16_bf16 v[48:63], v[112:115], v[96:99], 0
  v_pk_fma_f32 v[64:65], v[80:81], v[34:35], v[64:65] op_sel_hi:[1,0,1] neg_lo:[0,1,0] neg_hi:[0,1,0]
  v_pk_fma_f32 v[66:67], v[82:83], v[34:35], v[66:67] op_sel_hi:[1,0,1] neg_lo:[0,1,0] neg_hi:[0,1,0]
  v_pk_fma_f32 v[68:69], v[84:85], v[34:35], v[68:69] op_sel_hi:[1,0,1] neg_lo:[0,1,0] neg_hi:[0,1,0]
  v_pk_fma_f32 v[70:71], v[86:87], v[34:35], v[70:71] op_sel_hi:[1,0,1] neg_lo:[0,1,0] neg_hi:[0,1,0]
  v_pk_fma_f32 v[72:73], v[88:89], v[34:35], v[72:73] op_sel_hi:[1,0,1] neg_lo:[0,1,0] neg_hi:[0,1,0]
  v_pk_fma_f32 v[74:75], v[90:91], v[34:35], v[74:75] op_sel_hi:[1,0,1] neg_lo:[0,1,0] neg_hi:[0,1,0]
  v_pk_fma_f32 v[76:77], v[92:93], v[34:35], v[76:77] op_sel_hi:[1,0,1] neg_lo:[0,1,0] neg_hi:[0,1,0]
  v_pk_fma_f32 v[78:79], v[94:95], v[34:35], v[78:79] op_sel_hi:[1,0,1] neg_lo:[0,1,0] neg_hi:[0,1,0]
  v_pk_mul_f32 v[64:65], v[64:65], v[34:35] op_sel:[0,1] op_sel_hi:[1,1]
  v_pk_mul_f32 v[66:67], v[66:67], v[34:35] op_sel:[0,1] op_sel_hi:[1,1]
  v_pk_mul_f32 v[68:69], v[68:69], v[34:35] op_sel:[0,1] op_sel_hi:[1,1]
  v_pk_mul_f32 v[70:71], v[70:71], v[34:35] op_sel:[0,1] op_sel_hi:[1,1]
  v_pk_mul_f32 v[72:73], v[72:73], v[34:35] op_sel:[0,1] op_sel_hi:[1,1]
  v_pk_mul_f32 v[74:75], v[74:75], v[34:35] op_sel:[0,1] op_sel_hi:[1,1]
  v_pk_mul_f32 v[76:77], v[76:77], v[34:35] op_sel:[0,1] op_sel_hi:[1,1]
  v_pk_mul_f32 v[78:79], v[78:79], v[34:35] op_sel:[0,1] op_sel_hi:[1,1]
  v_cvt_pk_bf16_f32 v104, v64, v65
  v_cvt_pk_bf16_f32 v105, v66, v67
  v_cvt_pk_bf16_f32 v106, v68, v69
  v_cvt_pk_bf16_f32 v107, v70, v71
  v_cvt_pk_bf16_f32 v108, v72, v73
  v_cvt_pk_bf16_f32 v109, v74, v75
  v_cvt_pk_bf16_f32 v110, v76, v77
  v_cvt_pk_bf16_f32 v111, v78, v79
  v_mfma_f32_32x32x16_bf16 v[64:79], v[112:115], v[104:107], 0
  ds_write_b64 v17, v[100:101]
  ds_write_b64 v17, v[102:103] offset:16
  ds_write_b64 v18, v[108:109]
  ds_write_b64 v18, v[110:111] offset:16
  v_max3_f32 v112, v48, v49, v50
  v_max3_f32 v113, v51, v52, v53
  v_max3_f32 v112, v112, v54, v55
  v_max3_f32 v113, v113, v56, v57
  v_max3_f32 v112, v112, v58, v59
  v_max3_f32 v113, v113, v60, v61
  v_max3_f32 v112, v112, v62, v63
  v_mov_b32 v114, 0x3fb8aa3b
  v_max_f32 v112, v112, v113
  v_mul_f32 v112, v114, v112
  v_max3_f32 v116, v64, v65, v66
  v_pk_fma_f32 v[48:49], v[48:49], v[114:115], v[112:113] op_sel_hi:[1,0,0] neg_lo:[0,0,1] neg_hi:[0,0,1]
  v_max3_f32 v117, v67, v68, v69
  v_pk_fma_f32 v[50:51], v[50:51], v[114:115], v[112:113] op_sel_hi:[1,0,0] neg_lo:[0,0,1] neg_hi:[0,0,1]
  v_max3_f32 v116, v116, v70, v71
  v_pk_fma_f32 v[52:53], v[52:53], v[114:115], v[112:113] op_sel_hi:[1,0,0] neg_lo:[0,0,1] neg_hi:[0,0,1]
  v_max3_f32 v117, v117, v72, v73
  v_pk_fma_f32 v[54:55], v[54:55], v[114:115], v[112:113] op_sel_hi:[1,0,0] neg_lo:[0,0,1] neg_hi:[0,0,1]
  v_max3_f32 v116, v116, v74, v75
  v_max3_f32 v117, v117, v76, v77
  v_pk_fma_f32 v[56:57], v[56:57], v[114:115], v[112:113] op_sel_hi:[1,0,0] neg_lo:[0,0,1] neg_hi:[0,0,1]
  v_max3_f32 v116, v116, v78, v79
  v_pk_fma_f32 v[58:59], v[58:59], v[114:115], v[112:113] op_sel_hi:[1,0,0] neg_lo:[0,0,1] neg_hi:[0,0,1]
  v_mov_b32 v118, 0x3fb8aa3b
  v_pk_fma_f32 v[60:61], v[60:61], v[114:115], v[112:113] op_sel_hi:[1,0,0] neg_lo:[0,0,1] neg_hi:[0,0,1]
  v_max_f32 v116, v116, v117
  v_pk_fma_f32 v[62:63], v[62:63], v[114:115], v[112:113] op_sel_hi:[1,0,0] neg_lo:[0,0,1] neg_hi:[0,0,1]
  v_mul_f32 v116, v118, v116
  v_exp_f32 v48, v48
  v_pk_fma_f32 v[64:65], v[64:65], v[118:119], v[116:117] op_sel_hi:[1,0,0] neg_lo:[0,0,1] neg_hi:[0,0,1]
  v_pk_fma_f32 v[66:67], v[66:67], v[118:119], v[116:117] op_sel_hi:[1,0,0] neg_lo:[0,0,1] neg_hi:[0,0,1]
  v_exp_f32 v49, v49
  v_pk_fma_f32 v[68:69], v[68:69], v[118:119], v[116:117] op_sel_hi:[1,0,0] neg_lo:[0,0,1] neg_hi:[0,0,1]
  v_exp_f32 v50, v50
  v_pk_fma_f32 v[70:71], v[70:71], v[118:119], v[116:117] op_sel_hi:[1,0,0] neg_lo:[0,0,1] neg_hi:[0,0,1]
  v_exp_f32 v51, v51
  v_pk_fma_f32 v[72:73], v[72:73], v[118:119], v[116:117] op_sel_hi:[1,0,0] neg_lo:[0,0,1] neg_hi:[0,0,1]
  v_exp_f32 v52, v52
  v_pk_fma_f32 v[74:75], v[74:75], v[118:119], v[116:117] op_sel_hi:[1,0,0] neg_lo:[0,0,1] neg_hi:[0,0,1]
  v_exp_f32 v53, v53
  v_pk_fma_f32 v[76:77], v[76:77], v[118:119], v[116:117] op_sel_hi:[1,0,0] neg_lo:[0,0,1] neg_hi:[0,0,1]
  v_pk_fma_f32 v[78:79], v[78:79], v[118:119], v[116:117] op_sel_hi:[1,0,0] neg_lo:[0,0,1] neg_hi:[0,0,1]
  v_exp_f32 v54, v54
  v_exp_f32 v64, v64
  v_exp_f32 v55, v55
  v_exp_f32 v65, v65
  v_exp_f32 v56, v56
  v_exp_f32 v66, v66
  v_exp_f32 v57, v57
  v_exp_f32 v67, v67
  v_exp_f32 v58, v58
  v_exp_f32 v68, v68
  v_exp_f32 v69, v69
  v_exp_f32 v59, v59
  v_exp_f32 v70, v70
  v_exp_f32 v60, v60
  v_exp_f32 v71, v71
  v_exp_f32 v61, v61
  v_exp_f32 v72, v72
  v_exp_f32 v62, v62
  v_exp_f32 v73, v73
  v_exp_f32 v63, v63
  v_exp_f32 v74, v74
  v_exp_f32 v75, v75
  v_pk_add_f32 v[114:115], v[48:49], v[50:51]
  v_exp_f32 v76, v76
  v_pk_add_f32 v[112:113], v[52:53], v[54:55]
  v_exp_f32 v77, v77
  v_pk_add_f32 v[114:115], v[114:115], v[56:57]
  v_exp_f32 v78, v78
  v_pk_add_f32 v[112:113], v[112:113], v[58:59]
  v_exp_f32 v79, v79
  v_pk_add_f32 v[114:115], v[114:115], v[60:61]
  v_pk_add_f32 v[118:119], v[64:65], v[66:67]
  v_pk_add_f32 v[116:117], v[68:69], v[70:71]
  v_pk_add_f32 v[112:113], v[112:113], v[62:63]
  v_pk_add_f32 v[118:119], v[118:119], v[72:73]
  v_pk_add_f32 v[114:115], v[114:115], v[112:113]
  v_pk_add_f32 v[116:117], v[116:117], v[74:75]
  v_add_f32 v114, v114, v115
  v_pk_add_f32 v[118:119], v[118:119], v[76:77]
  v_rcp_f32 v114, v114
  v_pk_add_f32 v[116:117], v[116:117], v[78:79]
  v_pk_mul_f32 v[48:49], v[48:49], v[114:115] op_sel_hi:[1,0]
  v_pk_add_f32 v[118:119], v[118:119], v[116:117]
  v_add_f32 v118, v118, v119
  v_pk_mul_f32 v[50:51], v[50:51], v[114:115] op_sel_hi:[1,0]
  v_rcp_f32 v118, v118
  v_pk_mul_f32 v[52:53], v[52:53], v[114:115] op_sel_hi:[1,0]
  v_pk_mul_f32 v[64:65], v[64:65], v[118:119] op_sel_hi:[1,0]
  v_pk_mul_f32 v[54:55], v[54:55], v[114:115] op_sel_hi:[1,0]
  v_pk_mul_f32 v[66:67], v[66:67], v[118:119] op_sel_hi:[1,0]
  v_pk_mul_f32 v[56:57], v[56:57], v[114:115] op_sel_hi:[1,0]
  v_pk_mul_f32 v[68:69], v[68:69], v[118:119] op_sel_hi:[1,0]
  v_pk_mul_f32 v[58:59], v[58:59], v[114:115] op_sel_hi:[1,0]
  v_pk_mul_f32 v[70:71], v[70:71], v[118:119] op_sel_hi:[1,0]
  v_pk_mul_f32 v[72:73], v[72:73], v[118:119] op_sel_hi:[1,0]
  v_pk_mul_f32 v[60:61], v[60:61], v[114:115] op_sel_hi:[1,0]
  v_pk_mul_f32 v[74:75], v[74:75], v[118:119] op_sel_hi:[1,0]
  v_pk_mul_f32 v[62:63], v[62:63], v[114:115] op_sel_hi:[1,0]
  v_pk_mul_f32 v[76:77], v[76:77], v[118:119] op_sel_hi:[1,0]
  v_cvt_pk_bf16_f32 v80, v48, v49
  v_pk_mul_f32 v[78:79], v[78:79], v[118:119] op_sel_hi:[1,0]
  v_cvt_pk_bf16_f32 v81, v50, v51
  v_cvt_pk_bf16_f32 v88, v64, v65
  v_cvt_pk_bf16_f32 v82, v52, v53
  v_cvt_pk_bf16_f32 v89, v66, v67
  v_cvt_pk_bf16_f32 v90, v68, v69
  v_cvt_pk_bf16_f32 v83, v54, v55
  v_cvt_pk_bf16_f32 v91, v70, v71
  v_cvt_pk_bf16_f32 v84, v56, v57
  v_cvt_pk_bf16_f32 v92, v72, v73
  v_cvt_pk_bf16_f32 v85, v58, v59
  v_cvt_pk_bf16_f32 v93, v74, v75
  v_cvt_pk_bf16_f32 v86, v60, v61
  v_cvt_pk_bf16_f32 v94, v76, v77
  v_cvt_pk_bf16_f32 v87, v62, v63
  v_cvt_pk_bf16_f32 v95, v78, v79
  ds_write_b128 v15, v[80:83]
  ds_write_b128 v15, v[84:87] offset:16
  ds_write_b128 v16, v[88:91]
  ds_write_b128 v16, v[92:95] offset:16
  ds_read_b64_tr_b16 v[64:65], v23 offset:0
  ds_read_b64_tr_b16 v[66:67], v26 offset:0
  ds_read_b64_tr_b16 v[68:69], v23 offset:1024
  ds_read_b64_tr_b16 v[70:71], v26 offset:1024
  v_mov_b32 v88, 0
  v_mov_b32 v89, 0
  v_mov_b32 v22, 0x3f803f80
  ds_read_b64_tr_b16 v[48:49], v19 offset:0
  ds_read_b64_tr_b16 v[50:51], v19 offset:320
  ds_read_b64_tr_b16 v[56:57], v19 offset:32
  ds_read_b64_tr_b16 v[58:59], v19 offset:352
  ds_read_b64_tr_b16 v[52:53], v19 offset:2560
  ds_read_b64_tr_b16 v[54:55], v19 offset:2880
  ds_read_b64_tr_b16 v[60:61], v19 offset:2592
  ds_read_b64_tr_b16 v[62:63], v19 offset:2912
  v_mov_b32 v97, s38
  v_mov_b32 v99, s38
  v_mov_b32 v101, s38
  v_mov_b32 v103, s38
  s_waitcnt lgkmcnt(4)
  v_mfma_f32_16x16x32_bf16 v[80:83], v[48:51], v[64:67], 0
  v_mfma_f32_16x16x32_bf16 v[84:87], v[56:59], v[64:67], 0
  s_waitcnt lgkmcnt(0)
  v_mfma_f32_16x16x32_bf16 v[80:83], v[52:55], v[68:71], v[80:83]
  v_mfma_f32_16x16x32_bf16 v[84:87], v[60:63], v[68:71], v[84:87]
  v_dot2c_f32_bf16 v88, v48, v22
  v_dot2c_f32_bf16 v89, v56, v22
  v_dot2c_f32_bf16 v88, v49, v22
  v_dot2c_f32_bf16 v89, v57, v22
  v_dot2c_f32_bf16 v88, v50, v22
  v_dot2c_f32_bf16 v89, v58, v22
  v_dot2c_f32_bf16 v88, v51, v22
  v_dot2c_f32_bf16 v89, v59, v22
  v_dot2c_f32_bf16 v88, v52, v22
  v_dot2c_f32_bf16 v89, v60, v22
  v_dot2c_f32_bf16 v88, v53, v22
  v_dot2c_f32_bf16 v89, v61, v22
  v_dot2c_f32_bf16 v88, v54, v22
  v_dot2c_f32_bf16 v89, v62, v22
  v_dot2c_f32_bf16 v88, v55, v22
  v_dot2c_f32_bf16 v89, v63, v22
  v_cvt_pk_bf16_f32 v96, v80, v81
  v_cvt_pk_bf16_f32 v98, v82, v83
  buffer_store_dwordx4 v[96:99], v27, s[88:91], 0 offen offset:0 sc1
  v_cvt_pk_bf16_f32 v100, v84, v85
  v_cvt_pk_bf16_f32 v102, v86, v87
  buffer_store_dwordx4 v[100:103], v27, s[88:91], 0 offen offset:64 sc1
  v_mov_b32 v90, v88
  s_nop 1
  v_permlane32_swap_b32 v88, v90
  v_add_f32 v88, v88, v90
  v_mov_b32 v90, v88
  s_nop 1
  v_permlane16_swap_b32 v88, v90
  v_add_f32 v88, v88, v90
  v_mov_b32 v90, v89
  s_nop 1
  v_permlane32_swap_b32 v89, v90
  v_add_f32 v89, v89, v90
  v_mov_b32 v90, v89
  s_nop 1
  v_permlane16_swap_b32 v89, v90
  v_add_f32 v89, v89, v90
  v_and_b32 v90, 16, v1
  v_cmp_eq_u32 vcc, 0, v90
  s_nop 1
  v_cndmask_b32 v88, v89, v88, vcc
  v_cvt_pk_bf16_f32 v88, v88, 0
  v_mov_b32 v89, s38
  s_mov_b32 exec_lo, -1
  s_mov_b32 exec_hi, 0
  buffer_store_dwordx2 v[88:89], v120, s[88:91], 0 offen sc1
  s_mov_b64 exec, -1
  s_xor_b32 s45, s40, 1
  v_bfe_u32 v24, v1, 2, 2
  v_lshlrev_b32 v24, 6, v24
  v_lshl_add_u32 v24, v2, 10, v24
  v_bfe_u32 v25, v1, 4, 1
  v_lshl_add_u32 v24, v25, 5, v24
  v_and_b32 v25, 3, v1
  v_lshl_add_u32 v24, v25, 3, v24
  s_lshl_b32 s44, s40, 8
  s_lshl_b32 s45, s45, 8
  v_add_u32 v112, s44, v24
  ds_read_b64_tr_b16 v[80:81], v112 offset:0
  ds_read_b64_tr_b16 v[82:83], v112 offset:512
  ds_read_b64_tr_b16 v[84:85], v112 offset:2048
  ds_read_b64_tr_b16 v[86:87], v112 offset:2560
  ds_read_b64_tr_b16 v[88:89], v112 offset:4096
  ds_read_b64_tr_b16 v[90:91], v112 offset:4608
  s_lshl_b32 s44, s34, 5
  s_lshl_b32 s45, s30, 3
  s_add_u32 s44, s44, s45
  s_mul_i32 s44, s44, 9216
  s_mul_i32 s45, s33, 288
  s_add_u32 s44, s44, s45
  s_add_u32 s44, s44, 3407872
  v_min_u32 v116, 35, v1
  v_lshlrev_b32 v116, 3, v116
  v_add_u32 v116, s44, v116
  s_lshl_b32 s48, s41, 7
  ds_read_b64_tr_b16 v[92:93], v112 offset:6144
  ds_read_b64_tr_b16 v[94:95], v112 offset:6656
  s_waitcnt lgkmcnt(6)
  v_mfma_f32_32x32x16_bf16 v[48:63], a[128:131], v[80:83], 0
  ds_read_b64_tr_b16 v[80:81], v112 offset:8192
  ds_read_b64_tr_b16 v[82:83], v112 offset:8704
  s_waitcnt lgkmcnt(6)
  v_mfma_f32_32x32x16_bf16 v[48:63], a[132:135], v[84:87], v[48:63]
  ds_read_b64_tr_b16 v[84:85], v112 offset:10240
  ds_read_b64_tr_b16 v[86:87], v112 offset:10752
  s_waitcnt lgkmcnt(6)
  v_mfma_f32_32x32x16_bf16 v[48:63], a[136:139], v[88:91], v[48:63]
  s_and_b32 s44, s34, 1
  s_lshl_b32 s45, s36, 5
  s_lshl_b32 s46, s30, 3
  s_add_u32 s45, s45, s46
  s_lshl_b32 s45, s45, 9
  s_lshl_b32 s44, s44, 8
  s_add_u32 s44, s44, s45
  v_bfe_u32 v104, v1, 2, 2
  v_lshlrev_b32 v104, 6, v104
  v_lshl_add_u32 v104, v2, 9, v104
  v_bfe_u32 v105, v1, 4, 1
  v_lshl_add_u32 v104, v105, 5, v104
  v_and_b32 v105, 3, v1
  v_lshl_add_u32 v104, v105, 3, v104
  v_add_u32 v104, s44, v104
  ds_read_b64_tr_b16 v[12:13], v104 offset:0
  ds_read_b64_tr_b16 v[14:15], v104 offset:1024
  ds_read_b64_tr_b16 v[16:17], v104 offset:2048
  ds_read_b64_tr_b16 v[18:19], v104 offset:3072
  ds_read_b64_tr_b16 v[88:89], v112 offset:12288
  ds_read_b64_tr_b16 v[90:91], v112 offset:12800
  s_waitcnt lgkmcnt(10)
  v_mfma_f32_32x32x16_bf16 v[48:63], a[140:143], v[92:95], v[48:63]
  ds_read_b64_tr_b16 v[92:93], v112 offset:14336
  ds_read_b64_tr_b16 v[94:95], v112 offset:14848
  s_waitcnt lgkmcnt(10)
  v_mfma_f32_32x32x16_bf16 v[48:63], a[144:147], v[80:83], v[48:63]
  ds_read_b64_tr_b16 v[80:81], v112 offset:16384
  ds_read_b64_tr_b16 v[82:83], v112 offset:16896
  s_waitcnt lgkmcnt(10)
  v_mfma_f32_32x32x16_bf16 v[48:63], a[148:151], v[84:87], v[48:63]
  ds_read_b64_tr_b16 v[84:85], v112 offset:18432
  ds_read_b64_tr_b16 v[86:87], v112 offset:18944
  s_waitcnt lgkmcnt(6)
  v_mfma_f32_32x32x16_bf16 v[48:63], a[152:155], v[88:91], v[48:63]
  ds_read_b64_tr_b16 v[88:89], v112 offset:20480
  ds_read_b64_tr_b16 v[90:91], v112 offset:20992
  s_waitcnt lgkmcnt(6)
  v_mfma_f32_32x32x16_bf16 v[48:63], a[156:159], v[92:95], v[48:63]
  ds_read_b64_tr_b16 v[92:93], v112 offset:22528
  ds_read_b64_tr_b16 v[94:95], v112 offset:23040
  s_waitcnt lgkmcnt(6)
  v_mfma_f32_32x32x16_bf16 v[48:63], a[160:163], v[80:83], v[48:63]
  ds_read_b64_tr_b16 v[80:81], v112 offset:24576
  ds_read_b64_tr_b16 v[82:83], v112 offset:25088
  s_waitcnt lgkmcnt(6)
  v_mfma_f32_32x32x16_bf16 v[48:63], a[164:167], v[84:87], v[48:63]
  ds_read_b64_tr_b16 v[84:85], v112 offset:26624
  ds_read_b64_tr_b16 v[86:87], v112 offset:27136
  s_waitcnt lgkmcnt(6)
  v_mfma_f32_32x32x16_bf16 v[48:63], a[168:171], v[88:91], v[48:63]
  ds_read_b64_tr_b16 v[88:89], v112 offset:28672
  ds_read_b64_tr_b16 v[90:91], v112 offset:29184
  s_waitcnt lgkmcnt(6)
  v_mfma_f32_32x32x16_bf16 v[48:63], a[172:175], v[92:95], v[48:63]
  ds_read_b64_tr_b16 v[92:93], v112 offset:30720
  ds_read_b64_tr_b16 v[94:95], v112 offset:31232
  s_waitcnt lgkmcnt(6)
  v_mfma_f32_32x32x16_bf16 v[48:63], a[176:179], v[80:83], v[48:63]
  ds_read_b64_tr_b16 v[80:81], v112 offset:32768
  ds_read_b64_tr_b16 v[82:83], v112 offset:33280
  s_waitcnt lgkmcnt(6)
  v_mfma_f32_32x32x16_bf16 v[48:63], a[180:183], v[84:87], v[48:63]
  ds_read_b64_tr_b16 v[84:85], v112 offset:34816
  ds_read_b64_tr_b16 v[86:87], v112 offset:35328
  s_waitcnt lgkmcnt(6)
  v_mfma_f32_32x32x16_bf16 v[48:63], a[184:187], v[88:91], v[48:63]
  ds_read_b64_tr_b16 v[88:89], v112 offset:36864
  ds_read_b64_tr_b16 v[90:91], v112 offset:37376
  s_waitcnt lgkmcnt(6)
  v_mfma_f32_32x32x16_bf16 v[48:63], a[188:191], v[92:95], v[48:63]
  ds_read_b64_tr_b16 v[92:93], v112 offset:38912
  ds_read_b64_tr_b16 v[94:95], v112 offset:39424
  s_waitcnt lgkmcnt(6)
  v_mfma_f32_32x32x16_bf16 v[48:63], a[192:195], v[80:83], v[48:63]
  ds_read_b64_tr_b16 v[80:81], v112 offset:40960
  ds_read_b64_tr_b16 v[82:83], v112 offset:41472
  s_waitcnt lgkmcnt(6)
  v_mfma_f32_32x32x16_bf16 v[48:63], a[196:199], v[84:87], v[48:63]
  ds_read_b64_tr_b16 v[84:85], v112 offset:43008
  ds_read_b64_tr_b16 v[86:87], v112 offset:43520
  s_waitcnt lgkmcnt(6)
  v_mfma_f32_32x32x16_bf16 v[48:63], a[200:203], v[88:91], v[48:63]
  ds_read_b64_tr_b16 v[88:89], v112 offset:45056
  ds_read_b64_tr_b16 v[90:91], v112 offset:45568
  s_waitcnt lgkmcnt(6)
  v_mfma_f32_32x32x16_bf16 v[48:63], a[204:207], v[92:95], v[48:63]
  ds_read_b64_tr_b16 v[92:93], v112 offset:47104
  ds_read_b64_tr_b16 v[94:95], v112 offset:47616
  s_waitcnt lgkmcnt(6)
  v_mfma_f32_32x32x16_bf16 v[48:63], a[208:211], v[80:83], v[48:63]
  ds_read_b64_tr_b16 v[80:81], v112 offset:49152
  ds_read_b64_tr_b16 v[82:83], v112 offset:49664
  s_waitcnt lgkmcnt(6)
  v_mfma_f32_32x32x16_bf16 v[48:63], a[212:215], v[84:87], v[48:63]
  ds_read_b64_tr_b16 v[84:85], v112 offset:51200
  ds_read_b64_tr_b16 v[86:87], v112 offset:51712
  s_waitcnt lgkmcnt(6)
  v_mfma_f32_32x32x16_bf16 v[48:63], a[216:219], v[88:91], v[48:63]
  ds_read_b64_tr_b16 v[88:89], v112 offset:53248
  ds_read_b64_tr_b16 v[90:91], v112 offset:53760
  s_waitcnt lgkmcnt(6)
  v_mfma_f32_32x32x16_bf16 v[48:63], a[220:223], v[92:95], v[48:63]
  ds_read_b64_tr_b16 v[92:93], v112 offset:55296
  ds_read_b64_tr_b16 v[94:95], v112 offset:55808
  s_waitcnt lgkmcnt(6)
  v_mfma_f32_32x32x16_bf16 v[48:63], a[224:227], v[80:83], v[48:63]
  v_lshlrev_b32 v30, 4, v2
  v_add_u32 v30, 108032, v30
  v_add_u32 v30, s48, v30
  ds_read_b128 v[64:67], v30 offset:0
  ds_read_b128 v[68:71], v30 offset:32
  ds_read_b128 v[72:75], v30 offset:64
  ds_read_b128 v[76:79], v30 offset:96
  ds_read_b64_tr_b16 v[80:81], v112 offset:57344
  ds_read_b64_tr_b16 v[82:83], v112 offset:57856
  s_waitcnt lgkmcnt(10)
  v_mfma_f32_32x32x16_bf16 v[48:63], a[228:231], v[84:87], v[48:63]
  ds_read_b64_tr_b16 v[84:85], v112 offset:59392
  ds_read_b64_tr_b16 v[86:87], v112 offset:59904
  s_waitcnt lgkmcnt(10)
  v_mfma_f32_32x32x16_bf16 v[48:63], a[232:235], v[88:91], v[48:63]
  ds_read_b64_tr_b16 v[88:89], v112 offset:61440
  ds_read_b64_tr_b16 v[90:91], v112 offset:61952
  s_waitcnt lgkmcnt(10)
  v_mfma_f32_32x32x16_bf16 v[48:63], a[236:239], v[92:95], v[48:63]
  v_add_u32 v117, 0, v116
  buffer_load_dwordx2 v[96:97], v117, s[88:91], 0 offen sc1
  v_add_u32 v117, 9216, v116
  buffer_load_dwordx2 v[98:99], v117, s[88:91], 0 offen sc1
  v_add_u32 v117, 18432, v116
  buffer_load_dwordx2 v[100:101], v117, s[88:91], 0 offen sc1
  v_add_u32 v117, 27648, v116
  buffer_load_dwordx2 v[102:103], v117, s[88:91], 0 offen sc1
  v_add_u32 v117, 36864, v116
  buffer_load_dwordx2 v[104:105], v117, s[88:91], 0 offen sc1
  v_add_u32 v117, 46080, v116
  buffer_load_dwordx2 v[106:107], v117, s[88:91], 0 offen sc1
  v_add_u32 v117, 55296, v116
  buffer_load_dwordx2 v[108:109], v117, s[88:91], 0 offen sc1
  v_add_u32 v117, 64512, v116
  buffer_load_dwordx2 v[110:111], v117, s[88:91], 0 offen sc1
  ds_read_b64_tr_b16 v[92:93], v112 offset:63488
  ds_read_b64_tr_b16 v[94:95], v112 offset:64000
  s_waitcnt lgkmcnt(6)
  v_mfma_f32_32x32x16_bf16 v[48:63], a[240:243], v[80:83], v[48:63]
  s_waitcnt lgkmcnt(4)
  v_mfma_f32_32x32x16_bf16 v[48:63], a[244:247], v[84:87], v[48:63]
  s_waitcnt lgkmcnt(2)
  v_mfma_f32_32x32x16_bf16 v[48:63], a[248:251], v[88:91], v[48:63]
  s_waitcnt lgkmcnt(0)
  v_mfma_f32_32x32x16_bf16 v[48:63], a[252:255], v[92:95], v[48:63]
  s_waitcnt lgkmcnt(0)
  s_nop 10
  v_pk_fma_f32 v[48:49], v[64:65], v[32:33], v[48:49] op_sel_hi:[1,0,1] neg_lo:[0,1,0] neg_hi:[0,1,0]
  v_pk_fma_f32 v[50:51], v[66:67], v[32:33], v[50:51] op_sel_hi:[1,0,1] neg_lo:[0,1,0] neg_hi:[0,1,0]
  v_pk_fma_f32 v[52:53], v[68:69], v[32:33], v[52:53] op_sel_hi:[1,0,1] neg_lo:[0,1,0] neg_hi:[0,1,0]
  v_pk_fma_f32 v[54:55], v[70:71], v[32:33], v[54:55] op_sel_hi:[1,0,1] neg_lo:[0,1,0] neg_hi:[0,1,0]
  v_pk_fma_f32 v[56:57], v[72:73], v[32:33], v[56:57] op_sel_hi:[1,0,1] neg_lo:[0,1,0] neg_hi:[0,1,0]
  v_pk_fma_f32 v[58:59], v[74:75], v[32:33], v[58:59] op_sel_hi:[1,0,1] neg_lo:[0,1,0] neg_hi:[0,1,0]
  v_pk_fma_f32 v[60:61], v[76:77], v[32:33], v[60:61] op_sel_hi:[1,0,1] neg_lo:[0,1,0] neg_hi:[0,1,0]
  v_pk_fma_f32 v[62:63], v[78:79], v[32:33], v[62:63] op_sel_hi:[1,0,1] neg_lo:[0,1,0] neg_hi:[0,1,0]
  v_pk_mul_f32 v[48:49], v[48:49], v[32:33] op_sel:[0,1] op_sel_hi:[1,1]
  v_pk_mul_f32 v[50:51], v[50:51], v[32:33] op_sel:[0,1] op_sel_hi:[1,1]
  v_pk_mul_f32 v[52:53], v[52:53], v[32:33] op_sel:[0,1] op_sel_hi:[1,1]
  v_pk_mul_f32 v[54:55], v[54:55], v[32:33] op_sel:[0,1] op_sel_hi:[1,1]
  v_pk_mul_f32 v[56:57], v[56:57], v[32:33] op_sel:[0,1] op_sel_hi:[1,1]
  v_pk_mul_f32 v[58:59], v[58:59], v[32:33] op_sel:[0,1] op_sel_hi:[1,1]
  v_pk_mul_f32 v[60:61], v[60:61], v[32:33] op_sel:[0,1] op_sel_hi:[1,1]
  v_pk_mul_f32 v[62:63], v[62:63], v[32:33] op_sel:[0,1] op_sel_hi:[1,1]
  v_cvt_pk_bf16_f32 v20, v48, v49
  v_cvt_pk_bf16_f32 v21, v50, v51
  v_cvt_pk_bf16_f32 v22, v52, v53
  v_cvt_pk_bf16_f32 v23, v54, v55
  v_cvt_pk_bf16_f32 v24, v56, v57
  v_cvt_pk_bf16_f32 v25, v58, v59
  v_cvt_pk_bf16_f32 v26, v60, v61
  v_cvt_pk_bf16_f32 v27, v62, v63
  v_mfma_f32_32x32x16_bf16 v[48:63], v[4:7], v[20:23], 0
  s_nop 0
  v_mfma_f32_32x32x16_bf16 v[64:79], v[8:11], v[24:27], 0
  s_mov_b32 s46, 0
L_h1poll_28:
  s_waitcnt vmcnt(0)
  v_mov_b32 v80, 0
  v_sad_u32 v80, v97, s38, v80
  v_sad_u32 v80, v99, s38, v80
  v_sad_u32 v80, v101, s38, v80
  v_sad_u32 v80, v103, s38, v80
  v_sad_u32 v80, v105, s38, v80
  v_sad_u32 v80, v107, s38, v80
  v_sad_u32 v80, v109, s38, v80
  v_sad_u32 v80, v111, s38, v80
  s_add_u32 s46, s46, 1
  s_cmp_gt_u32 s46, 40000
  s_cbranch_scc1 L_h1done_29
  v_cmp_ne_u32 vcc, 0, v80
  s_nop 4
  s_cbranch_vccz L_h1done_29
  s_sleep 4
  v_add_u32 v117, 0, v116
  buffer_load_dwordx2 v[96:97], v117, s[88:91], 0 offen sc1
  v_add_u32 v117, 9216, v116
  buffer_load_dwordx2 v[98:99], v117, s[88:91], 0 offen sc1
  v_add_u32 v117, 18432, v116
  buffer_load_dwordx2 v[100:101], v117, s[88:91], 0 offen sc1
  v_add_u32 v117, 27648, v116
  buffer_load_dwordx2 v[102:103], v117, s[88:91], 0 offen sc1
  v_add_u32 v117, 36864, v116
  buffer_load_dwordx2 v[104:105], v117, s[88:91], 0 offen sc1
  v_add_u32 v117, 46080, v116
  buffer_load_dwordx2 v[106:107], v117, s[88:91], 0 offen sc1
  v_add_u32 v117, 55296, v116
  buffer_load_dwordx2 v[108:109], v117, s[88:91], 0 offen sc1
  v_add_u32 v117, 64512, v116
  buffer_load_dwordx2 v[110:111], v117, s[88:91], 0 offen sc1
  s_branch L_h1poll_28
L_h1done_29:
  v_mov_b32 v92, 0x00003f80
  v_mov_b32 v93, 0x3f800000
  v_mov_b32 v80, 0
  v_mov_b32 v81, 0
  v_dot2c_f32_bf16 v80, v96, v92
  v_dot2c_f32_bf16 v81, v96, v93
  v_dot2c_f32_bf16 v80, v98, v92
  v_dot2c_f32_bf16 v81, v98, v93
  v_dot2c_f32_bf16 v80, v100, v92
  v_dot2c_f32_bf16 v81, v100, v93
  v_dot2c_f32_bf16 v80, v102, v92
  v_dot2c_f32_bf16 v81, v102, v93
  v_dot2c_f32_bf16 v80, v104, v92
  v_dot2c_f32_bf16 v81, v104, v93
  v_dot2c_f32_bf16 v80, v106, v92
  v_dot2c_f32_bf16 v81, v106, v93
  v_dot2c_f32_bf16 v80, v108, v92
  v_dot2c_f32_bf16 v81, v108, v93
  v_dot2c_f32_bf16 v80, v110, v92
  v_dot2c_f32_bf16 v81, v110, v93
  v_lshlrev_b32 v82, 3, v1
  s_lshl_b32 s44, s30, 9
  s_add_u32 s44, s44, 95232
  v_add_u32 v83, s44, v82
  ds_write_b64 v83, v[80:81]
  s_waitcnt lgkmcnt(0)
  s_barrier
  s_cmp_lg_u32 s30, 0
  s_cbranch_scc1 L_h1pub_30
  v_add_u32 v83, 95232, v82
  ds_read_b64 v[84:85], v83 offset:0
  ds_read_b64 v[86:87], v83 offset:512
  ds_read_b64 v[88:89], v83 offset:1024
  ds_read_b64 v[90:91], v83 offset:1536
  s_mul_i32 s44, s34, 9216
  s_mul_i32 s45, s33, 288
  s_add_u32 s44, s44, s45
  s_add_u32 s44, s44, 401408
  v_add_u32 v82, s44, v82
  s_waitcnt lgkmcnt(0)
  v_pk_add_f32 v[84:85], v[84:85], v[86:87]
  v_pk_add_f32 v[88:89], v[88:89], v[90:91]
  v_pk_add_f32 v[84:85], v[84:85], v[88:89]
  v_cvt_pk_bf16_f32 v84, v84, v85
  v_mov_b32 v85, s38
  s_mov_b32 exec_lo, -1
  s_mov_b32 exec_hi, 0xf
  buffer_store_dwordx2 v[84:85], v82, s[88:91], 0 offen sc1
  s_mov_b64 exec, -1
L_h1pub_30:
  v_max3_f32 v80, v48, v49, v50
  v_max3_f32 v84, v64, v65, v66
  v_max3_f32 v81, v51, v52, v53
  v_max3_f32 v85, v67, v68, v69
  v_max3_f32 v80, v80, v54, v55
  v_max3_f32 v84, v84, v70, v71
  v_max3_f32 v81, v81, v56, v57
  v_max3_f32 v85, v85, v72, v73
  v_max3_f32 v80, v80, v58, v59
  v_max3_f32 v84, v84, v74, v75
  v_max3_f32 v81, v81, v60, v61
  v_max3_f32 v85, v85, v76, v77
  v_max3_f32 v80, v80, v62, v63
  v_max3_f32 v84, v84, v78, v79
  v_mov_b32 v82, 0x3fb8aa3b
  v_mov_b32 v86, 0x3fb8aa3b
  v_max_f32 v80, v80, v81
  v_max_f32 v84, v84, v85
  v_mul_f32 v80, v82, v80
  v_mul_f32 v84, v86, v84
  v_pk_fma_f32 v[48:49], v[48:49], v[82:83], v[80:81] op_sel_hi:[1,0,0] neg_lo:[0,0,1] neg_hi:[0,0,1]
  v_pk_fma_f32 v[64:65], v[64:65], v[86:87], v[84:85] op_sel_hi:[1,0,0] neg_lo:[0,0,1] neg_hi:[0,0,1]
  v_pk_fma_f32 v[50:51], v[50:51], v[82:83], v[80:81] op_sel_hi:[1,0,0] neg_lo:[0,0,1] neg_hi:[0,0,1]
  v_pk_fma_f32 v[66:67], v[66:67], v[86:87], v[84:85] op_sel_hi:[1,0,0] neg_lo:[0,0,1] neg_hi:[0,0,1]
  v_pk_fma_f32 v[52:53], v[52:53], v[82:83], v[80:81] op_sel_hi:[1,0,0] neg_lo:[0,0,1] neg_hi:[0,0,1]
  v_pk_fma_f32 v[68:69], v[68:69], v[86:87], v[84:85] op_sel_hi:[1,0,0] neg_lo:[0,0,1] neg_hi:[0,0,1]
  v_pk_fma_f32 v[54:55], v[54:55], v[82:83], v[80:81] op_sel_hi:[1,0,0] neg_lo:[0,0,1] neg_hi:[0,0,1]
  v_pk_fma_f32 v[70:71], v[70:71], v[86:87], v[84:85] op_sel_hi:[1,0,0] neg_lo:[0,0,1] neg_hi:[0,0,1]
  v_pk_fma_f32 v[56:57], v[56:57], v[82:83], v[80:81] op_sel_hi:[1,0,0] neg_lo:[0,0,1] neg_hi:[0,0,1]
  v_pk_fma_f32 v[72:73], v[72:73], v[86:87], v[84:85] op_sel_hi:[1,0,0] neg_lo:[0,0,1] neg_hi:[0,0,1]
  v_pk_fma_f32 v[58:59], v[58:59], v[82:83], v[80:81] op_sel_hi:[1,0,0] neg_lo:[0,0,1] neg_hi:[0,0,1]
  v_pk_fma_f32 v[74:75], v[74:75], v[86:87], v[84:85] op_sel_hi:[1,0,0] neg_lo:[0,0,1] neg_hi:[0,0,1]
  v_pk_fma_f32 v[60:61], v[60:61], v[82:83], v[80:81] op_sel_hi:[1,0,0] neg_lo:[0,0,1] neg_hi:[0,0,1]
  v_pk_fma_f32 v[76:77], v[76:77], v[86:87], v[84:85] op_sel_hi:[1,0,0] neg_lo:[0,0,1] neg_hi:[0,0,1]
  v_pk_fma_f32 v[62:63], v[62:63], v[82:83], v[80:81] op_sel_hi:[1,0,0] neg_lo:[0,0,1] neg_hi:[0,0,1]
  v_pk_fma_f32 v[78:79], v[78:79], v[86:87], v[84:85] op_sel_hi:[1,0,0] neg_lo:[0,0,1] neg_hi:[0,0,1]
  v_exp_f32 v48, v48
  v_exp_f32 v64, v64
  v_exp_f32 v49, v49
  v_exp_f32 v65, v65
  v_exp_f32 v50, v50
  v_exp_f32 v66, v66
  v_exp_f32 v51, v51
  v_exp_f32 v67, v67
  v_exp_f32 v52, v52
  v_exp_f32 v68, v68
  v_exp_f32 v53, v53
  v_exp_f32 v69, v69
  v_exp_f32 v54, v54
  v_exp_f32 v70, v70
  v_exp_f32 v55, v55
  v_exp_f32 v71, v71
  v_exp_f32 v56, v56
  v_exp_f32 v72, v72
  v_exp_f32 v57, v57
  v_exp_f32 v73, v73
  v_exp_f32 v58, v58
  v_exp_f32 v74, v74
  v_exp_f32 v59, v59
  v_exp_f32 v75, v75
  v_exp_f32 v60, v60
  v_exp_f32 v76, v76
  v_exp_f32 v61, v61
  v_exp_f32 v77, v77
  v_exp_f32 v62, v62
  v_exp_f32 v78, v78
  v_exp_f32 v63, v63
  v_exp_f32 v79, v79
  v_pk_add_f32 v[82:83], v[48:49], v[50:51]
  v_pk_add_f32 v[86:87], v[64:65], v[66:67]
  v_pk_add_f32 v[80:81], v[52:53], v[54:55]
  v_pk_add_f32 v[84:85], v[68:69], v[70:71]
  v_pk_add_f32 v[82:83], v[82:83], v[56:57]
  v_pk_add_f32 v[86:87], v[86:87], v[72:73]
  v_pk_add_f32 v[80:81], v[80:81], v[58:59]
  v_pk_add_f32 v[84:85], v[84:85], v[74:75]
  v_pk_add_f32 v[82:83], v[82:83], v[60:61]
  v_pk_add_f32 v[86:87], v[86:87], v[76:77]
  v_pk_add_f32 v[80:81], v[80:81], v[62:63]
  v_pk_add_f32 v[84:85], v[84:85], v[78:79]
  v_pk_add_f32 v[82:83], v[82:83], v[80:81]
  v_pk_add_f32 v[86:87], v[86:87], v[84:85]
  v_add_f32 v82, v82, v83
  v_add_f32 v86, v86, v87
  v_rcp_f32 v82, v82
  v_rcp_f32 v86, v86
  v_pk_mul_f32 v[48:49], v[48:49], v[82:83] op_sel_hi:[1,0]
  v_pk_mul_f32 v[64:65], v[64:65], v[86:87] op_sel_hi:[1,0]
  v_pk_mul_f32 v[50:51], v[50:51], v[82:83] op_sel_hi:[1,0]
  v_pk_mul_f32 v[66:67], v[66:67], v[86:87] op_sel_hi:[1,0]
  v_pk_mul_f32 v[52:53], v[52:53], v[82:83] op_sel_hi:[1,0]
  v_pk_mul_f32 v[68:69], v[68:69], v[86:87] op_sel_hi:[1,0]
  v_pk_mul_f32 v[54:55], v[54:55], v[82:83] op_sel_hi:[1,0]
  v_pk_mul_f32 v[70:71], v[70:71], v[86:87] op_sel_hi:[1,0]
  v_pk_mul_f32 v[56:57], v[56:57], v[82:83] op_sel_hi:[1,0]
  v_pk_mul_f32 v[72:73], v[72:73], v[86:87] op_sel_hi:[1,0]
  v_pk_mul_f32 v[58:59], v[58:59], v[82:83] op_sel_hi:[1,0]
  v_pk_mul_f32 v[74:75], v[74:75], v[86:87] op_sel_hi:[1,0]
  v_pk_mul_f32 v[60:61], v[60:61], v[82:83] op_sel_hi:[1,0]
  v_pk_mul_f32 v[76:77], v[76:77], v[86:87] op_sel_hi:[1,0]
  v_pk_mul_f32 v[62:63], v[62:63], v[82:83] op_sel_hi:[1,0]
  v_pk_mul_f32 v[78:79], v[78:79], v[86:87] op_sel_hi:[1,0]
  v_cvt_pk_bf16_f32 v20, v48, v49
  v_cvt_pk_bf16_f32 v28, v64, v65
  v_cvt_pk_bf16_f32 v21, v50, v51
  v_cvt_pk_bf16_f32 v29, v66, v67
  v_cvt_pk_bf16_f32 v22, v52, v53
  v_cvt_pk_bf16_f32 v30, v68, v69
  v_cvt_pk_bf16_f32 v23, v54, v55
  v_cvt_pk_bf16_f32 v31, v70, v71
  v_cvt_pk_bf16_f32 v24, v56, v57
  v_cvt_pk_bf16_f32 v32, v72, v73
  v_cvt_pk_bf16_f32 v25, v58, v59
  v_cvt_pk_bf16_f32 v33, v74, v75
  v_cvt_pk_bf16_f32 v26, v60, v61
  v_cvt_pk_bf16_f32 v34, v76, v77
  v_cvt_pk_bf16_f32 v27, v62, v63
  v_cvt_pk_bf16_f32 v35, v78, v79
  s_mul_i32 s44, s34, 9216
  s_add_u32 s44, s44, 401408
  v_lshlrev_b32 v120, 4, v0
  v_add_u32 v120, s44, v120
  v_min_u32 v121, 63, v0
  v_lshlrev_b32 v121, 4, v121
  v_add_u32 v121, s44, v121
  v_add_u32 v121, 8192, v121
  v_add_u32 v122, 4096, v120
  v_lshrrev_b32 v60, 7, v0
  v_mul_u32_u24 v60, 2560, v60
  v_bfe_u32 v61, v0, 3, 4
  v_mul_u32_u24 v61, 80, v61
  v_and_b32 v62, 7, v0
  v_lshlrev_b32 v62, 3, v62
  v_add3_u32 v60, v60, v61, v62
  v_add_u32 v60, 97280, v60
  v_bfe_u32 v61, v0, 4, 2
  v_mul_u32_u24 v61, 2560, v61
  v_and_b32 v62, 15, v0
  v_lshl_add_u32 v61, v62, 2, v61
  v_add_u32 v61, 98560, v61
  v_mul_u32_u24 v62, 80, v3
  v_lshl_add_u32 v62, v2, 5, v62
  s_mul_i32 s45, s41, 5120
  s_add_u32 s45, s45, 97280
  v_add_u32 v62, s45, v62
  s_lshl_b32 s45, s33, 1
  s_add_u32 s45, s45, s40
  s_lshl_b32 s52, s45, 4
  s_lshl_b32 s47, s34, 1
  s_add_u32 s52, s52, s47
  s_add_u32 s52, s52, s41
  s_lshl_b32 s45, s45, 15
  s_lshl_b32 s47, s34, 12
  s_add_u32 s45, s45, s47
  s_lshl_b32 s47, s41, 11
  s_add_u32 s45, s45, s47
  s_add_u32 s45, s45, 8388608
  v_lshlrev_b32 v63, 4, v1
  v_add_u32 v63, s45, v63
  s_mov_b32 s46, 0
  s_sleep 4
  buffer_load_dwordx4 v[72:75], v120, s[88:91], 0 offen sc1
  buffer_load_dwordx4 v[76:79], v122, s[88:91], 0 offen sc1
  buffer_load_dwordx4 v[80:83], v121, s[88:91], 0 offen sc1
L_h2poll_31:
  s_waitcnt vmcnt(0)
  v_sad_u32 v123, v73, s38, 0
  v_sad_u32 v123, v75, s38, v123
  v_sad_u32 v123, v77, s38, v123
  v_sad_u32 v123, v79, s38, v123
  v_sad_u32 v123, v81, s38, v123
  v_sad_u32 v123, v83, s38, v123
  s_add_u32 s46, s46, 1
  s_cmp_gt_u32 s46, 40000
  s_cbranch_scc1 L_h2done_32
  v_cmp_ne_u32 vcc, 0, v123
  s_nop 4
  s_cbranch_vccz L_h2done_32
  s_sleep 4
  buffer_load_dwordx4 v[72:75], v120, s[88:91], 0 offen sc1
  buffer_load_dwordx4 v[76:79], v122, s[88:91], 0 offen sc1
  buffer_load_dwordx4 v[80:83], v121, s[88:91], 0 offen sc1
  s_branch L_h2poll_31
L_h2done_32:
  v_mov_b32 v73, v74
  v_mov_b32 v77, v78
  v_lshl_or_b32 v80, v82, 16, v80
  ds_write_b64 v60, v[72:73]
  ds_write_b64 v60, v[76:77] offset:5120
  s_cmp_lg_u32 s30, 0
  s_cbranch_scc1 L_zw_33
  ds_write_b32 v61, v80
  ds_write_b32 v61, v80 offset:320
L_zw_33:
  s_waitcnt lgkmcnt(0)
  s_barrier
  ds_read_b128 v[64:67], v62 offset:0
  ds_read_b128 v[68:71], v62 offset:16
  ds_read_b128 v[72:75], v62 offset:2560
  ds_read_b128 v[76:79], v62 offset:2576
  s_waitcnt lgkmcnt(2)
  v_mfma_f32_32x32x16_bf16 v[88:103], v[64:67], v[20:23], 0
  v_mfma_f32_32x32x16_bf16 v[88:103], v[68:71], v[24:27], v[88:103]
  s_waitcnt lgkmcnt(0)
  v_mfma_f32_32x32x16_bf16 v[104:119], v[72:75], v[28:31], 0
  v_mfma_f32_32x32x16_bf16 v[104:119], v[76:79], v[32:35], v[104:119]
  s_nop 8
  v_add_f32 v96, 0x358637bd, v96
  v_rcp_f32 v96, v96
  s_nop 0
  v_pk_mul_f32 v[88:89], v[88:89], v[96:97] op_sel_hi:[1,0]
  v_pk_mul_f32 v[90:91], v[90:91], v[96:97] op_sel_hi:[1,0]
  v_pk_mul_f32 v[92:93], v[92:93], v[96:97] op_sel_hi:[1,0]
  v_pk_mul_f32 v[94:95], v[94:95], v[96:97] op_sel_hi:[1,0]
  v_cvt_pk_bf16_f32 v48, v88, v89
  v_cvt_pk_bf16_f32 v49, v90, v91
  v_cvt_pk_bf16_f32 v50, v92, v93
  v_cvt_pk_bf16_f32 v51, v94, v95
  v_add_f32 v112, 0x358637bd, v112
  v_rcp_f32 v112, v112
  s_nop 0
  v_pk_mul_f32 v[104:105], v[104:105], v[112:113] op_sel_hi:[1,0]
  v_pk_mul_f32 v[106:107], v[106:107], v[112:113] op_sel_hi:[1,0]
  v_pk_mul_f32 v[108:109], v[108:109], v[112:113] op_sel_hi:[1,0]
  v_pk_mul_f32 v[110:111], v[110:111], v[112:113] op_sel_hi:[1,0]
  v_cvt_pk_bf16_f32 v52, v104, v105
  v_cvt_pk_bf16_f32 v53, v106, v107
  v_cvt_pk_bf16_f32 v54, v108, v109
  v_cvt_pk_bf16_f32 v55, v110, v111
  s_cmp_eq_u32 s68, 1
  s_cbranch_scc1 L_ofast_34
  buffer_store_dwordx4 v[48:51], v63, s[88:91], 0 offen offset:0 sc1
  buffer_store_dwordx4 v[52:55], v63, s[88:91], 0 offen offset:1024 sc1
  s_waitcnt vmcnt(0)
  s_lshl_b32 s44, s52, 4
  s_add_u32 s44, s44, 851968
  v_mov_b32 v126, s44
  v_mov_b32 v127, s38
  s_mov_b64 exec, 1
  buffer_store_dword v127, v126, s[88:91], 0 offen sc1
  s_mov_b64 exec, -1
  s_branch L_oend_35
L_ofast_34:
  buffer_store_dwordx4 v[48:51], v63, s[88:91], 0 offen offset:0
  buffer_store_dwordx4 v[52:55], v63, s[88:91], 0 offen offset:1024
  s_waitcnt vmcnt(0)
  s_lshl_b32 s44, s52, 4
  s_add_u32 s44, s44, 851968
  v_mov_b32 v126, s44
  v_mov_b32 v127, s38
  s_mov_b64 exec, 1
  buffer_store_dword v127, v126, s[88:91], 0 offen
  s_mov_b64 exec, -1
L_oend_35:
  s_lshl_b32 s53, s35, 4
  s_lshl_b32 s48, s35, 15
  s_add_u32 s48, s48, s39
  s_add_u32 s48, s48, 8388608
  v_lshlrev_b32 v50, 4, v1
  v_add_u32 v48, s48, v50
  v_mul_u32_u24 v52, 72, v3
  v_lshl_add_u32 v52, v2, 3, v52
  s_mul_i32 s44, s30, 2304
  s_add_u32 s44, s44, 65536
  v_add_u32 v52, s44, v52
  v_lshrrev_b32 v88, 4, v1
  v_bfe_u32 v53, v1, 2, 2
  v_lshl_add_u32 v53, v88, 3, v53
  v_mul_u32_u24 v53, 72, v53
  v_and_b32 v89, 3, v1
  v_lshl_add_u32 v53, v89, 3, v53
  v_add_u32 v53, s44, v53
  s_lshl_b32 s44, s36, 7
  s_lshl_b32 s45, s30, 5
  s_add_u32 s44, s44, s45
  s_lshl_b32 s44, s44, 12
  s_lshl_b32 s45, s35, 6
  s_add_u32 s44, s44, s45
  s_add_u32 s44, s44, 12582912
  v_and_b32 v54, 15, v1
  v_lshlrev_b32 v54, 12, v54
  v_lshl_add_u32 v54, v88, 4, v54
  v_add_u32 v54, s44, v54
  s_lshl_b32 s44, s35, 7
  s_add_u32 s44, s44, 278528
  v_lshlrev_b32 v55, 2, v3
  v_lshl_add_u32 v55, v2, 13, v55
  v_add_u32 v55, s44, v55
  s_cmp_lg_u32 s30, 0
  s_cbranch_scc1 L_wait_36
  v_and_b32 v126, 15, v1
  v_lshlrev_b32 v126, 4, v126
  s_lshl_b32 s44, s53, 4
  s_add_u32 s44, s44, 851968
  v_add_u32 v126, s44, v126
  s_mov_b32 s45, 0
  s_waitcnt vmcnt(0)
L_poll_37:
  buffer_load_dword v127, v126, s[88:91], 0 offen sc1
  s_add_u32 s45, s45, 1
  s_cmp_gt_u32 s45, 40000
  s_cbranch_scc1 L_pdone_38
  s_waitcnt vmcnt(0)
  v_cmp_ne_u32 vcc, s38, v127
  s_nop 4
  s_cbranch_vccz L_pdone_38
  s_sleep 4
  s_branch L_poll_37
L_pdone_38:
  s_waitcnt vmcnt(0)
L_wait_36:
  s_barrier
  s_add_u32 m0, s39, 0
  v_add_u32 v49, 0, v48
  buffer_load_dwordx4 v49, s[88:91], 0 offen sc1 lds
  s_add_u32 m0, s39, 4096
  v_add_u32 v49, 4096, v48
  buffer_load_dwordx4 v49, s[88:91], 0 offen sc1 lds
  s_add_u32 m0, s39, 8192
  v_add_u32 v49, 8192, v48
  buffer_load_dwordx4 v49, s[88:91], 0 offen sc1 lds
  s_add_u32 m0, s39, 12288
  v_add_u32 v49, 12288, v48
  buffer_load_dwordx4 v49, s[88:91], 0 offen sc1 lds
  s_add_u32 m0, s39, 16384
  v_add_u32 v49, 16384, v48
  buffer_load_dwordx4 v49, s[88:91], 0 offen sc1 lds
  s_add_u32 m0, s39, 20480
  v_add_u32 v49, 20480, v48
  buffer_load_dwordx4 v49, s[88:91], 0 offen sc1 lds
  s_add_u32 m0, s39, 24576
  v_add_u32 v49, 24576, v48
  buffer_load_dwordx4 v49, s[88:91], 0 offen sc1 lds
  s_add_u32 m0, s39, 28672
  v_add_u32 v49, 28672, v48
  buffer_load_dwordx4 v49, s[88:91], 0 offen sc1 lds
  s_waitcnt vmcnt(6)
  s_barrier
  ds_read_b128 v[56:59], v50 offset:0
  ds_read_b128 v[60:63], v50 offset:1024
  ds_read_b128 v[64:67], v50 offset:2048
  ds_read_b128 v[68:71], v50 offset:3072
  s_waitcnt lgkmcnt(3)
  v_mfma_f32_32x32x16_bf16 v[72:87], v[128:131], v[56:59], 0
  ds_read_b128 v[56:59], v50 offset:4096
  s_waitcnt lgkmcnt(3)
  v_mfma_f32_32x32x16_bf16 v[72:87], v[132:135], v[60:63], v[72:87]
  ds_read_b128 v[60:63], v50 offset:5120
  s_waitcnt lgkmcnt(3)
  v_mfma_f32_32x32x16_bf16 v[72:87], v[136:139], v[64:67], v[72:87]
  ds_read_b128 v[64:67], v50 offset:6144
  s_waitcnt lgkmcnt(3)
  v_mfma_f32_32x32x16_bf16 v[72:87], v[140:143], v[68:71], v[72:87]
  ds_read_b128 v[68:71], v50 offset:7168
  s_waitcnt lgkmcnt(3)
  v_mfma_f32_32x32x16_bf16 v[72:87], v[144:147], v[56:59], v[72:87]
  s_waitcnt vmcnt(4)
  s_barrier
  ds_read_b128 v[56:59], v50 offset:8192
  s_waitcnt lgkmcnt(3)
  v_mfma_f32_32x32x16_bf16 v[72:87], v[148:151], v[60:63], v[72:87]
  ds_read_b128 v[60:63], v50 offset:9216
  s_waitcnt lgkmcnt(3)
  v_mfma_f32_32x32x16_bf16 v[72:87], v[152:155], v[64:67], v[72:87]
  ds_read_b128 v[64:67], v50 offset:10240
  s_waitcnt lgkmcnt(3)
  v_mfma_f32_32x32x16_bf16 v[72:87], v[156:159], v[68:71], v[72:87]
  ds_read_b128 v[68:71], v50 offset:11264
  s_waitcnt lgkmcnt(3)
  v_mfma_f32_32x32x16_bf16 v[72:87], v[160:163], v[56:59], v[72:87]
  ds_read_b128 v[56:59], v50 offset:12288
  s_waitcnt lgkmcnt(3)
  v_mfma_f32_32x32x16_bf16 v[72:87], v[164:167], v[60:63], v[72:87]
  ds_read_b128 v[60:63], v50 offset:13312
  s_waitcnt lgkmcnt(3)
  v_mfma_f32_32x32x16_bf16 v[72:87], v[168:171], v[64:67], v[72:87]
  ds_read_b128 v[64:67], v50 offset:14336
  s_waitcnt lgkmcnt(3)
  v_mfma_f32_32x32x16_bf16 v[72:87], v[172:175], v[68:71], v[72:87]
  ds_read_b128 v[68:71], v50 offset:15360
  s_waitcnt lgkmcnt(3)
  v_mfma_f32_32x32x16_bf16 v[72:87], v[176:179], v[56:59], v[72:87]
  s_waitcnt vmcnt(2)
  s_barrier
  ds_read_b128 v[56:59], v50 offset:16384
  s_waitcnt lgkmcnt(3)
  v_mfma_f32_32x32x16_bf16 v[72:87], v[180:183], v[60:63], v[72:87]
  ds_read_b128 v[60:63], v50 offset:17408
  s_waitcnt lgkmcnt(3)
  v_mfma_f32_32x32x16_bf16 v[72:87], v[184:187], v[64:67], v[72:87]
  ds_read_b128 v[64:67], v50 offset:18432
  s_waitcnt lgkmcnt(3)
  v_mfma_f32_32x32x16_bf16 v[72:87], v[188:191], v[68:71], v[72:87]
  ds_read_b128 v[68:71], v50 offset:19456
  s_waitcnt lgkmcnt(3)
  v_mfma_f32_32x32x16_bf16 v[72:87], v[192:195], v[56:59], v[72:87]
  ds_read_b128 v[56:59], v50 offset:20480
  s_waitcnt lgkmcnt(3)
  v_mfma_f32_32x32x16_bf16 v[72:87], v[196:199], v[60:63], v[72:87]
  ds_read_b128 v[60:63], v50 offset:21504
  s_waitcnt lgkmcnt(3)
  v_mfma_f32_32x32x16_bf16 v[72:87], v[200:203], v[64:67], v[72:87]
  ds_read_b128 v[64:67], v50 offset:22528
  s_waitcnt lgkmcnt(3)
  v_mfma_f32_32x32x16_bf16 v[72:87], v[204:207], v[68:71], v[72:87]
  ds_read_b128 v[68:71], v50 offset:23552
  s_waitcnt lgkmcnt(3)
  v_mfma_f32_32x32x16_bf16 v[72:87], v[208:211], v[56:59], v[72:87]
  s_waitcnt vmcnt(0)
  s_barrier
  ds_read_b128 v[56:59], v50 offset:24576
  s_waitcnt lgkmcnt(3)
  v_mfma_f32_32x32x16_bf16 v[72:87], v[212:215], v[60:63], v[72:87]
  ds_read_b128 v[60:63], v50 offset:25600
  s_waitcnt lgkmcnt(3)
  v_mfma_f32_32x32x16_bf16 v[72:87], v[216:219], v[64:67], v[72:87]
  ds_read_b128 v[64:67], v50 offset:26624
  s_waitcnt lgkmcnt(3)
  v_mfma_f32_32x32x16_bf16 v[72:87], v[220:223], v[68:71], v[72:87]
  ds_read_b128 v[68:71], v50 offset:27648
  s_waitcnt lgkmcnt(3)
  v_mfma_f32_32x32x16_bf16 v[72:87], v[224:227], v[56:59], v[72:87]
  ds_read_b128 v[56:59], v50 offset:28672
  s_waitcnt lgkmcnt(3)
  v_mfma_f32_32x32x16_bf16 v[72:87], v[228:231], v[60:63], v[72:87]
  ds_read_b128 v[60:63], v50 offset:29696
  s_waitcnt lgkmcnt(3)
  v_mfma_f32_32x32x16_bf16 v[72:87], v[232:235], v[64:67], v[72:87]
  ds_read_b128 v[64:67], v50 offset:30720
  s_waitcnt lgkmcnt(3)
  v_mfma_f32_32x32x16_bf16 v[72:87], v[236:239], v[68:71], v[72:87]
  ds_read_b128 v[68:71], v50 offset:31744
  s_waitcnt lgkmcnt(3)
  v_mfma_f32_32x32x16_bf16 v[72:87], v[240:243], v[56:59], v[72:87]
  s_waitcnt lgkmcnt(2)
  v_mfma_f32_32x32x16_bf16 v[72:87], v[244:247], v[60:63], v[72:87]
  s_waitcnt lgkmcnt(1)
  v_mfma_f32_32x32x16_bf16 v[72:87], v[248:251], v[64:67], v[72:87]
  s_waitcnt lgkmcnt(0)
  v_mfma_f32_32x32x16_bf16 v[72:87], v[252:255], v[68:71], v[72:87]
  v_mov_b32 v116, 0
  v_mov_b32 v117, 0
  v_mov_b32 v118, 0x3f803f80
  v_lshlrev_b32 v96, 16, v12
  v_and_b32 v97, 0xffff0000, v12
  s_nop 6
  v_pk_add_f32 v[72:73], v[72:73], v[96:97]
  v_cvt_pk_bf16_f32 v88, v72, v73
  v_lshlrev_b32 v98, 16, v13
  v_and_b32 v99, 0xffff0000, v13
  v_pk_add_f32 v[74:75], v[74:75], v[98:99]
  v_cvt_pk_bf16_f32 v89, v74, v75
  ds_write_b64 v52, v[88:89] offset:0
  v_lshlrev_b32 v96, 16, v14
  v_and_b32 v97, 0xffff0000, v14
  v_pk_add_f32 v[76:77], v[76:77], v[96:97]
  v_cvt_pk_bf16_f32 v90, v76, v77
  v_lshlrev_b32 v98, 16, v15
  v_and_b32 v99, 0xffff0000, v15
  v_pk_add_f32 v[78:79], v[78:79], v[98:99]
  v_cvt_pk_bf16_f32 v91, v78, v79
  ds_write_b64 v52, v[90:91] offset:16
  v_lshlrev_b32 v96, 16, v16
  v_and_b32 v97, 0xffff0000, v16
  v_pk_add_f32 v[80:81], v[80:81], v[96:97]
  v_cvt_pk_bf16_f32 v92, v80, v81
  v_lshlrev_b32 v98, 16, v17
  v_and_b32 v99, 0xffff0000, v17
  v_pk_add_f32 v[82:83], v[82:83], v[98:99]
  v_cvt_pk_bf16_f32 v93, v82, v83
  ds_write_b64 v52, v[92:93] offset:32
  v_lshlrev_b32 v96, 16, v18
  v_and_b32 v97, 0xffff0000, v18
  v_pk_add_f32 v[84:85], v[84:85], v[96:97]
  v_cvt_pk_bf16_f32 v94, v84, v85
  v_lshlrev_b32 v98, 16, v19
  v_and_b32 v99, 0xffff0000, v19
  v_pk_add_f32 v[86:87], v[86:87], v[98:99]
  v_cvt_pk_bf16_f32 v95, v86, v87
  ds_write_b64 v52, v[94:95] offset:48
  v_dot2c_f32_bf16 v116, v88, v118
  v_dot2c_f32_bf16 v117, v88, v88
  v_dot2c_f32_bf16 v116, v89, v118
  v_dot2c_f32_bf16 v117, v89, v89
  v_dot2c_f32_bf16 v116, v90, v118
  v_dot2c_f32_bf16 v117, v90, v90
  v_dot2c_f32_bf16 v116, v91, v118
  v_dot2c_f32_bf16 v117, v91, v91
  v_dot2c_f32_bf16 v116, v92, v118
  v_dot2c_f32_bf16 v117, v92, v92
  v_dot2c_f32_bf16 v116, v93, v118
  v_dot2c_f32_bf16 v117, v93, v93
  v_dot2c_f32_bf16 v116, v94, v118
  v_dot2c_f32_bf16 v117, v94, v94
  v_dot2c_f32_bf16 v116, v95, v118
  v_dot2c_f32_bf16 v117, v95, v95
  s_nop 1
  v_mov_b32 v96, v116
  v_mov_b32 v97, v117
  s_nop 0
  v_permlane32_swap_b32 v116, v96
  v_permlane32_swap_b32 v117, v97
  v_add_f32 v116, v116, v96
  v_add_f32 v117, v117, v97
  v_cmp_eq_u32 vcc, 0, v2
  s_nop 1
  v_cndmask_b32 v116, v117, v116, vcc
  v_lshlrev_b32 v96, 2, v1
  s_lshl_b32 s44, s30, 8
  s_add_u32 s44, s44, 95232
  v_add_u32 v97, s44, v96
  ds_write_b32 v97, v116
  ds_read_b64_tr_b16 v[104:105], v53 offset:0
  ds_read_b64_tr_b16 v[106:107], v53 offset:288
  ds_read_b64_tr_b16 v[108:109], v53 offset:32
  ds_read_b64_tr_b16 v[110:111], v53 offset:320
  v_add_u32 v48, 65536, v54
  s_waitcnt lgkmcnt(4)
  s_barrier
  s_cmp_lg_u32 s30, 0
  s_cbranch_scc1 L_at_39
  v_add_u32 v96, 95232, v96
  ds_read_b32 v98, v96 offset:0
  ds_read_b32 v99, v96 offset:256
  ds_read_b32 v100, v96 offset:512
  ds_read_b32 v101, v96 offset:768
  s_waitcnt lgkmcnt(0)
  v_add_f32 v98, v98, v99
  v_add_f32 v100, v100, v101
  v_add_f32 v98, v98, v100
  buffer_atomic_add_f32 v98, v55, s[88:91], 0 offen
L_at_39:
  s_waitcnt lgkmcnt(0)
  buffer_store_dwordx4 v[104:107], v54, s[88:91], 0 offen sc1
  buffer_store_dwordx4 v[108:111], v48, s[88:91], 0 offen sc1
  s_waitcnt vmcnt(0)
  s_barrier
  s_cmp_lg_u32 s30, 0
  s_cbranch_scc1 L_sig_40
  s_lshl_b32 s44, s42, 4
  s_add_u32 s44, s44, 917504
  v_mov_b32 v126, s44
  v_mov_b32 v127, s38
  s_mov_b64 exec, 1
  buffer_store_dword v127, v126, s[88:91], 0 offen sc1
  s_mov_b64 exec, -1
L_sig_40:
  v_mov_b32 v56, 0
  v_mov_b32 v57, 0
  v_mov_b32 v58, 0
  v_mov_b32 v59, 0
  v_lshrrev_b32 v49, 5, v0
  v_mul_u32_u24 v49, 4608, v49
  v_and_b32 v50, 31, v0
  v_lshl_add_u32 v49, v50, 4, v49
  v_add_u32 v49, 512, v49
  s_cmp_lg_u32 s30, 0
  s_cbranch_scc1 L_up_41
  ds_write_b128 v49, v[56:59]
L_up_41:
  s_lshl_b32 s44, s37, 12
  s_add_u32 s44, s44, 12582912
  v_lshlrev_b32 v112, 4, v0
  v_add_u32 v112, s44, v112
  v_add_u32 v113, 4096, v112
  v_lshlrev_b32 v114, 5, v0
  v_add_u32 v114, 278528, v114
  v_add_u32 v115, 8192, v114
  v_bfe_u32 v50, v1, 2, 2
  v_mul_u32_u24 v24, 4160, v50
  v_lshrrev_b32 v50, 4, v1
  v_lshlrev_b32 v51, 4, v50
  v_sub_u32 v24, v24, v51
  v_and_b32 v52, 3, v1
  v_lshl_add_u32 v24, v52, 3, v24
  s_mul_i32 s44, s40, 16640
  s_lshl_b32 s45, s41, 8
  s_add_u32 s44, s44, s45
  s_add_u32 s44, s44, 108576
  v_add_u32 v24, s44, v24
  v_and_b32 v25, 15, v1
  v_lshlrev_b32 v25, 5, v25
  v_add_u32 v25, v25, v51
  s_mul_i32 s44, s40, 4608
  s_add_u32 s44, s44, 512
  s_lshl_b32 s45, s41, 8
  s_sub_u32 s44, s44, s45
  v_add_u32 v25, s44, v25
  v_lshlrev_b32 v50, 4, v1
  s_lshl_b32 s44, s30, 13
  s_add_u32 s44, s44, 17920
  v_add_u32 v26, s44, v50
  s_lshl_b32 s44, s30, 11
  s_add_u32 s44, s44, 17920
  v_add_u32 v27, s44, v50
  v_and_b32 v50, 15, v1
  v_lshlrev_b32 v50, 4, v50
  v_lshrrev_b32 v51, 4, v1
  v_lshl_add_u32 v50, v51, 2, v50
  s_lshl_b32 s44, s30, 9
  v_add_u32 v50, s44, v50
  v_lshlrev_b32 v28, 1, v50
  s_lshl_b32 s46, s37, 1
  v_lshlrev_b32 v29, 10, v50
  v_add_u32 v29, s46, v29
  v_mov_b32 v72, 0x3b000000
  v_mov_b32 v73, 0x3b000000
  v_mov_b32 v74, 0x3727c5ac
  v_mov_b32 v75, 0x3727c5ac
  s_waitcnt lgkmcnt(0)
  s_cmp_lg_u32 s30, 0
  s_cbranch_scc1 L_wait_42
  v_lshlrev_b32 v126, 4, v1
  v_add_u32 v126, 917504, v126
  v_add_u32 v125, 1024, v126
  v_add_u32 v124, 2048, v126
  v_add_u32 v123, 3072, v126
  s_mov_b32 s45, 0
  s_waitcnt vmcnt(0)
  s_sleep 17
L_poll_43:
  buffer_load_dword v127, v126, s[88:91], 0 offen sc1
  buffer_load_dword v122, v125, s[88:91], 0 offen sc1
  buffer_load_dword v121, v124, s[88:91], 0 offen sc1
  buffer_load_dword v120, v123, s[88:91], 0 offen sc1
  s_add_u32 s45, s45, 1
  s_cmp_gt_u32 s45, 40000
  s_cbranch_scc1 L_pdone_44
  s_waitcnt vmcnt(0)
  v_sad_u32 v127, v127, s38, 0
  v_sad_u32 v127, v122, s38, v127
  v_sad_u32 v127, v121, s38, v127
  v_sad_u32 v127, v120, s38, v127
  v_cmp_ne_u32 vcc, 0, v127
  s_nop 4
  s_cbranch_vccz L_pdone_44
  s_sleep 4
  s_branch L_poll_43
L_pdone_44:
  s_waitcnt vmcnt(0)
L_wait_42:
  s_barrier
  buffer_load_dwordx4 v[56:59], v114, s[88:91], 0 offen sc1
  buffer_load_dwordx4 v[64:67], v115, s[88:91], 0 offen sc1
  buffer_load_dwordx4 v[60:63], v114, s[88:91], 0 offen offset:16 sc1
  buffer_load_dwordx4 v[68:71], v115, s[88:91], 0 offen offset:16 sc1
  buffer_load_dwordx4 v[48:51], v112, s[88:91], 0 offen sc1
  buffer_load_dwordx4 v[52:55], v113, s[88:91], 0 offen sc1
  s_waitcnt vmcnt(4)
  v_pk_mul_f32 v[56:57], v[56:57], v[72:73]
  v_pk_mul_f32 v[58:59], v[58:59], v[72:73]
  v_pk_mul_f32 v[64:65], v[64:65], v[72:73]
  v_pk_mul_f32 v[66:67], v[66:67], v[72:73]
  v_pk_fma_f32 v[64:65], v[56:57], v[56:57], v[64:65] neg_lo:[1,0,0] neg_hi:[1,0,0]
  v_pk_fma_f32 v[66:67], v[58:59], v[58:59], v[66:67] neg_lo:[1,0,0] neg_hi:[1,0,0]
  v_max_f32 v64, 0, v64
  v_max_f32 v66, 0, v66
  v_max_f32 v65, 0, v65
  v_max_f32 v67, 0, v67
  v_cvt_pk_bf16_f32 v76, v56, v57
  v_cvt_pk_bf16_f32 v77, v58, v59
  v_lshlrev_b32 v56, 16, v76
  v_lshlrev_b32 v58, 16, v77
  v_and_b32 v57, 0xffff0000, v76
  v_and_b32 v59, 0xffff0000, v77
  v_cvt_pk_bf16_f32 v76, v64, v65
  v_cvt_pk_bf16_f32 v77, v66, v67
  v_lshlrev_b32 v64, 16, v76
  v_lshlrev_b32 v66, 16, v77
  v_and_b32 v65, 0xffff0000, v76
  v_and_b32 v67, 0xffff0000, v77
  v_pk_add_f32 v[64:65], v[64:65], v[74:75]
  v_pk_add_f32 v[66:67], v[66:67], v[74:75]
  v_cvt_pk_bf16_f32 v76, v64, v65
  v_cvt_pk_bf16_f32 v77, v66, v67
  v_lshlrev_b32 v64, 16, v76
  v_lshlrev_b32 v66, 16, v77
  v_and_b32 v65, 0xffff0000, v76
  v_and_b32 v67, 0xffff0000, v77
  v_sqrt_f32 v64, v64
  v_sqrt_f32 v66, v66
  v_sqrt_f32 v65, v65
  v_sqrt_f32 v67, v67
  v_cvt_pk_bf16_f32 v76, v64, v65
  v_cvt_pk_bf16_f32 v77, v66, v67
  v_lshlrev_b32 v64, 16, v76
  v_lshlrev_b32 v66, 16, v77
  v_and_b32 v65, 0xffff0000, v76
  v_and_b32 v67, 0xffff0000, v77
  v_rcp_f32 v64, v64
  v_rcp_f32 v66, v66
  v_rcp_f32 v65, v65
  v_rcp_f32 v67, v67
  s_waitcnt vmcnt(2)
  v_pk_mul_f32 v[60:61], v[60:61], v[72:73]
  v_pk_mul_f32 v[62:63], v[62:63], v[72:73]
  v_pk_mul_f32 v[68:69], v[68:69], v[72:73]
  v_pk_mul_f32 v[70:71], v[70:71], v[72:73]
  v_pk_fma_f32 v[68:69], v[60:61], v[60:61], v[68:69] neg_lo:[1,0,0] neg_hi:[1,0,0]
  v_pk_fma_f32 v[70:71], v[62:63], v[62:63], v[70:71] neg_lo:[1,0,0] neg_hi:[1,0,0]
  v_max_f32 v68, 0, v68
  v_max_f32 v70, 0, v70
  v_max_f32 v69, 0, v69
  v_max_f32 v71, 0, v71
  v_cvt_pk_bf16_f32 v76, v60, v61
  v_cvt_pk_bf16_f32 v77, v62, v63
  v_lshlrev_b32 v60, 16, v76
  v_lshlrev_b32 v62, 16, v77
  v_and_b32 v61, 0xffff0000, v76
  v_and_b32 v63, 0xffff0000, v77
  v_cvt_pk_bf16_f32 v76, v68, v69
  v_cvt_pk_bf16_f32 v77, v70, v71
  v_lshlrev_b32 v68, 16, v76
  v_lshlrev_b32 v70, 16, v77
  v_and_b32 v69, 0xffff0000, v76
  v_and_b32 v71, 0xffff0000, v77
  v_pk_add_f32 v[68:69], v[68:69], v[74:75]
  v_pk_add_f32 v[70:71], v[70:71], v[74:75]
  v_cvt_pk_bf16_f32 v76, v68, v69
  v_cvt_pk_bf16_f32 v77, v70, v71
  v_lshlrev_b32 v68, 16, v76
  v_lshlrev_b32 v70, 16, v77
  v_and_b32 v69, 0xffff0000, v76
  v_and_b32 v71, 0xffff0000, v77
  v_sqrt_f32 v68, v68
  v_sqrt_f32 v70, v70
  v_sqrt_f32 v69, v69
  v_sqrt_f32 v71, v71
  v_cvt_pk_bf16_f32 v76, v68, v69
  v_cvt_pk_bf16_f32 v77, v70, v71
  v_lshlrev_b32 v68, 16, v76
  v_lshlrev_b32 v70, 16, v77
  v_and_b32 v69, 0xffff0000, v76
  v_and_b32 v71, 0xffff0000, v77
  v_rcp_f32 v68, v68
  v_rcp_f32 v70, v70
  v_rcp_f32 v69, v69
  v_rcp_f32 v71, v71
  s_waitcnt vmcnt(0)
  v_lshlrev_b32 v112, 4, v0
  ds_write_b128 v112, v[48:51] offset:9728
  ds_write_b128 v112, v[52:55] offset:13824
  v_lshlrev_b32 v88, 16, v48
  v_lshlrev_b32 v90, 16, v49
  v_and_b32 v89, 0xffff0000, v48
  v_and_b32 v91, 0xffff0000, v49
  v_pk_add_f32 v[88:89], v[88:89], v[56:57] neg_lo:[0,1] neg_hi:[0,1]
  v_pk_add_f32 v[90:91], v[90:91], v[58:59] neg_lo:[0,1] neg_hi:[0,1]
  v_pk_mul_f32 v[88:89], v[88:89], v[64:65]
  v_pk_mul_f32 v[90:91], v[90:91], v[66:67]
  v_cvt_f16_f32 v88, v88
  v_cvt_f16_f32 v90, v90
  v_cvt_f16_f32 v89, v89
  v_cvt_f16_f32 v91, v91
  v_lshl_or_b32 v80, v89, 16, v88
  v_lshl_or_b32 v81, v91, 16, v90
  v_lshlrev_b32 v88, 16, v50
  v_lshlrev_b32 v90, 16, v51
  v_and_b32 v89, 0xffff0000, v50
  v_and_b32 v91, 0xffff0000, v51
  v_pk_add_f32 v[88:89], v[88:89], v[60:61] neg_lo:[0,1] neg_hi:[0,1]
  v_pk_add_f32 v[90:91], v[90:91], v[62:63] neg_lo:[0,1] neg_hi:[0,1]
  v_pk_mul_f32 v[88:89], v[88:89], v[68:69]
  v_pk_mul_f32 v[90:91], v[90:91], v[70:71]
  v_cvt_f16_f32 v88, v88
  v_cvt_f16_f32 v90, v90
  v_cvt_f16_f32 v89, v89
  v_cvt_f16_f32 v91, v91
  v_lshl_or_b32 v82, v89, 16, v88
  v_lshl_or_b32 v83, v91, 16, v90
  ds_write_b128 v112, v[80:83] offset:1024
  v_lshlrev_b32 v88, 16, v52
  v_lshlrev_b32 v90, 16, v53
  v_and_b32 v89, 0xffff0000, v52
  v_and_b32 v91, 0xffff0000, v53
  v_pk_add_f32 v[88:89], v[88:89], v[56:57] neg_lo:[0,1] neg_hi:[0,1]
  v_pk_add_f32 v[90:91], v[90:91], v[58:59] neg_lo:[0,1] neg_hi:[0,1]
  v_pk_mul_f32 v[88:89], v[88:89], v[64:65]
  v_pk_mul_f32 v[90:91], v[90:91], v[66:67]
  v_cvt_f16_f32 v88, v88
  v_cvt_f16_f32 v90, v90
  v_cvt_f16_f32 v89, v89
  v_cvt_f16_f32 v91, v91
  v_lshl_or_b32 v84, v89, 16, v88
  v_lshl_or_b32 v85, v91, 16, v90
  v_lshlrev_b32 v88, 16, v54
  v_lshlrev_b32 v90, 16, v55
  v_and_b32 v89, 0xffff0000, v54
  v_and_b32 v91, 0xffff0000, v55
  v_pk_add_f32 v[88:89], v[88:89], v[60:61] neg_lo:[0,1] neg_hi:[0,1]
  v_pk_add_f32 v[90:91], v[90:91], v[62:63] neg_lo:[0,1] neg_hi:[0,1]
  v_pk_mul_f32 v[88:89], v[88:89], v[68:69]
  v_pk_mul_f32 v[90:91], v[90:91], v[70:71]
  v_cvt_f16_f32 v88, v88
  v_cvt_f16_f32 v90, v90
  v_cvt_f16_f32 v89, v89
  v_cvt_f16_f32 v91, v91
  v_lshl_or_b32 v86, v89, 16, v88
  v_lshl_or_b32 v87, v91, 16, v90
  ds_write_b128 v112, v[84:87] offset:5632
  s_waitcnt lgkmcnt(0)
  s_barrier
  v_lshlrev_b32 v104, 4, v1
  s_lshl_b32 s44, s30, 10
  s_add_u32 s44, s44, 17920
  v_add_u32 v31, s44, v104
  v_and_b32 v104, 15, v1
  v_lshlrev_b32 v104, 4, v104
  v_lshrrev_b32 v105, 4, v1
  v_lshl_add_u32 v104, v105, 2, v104
  s_lshl_b32 s44, s30, 8
  v_add_u32 v104, s44, v104
  v_lshlrev_b32 v32, 1, v104
  s_lshl_b32 s46, s37, 1
  v_lshlrev_b32 v33, 10, v104
  v_add_u32 v33, s46, v33
  s_lshl_b32 s44, s66, 16
  s_and_b32 s45, s66, 0xffff0000
  ds_read_b64_tr_b16 v[12:13], v24 offset:32
  ds_read_b64_tr_b16 v[14:15], v24 offset:24
  ds_read_b128 v[92:95], v25 offset:2016
  ds_read_b128 v[88:91], v25 offset:1504
  ds_read_b128 v[84:87], v25 offset:992
  ds_read_b128 v[80:83], v25 offset:480
  ds_read_b64_tr_b16 v[16:17], v24 offset:544
  ds_read_b64_tr_b16 v[18:19], v24 offset:536
  ds_read_b64_tr_b16 v[20:21], v24 offset:1056
  ds_read_b64_tr_b16 v[22:23], v24 offset:1048
  ds_read_b64_tr_b16 v[112:113], v24 offset:1568
  ds_read_b64_tr_b16 v[114:115], v24 offset:1560
  s_waitcnt lgkmcnt(10)
  s_waitcnt lgkmcnt(9)
  v_mfma_f32_16x16x32_f16 v[60:63], v[12:15], v[92:95], 0
  ds_read_b128 v[92:95], v25 offset:1952
  s_waitcnt lgkmcnt(9)
  v_mfma_f32_16x16x32_f16 v[56:59], v[12:15], v[88:91], 0
  s_waitcnt lgkmcnt(8)
  v_mfma_f32_16x16x32_f16 v[52:55], v[12:15], v[84:87], 0
  s_waitcnt lgkmcnt(7)
  v_mfma_f32_16x16x32_f16 v[48:51], v[12:15], v[80:83], 0
  ds_read_b64_tr_b16 v[12:13], v24 offset:96
  ds_read_b64_tr_b16 v[14:15], v24 offset:88
  s_waitcnt lgkmcnt(7)
  v_mfma_f32_16x16x32_f16 v[60:63], v[16:19], v[88:91], v[60:63]
  ds_read_b128 v[88:91], v25 offset:1440
  v_mfma_f32_16x16x32_f16 v[56:59], v[16:19], v[84:87], v[56:59]
  v_mfma_f32_16x16x32_f16 v[52:55], v[16:19], v[80:83], v[52:55]
  ds_read_b64_tr_b16 v[16:17], v24 offset:608
  ds_read_b64_tr_b16 v[18:19], v24 offset:600
  s_waitcnt lgkmcnt(8)
  v_mfma_f32_16x16x32_f16 v[60:63], v[20:23], v[84:87], v[60:63]
  ds_read_b128 v[84:87], v25 offset:928
  v_mfma_f32_16x16x32_f16 v[56:59], v[20:23], v[80:83], v[56:59]
  ds_read_b64_tr_b16 v[20:21], v24 offset:1120
  ds_read_b64_tr_b16 v[22:23], v24 offset:1112
  s_waitcnt lgkmcnt(9)
  v_mfma_f32_16x16x32_f16 v[60:63], v[112:115], v[80:83], v[60:63]
  ds_read_b128 v[80:83], v25 offset:416
  ds_read_b64_tr_b16 v[112:113], v24 offset:1632
  ds_read_b64_tr_b16 v[114:115], v24 offset:1624
  s_waitcnt lgkmcnt(9)
  v_mfma_f32_16x16x32_f16 v[60:63], v[12:15], v[92:95], v[60:63]
  ds_read_b128 v[92:95], v25 offset:1888
  s_waitcnt lgkmcnt(9)
  v_mfma_f32_16x16x32_f16 v[56:59], v[12:15], v[88:91], v[56:59]
  s_waitcnt lgkmcnt(6)
  v_mfma_f32_16x16x32_f16 v[52:55], v[12:15], v[84:87], v[52:55]
  s_waitcnt lgkmcnt(3)
  v_mfma_f32_16x16x32_f16 v[48:51], v[12:15], v[80:83], v[48:51]
  ds_read_b64_tr_b16 v[12:13], v24 offset:160
  ds_read_b64_tr_b16 v[14:15], v24 offset:152
  v_mfma_f32_16x16x32_f16 v[60:63], v[16:19], v[88:91], v[60:63]
  ds_read_b128 v[88:91], v25 offset:1376
  v_mfma_f32_16x16x32_f16 v[56:59], v[16:19], v[84:87], v[56:59]
  v_mfma_f32_16x16x32_f16 v[52:55], v[16:19], v[80:83], v[52:55]
  ds_read_b64_tr_b16 v[16:17], v24 offset:672
  ds_read_b64_tr_b16 v[18:19], v24 offset:664
  v_mfma_f32_16x16x32_f16 v[60:63], v[20:23], v[84:87], v[60:63]
  ds_read_b128 v[84:87], v25 offset:864
  v_mfma_f32_16x16x32_f16 v[56:59], v[20:23], v[80:83], v[56:59]
  ds_read_b64_tr_b16 v[20:21], v24 offset:1184
  ds_read_b64_tr_b16 v[22:23], v24 offset:1176
  s_waitcnt lgkmcnt(9)
  v_mfma_f32_16x16x32_f16 v[60:63], v[112:115], v[80:83], v[60:63]
  ds_read_b128 v[80:83], v25 offset:352
  ds_read_b64_tr_b16 v[112:113], v24 offset:1696
  ds_read_b64_tr_b16 v[114:115], v24 offset:1688
  s_waitcnt lgkmcnt(9)
  v_mfma_f32_16x16x32_f16 v[60:63], v[12:15], v[92:95], v[60:63]
  ds_read_b128 v[92:95], v25 offset:1824
  s_waitcnt lgkmcnt(9)
  v_mfma_f32_16x16x32_f16 v[56:59], v[12:15], v[88:91], v[56:59]
  s_waitcnt lgkmcnt(6)
  v_mfma_f32_16x16x32_f16 v[52:55], v[12:15], v[84:87], v[52:55]
  s_waitcnt lgkmcnt(3)
  v_mfma_f32_16x16x32_f16 v[48:51], v[12:15], v[80:83], v[48:51]
  ds_read_b64_tr_b16 v[12:13], v24 offset:224
  ds_read_b64_tr_b16 v[14:15], v24 offset:216
  v_mfma_f32_16x16x32_f16 v[60:63], v[16:19], v[88:91], v[60:63]
  ds_read_b128 v[88:91], v25 offset:1312
  v_mfma_f32_16x16x32_f16 v[56:59], v[16:19], v[84:87], v[56:59]
  v_mfma_f32_16x16x32_f16 v[52:55], v[16:19], v[80:83], v[52:55]
  ds_read_b64_tr_b16 v[16:17], v24 offset:736
  ds_read_b64_tr_b16 v[18:19], v24 offset:728
  v_mfma_f32_16x16x32_f16 v[60:63], v[20:23], v[84:87], v[60:63]
  ds_read_b128 v[84:87], v25 offset:800
  v_mfma_f32_16x16x32_f16 v[56:59], v[20:23], v[80:83], v[56:59]
  ds_read_b64_tr_b16 v[20:21], v24 offset:1248
  ds_read_b64_tr_b16 v[22:23], v24 offset:1240
  s_waitcnt lgkmcnt(9)
  v_mfma_f32_16x16x32_f16 v[60:63], v[112:115], v[80:83], v[60:63]
  ds_read_b128 v[80:83], v25 offset:288
  ds_read_b64_tr_b16 v[112:113], v24 offset:1760
  ds_read_b64_tr_b16 v[114:115], v24 offset:1752
  s_waitcnt lgkmcnt(9)
  v_mfma_f32_16x16x32_f16 v[60:63], v[12:15], v[92:95], v[60:63]
  s_waitcnt lgkmcnt(8)
  v_mfma_f32_16x16x32_f16 v[56:59], v[12:15], v[88:91], v[56:59]
  s_waitcnt lgkmcnt(5)
  v_mfma_f32_16x16x32_f16 v[52:55], v[12:15], v[84:87], v[52:55]
  s_waitcnt lgkmcnt(2)
  v_mfma_f32_16x16x32_f16 v[48:51], v[12:15], v[80:83], v[48:51]
  v_mfma_f32_16x16x32_f16 v[60:63], v[16:19], v[88:91], v[60:63]
  v_mfma_f32_16x16x32_f16 v[56:59], v[16:19], v[84:87], v[56:59]
  v_mfma_f32_16x16x32_f16 v[52:55], v[16:19], v[80:83], v[52:55]
  v_mfma_f32_16x16x32_f16 v[60:63], v[20:23], v[84:87], v[60:63]
  v_mfma_f32_16x16x32_f16 v[56:59], v[20:23], v[80:83], v[56:59]
  s_waitcnt lgkmcnt(0)
  v_mfma_f32_16x16x32_f16 v[60:63], v[112:115], v[80:83], v[60:63]
  s_waitcnt lgkmcnt(0)
  s_nop 6
  ds_write_b128 v26, v[60:63] offset:3072
  ds_write_b128 v26, v[56:59] offset:2048
  ds_write_b128 v26, v[52:55] offset:1024
  ds_write_b128 v26, v[48:51] offset:0
  ds_read_b64 v[96:97], v32 offset:9728
  ds_read_b64 v[100:101], v32 offset:1024
  ds_read_b64 v[98:99], v32 offset:13824
  ds_read_b64 v[102:103], v32 offset:5632
  s_waitcnt lgkmcnt(0)
  s_barrier
  ds_read_b128 v[64:67], v31 offset:0
  ds_read_b128 v[68:71], v31 offset:16384
  ds_read_b128 v[72:75], v31 offset:8192
  ds_read_b128 v[76:79], v31 offset:24576
  v_cvt_f32_f16 v112, v100
  v_cvt_f32_f16 v114, v101
  v_cvt_f32_f16_sdwa v113, v100 dst_sel:DWORD dst_unused:UNUSED_PAD src0_sel:WORD_1
  v_cvt_f32_f16_sdwa v115, v101 dst_sel:DWORD dst_unused:UNUSED_PAD src0_sel:WORD_1
  v_lshlrev_b32 v104, 16, v96
  v_lshlrev_b32 v106, 16, v97
  v_and_b32 v105, 0xffff0000, v96
  v_and_b32 v107, 0xffff0000, v97
  v_fmac_f32 v104, s44, v112
  v_fmac_f32 v106, s44, v114
  v_fmac_f32 v105, s44, v113
  v_fmac_f32 v107, s44, v115
  v_cvt_f32_f16 v112, v102
  v_cvt_f32_f16 v114, v103
  v_cvt_f32_f16_sdwa v113, v102 dst_sel:DWORD dst_unused:UNUSED_PAD src0_sel:WORD_1
  v_cvt_f32_f16_sdwa v115, v103 dst_sel:DWORD dst_unused:UNUSED_PAD src0_sel:WORD_1
  v_lshlrev_b32 v108, 16, v98
  v_lshlrev_b32 v110, 16, v99
  v_and_b32 v109, 0xffff0000, v98
  v_and_b32 v111, 0xffff0000, v99
  v_fmac_f32 v108, s45, v112
  v_fmac_f32 v110, s45, v114
  v_fmac_f32 v109, s45, v113
  v_fmac_f32 v111, s45, v115
  s_waitcnt lgkmcnt(0)
  v_pk_add_f32 v[64:65], v[64:65], v[68:69]
  v_pk_add_f32 v[66:67], v[66:67], v[70:71]
  v_fmac_f32 v104, s64, v64
  v_fmac_f32 v105, s64, v65
  v_fmac_f32 v106, s64, v66
  v_fmac_f32 v107, s64, v67
  v_pk_add_f32 v[72:73], v[72:73], v[76:77]
  v_pk_add_f32 v[74:75], v[74:75], v[78:79]
  v_fmac_f32 v108, s65, v72
  v_fmac_f32 v109, s65, v73
  v_fmac_f32 v110, s65, v74
  v_fmac_f32 v111, s65, v75
  v_cvt_pk_bf16_f32 v112, v104, v108
  v_add_u32 v116, 0, v33
  buffer_store_dword v112, v116, s[92:95], 0 offen
  v_cvt_pk_bf16_f32 v113, v105, v109
  v_add_u32 v117, 1024, v33
  buffer_store_dword v113, v117, s[92:95], 0 offen
  v_cvt_pk_bf16_f32 v114, v106, v110
  v_add_u32 v116, 2048, v33
  buffer_store_dword v114, v116, s[92:95], 0 offen
  v_cvt_pk_bf16_f32 v115, v107, v111
  v_add_u32 v117, 3072, v33
  buffer_store_dword v115, v117, s[92:95], 0 offen
  ds_read_b64_tr_b16 v[12:13], v24 offset:32
  ds_read_b64_tr_b16 v[14:15], v24 offset:24
  ds_read_b128 v[108:111], v25 offset:4064
  ds_read_b128 v[104:107], v25 offset:3552
  ds_read_b128 v[100:103], v25 offset:3040
  ds_read_b128 v[96:99], v25 offset:2528
  ds_read_b128 v[92:95], v25 offset:2016
  ds_read_b128 v[88:91], v25 offset:1504
  ds_read_b128 v[84:87], v25 offset:992
  ds_read_b128 v[80:83], v25 offset:480
  ds_read_b64_tr_b16 v[16:17], v24 offset:544
  ds_read_b64_tr_b16 v[18:19], v24 offset:536
  ds_read_b64_tr_b16 v[20:21], v24 offset:1056
  ds_read_b64_tr_b16 v[22:23], v24 offset:1048
  ds_read_b64_tr_b16 v[112:113], v24 offset:1568
  ds_read_b64_tr_b16 v[114:115], v24 offset:1560
  ds_read_b64_tr_b16 v[116:117], v24 offset:2080
  ds_read_b64_tr_b16 v[118:119], v24 offset:2072
  s_waitcnt lgkmcnt(15)
  v_mfma_f32_16x16x32_f16 v[76:79], v[12:15], v[108:111], 0
  ds_read_b128 v[108:111], v25 offset:4000
  s_waitcnt lgkmcnt(15)
  v_mfma_f32_16x16x32_f16 v[72:75], v[12:15], v[104:107], 0
  s_waitcnt lgkmcnt(14)
  v_mfma_f32_16x16x32_f16 v[68:71], v[12:15], v[100:103], 0
  s_waitcnt lgkmcnt(13)
  v_mfma_f32_16x16x32_f16 v[64:67], v[12:15], v[96:99], 0
  ds_read_b64_tr_b16 v[12:13], v24 offset:2592
  ds_read_b64_tr_b16 v[14:15], v24 offset:2584
  s_waitcnt lgkmcnt(9)
  v_mfma_f32_16x16x32_f16 v[76:79], v[16:19], v[104:107], v[76:79]
  ds_read_b128 v[104:107], v25 offset:3488
  v_mfma_f32_16x16x32_f16 v[72:75], v[16:19], v[100:103], v[72:75]
  v_mfma_f32_16x16x32_f16 v[68:71], v[16:19], v[96:99], v[68:71]
  v_mfma_f32_16x16x32_f16 v[64:67], v[16:19], v[92:95], v[64:67]
  ds_read_b64_tr_b16 v[16:17], v24 offset:3104
  ds_read_b64_tr_b16 v[18:19], v24 offset:3096
  s_waitcnt lgkmcnt(10)
  v_mfma_f32_16x16x32_f16 v[76:79], v[20:23], v[100:103], v[76:79]
  ds_read_b128 v[100:103], v25 offset:2976
  v_mfma_f32_16x16x32_f16 v[72:75], v[20:23], v[96:99], v[72:75]
  v_mfma_f32_16x16x32_f16 v[68:71], v[20:23], v[92:95], v[68:71]
  v_mfma_f32_16x16x32_f16 v[64:67], v[20:23], v[88:91], v[64:67]
  ds_read_b64_tr_b16 v[20:21], v24 offset:3616
  ds_read_b64_tr_b16 v[22:23], v24 offset:3608
  s_waitcnt lgkmcnt(11)
  v_mfma_f32_16x16x32_f16 v[76:79], v[112:115], v[96:99], v[76:79]
  ds_read_b128 v[96:99], v25 offset:2464
  v_mfma_f32_16x16x32_f16 v[72:75], v[112:115], v[92:95], v[72:75]
  v_mfma_f32_16x16x32_f16 v[68:71], v[112:115], v[88:91], v[68:71]
  v_mfma_f32_16x16x32_f16 v[64:67], v[112:115], v[84:87], v[64:67]
  ds_read_b64_tr_b16 v[112:113], v24 offset:96
  ds_read_b64_tr_b16 v[114:115], v24 offset:88
  s_waitcnt lgkmcnt(12)
  v_mfma_f32_16x16x32_f16 v[76:79], v[116:119], v[92:95], v[76:79]
  ds_read_b128 v[92:95], v25 offset:1952
  v_mfma_f32_16x16x32_f16 v[72:75], v[116:119], v[88:91], v[72:75]
  v_mfma_f32_16x16x32_f16 v[68:71], v[116:119], v[84:87], v[68:71]
  v_mfma_f32_16x16x32_f16 v[64:67], v[116:119], v[80:83], v[64:67]
  ds_read_b64_tr_b16 v[116:117], v24 offset:608
  ds_read_b64_tr_b16 v[118:119], v24 offset:600
  s_waitcnt lgkmcnt(12)
  v_mfma_f32_16x16x32_f16 v[76:79], v[12:15], v[88:91], v[76:79]
  ds_read_b128 v[88:91], v25 offset:1440
  v_mfma_f32_16x16x32_f16 v[72:75], v[12:15], v[84:87], v[72:75]
  v_mfma_f32_16x16x32_f16 v[68:71], v[12:15], v[80:83], v[68:71]
  ds_read_b64_tr_b16 v[12:13], v24 offset:1120
  ds_read_b64_tr_b16 v[14:15], v24 offset:1112
  s_waitcnt lgkmcnt(12)
  v_mfma_f32_16x16x32_f16 v[76:79], v[16:19], v[84:87], v[76:79]
  ds_read_b128 v[84:87], v25 offset:928
  v_mfma_f32_16x16x32_f16 v[72:75], v[16:19], v[80:83], v[72:75]
  ds_read_b64_tr_b16 v[16:17], v24 offset:1632
  ds_read_b64_tr_b16 v[18:19], v24 offset:1624
  s_waitcnt lgkmcnt(12)
  v_mfma_f32_16x16x32_f16 v[76:79], v[20:23], v[80:83], v[76:79]
  ds_read_b128 v[80:83], v25 offset:416
  ds_read_b64_tr_b16 v[20:21], v24 offset:2144
  ds_read_b64_tr_b16 v[22:23], v24 offset:2136
  s_waitcnt lgkmcnt(12)
  v_mfma_f32_16x16x32_f16 v[76:79], v[112:115], v[108:111], v[76:79]
  ds_read_b128 v[108:111], v25 offset:3936
  v_mfma_f32_16x16x32_f16 v[72:75], v[112:115], v[104:107], v[72:75]
  v_mfma_f32_16x16x32_f16 v[68:71], v[112:115], v[100:103], v[68:71]
  v_mfma_f32_16x16x32_f16 v[64:67], v[112:115], v[96:99], v[64:67]
  ds_read_b64_tr_b16 v[112:113], v24 offset:2656
  ds_read_b64_tr_b16 v[114:115], v24 offset:2648
  s_waitcnt lgkmcnt(12)
  v_mfma_f32_16x16x32_f16 v[76:79], v[116:119], v[104:107], v[76:79]
  ds_read_b128 v[104:107], v25 offset:3424
  v_mfma_f32_16x16x32_f16 v[72:75], v[116:119], v[100:103], v[72:75]
  v_mfma_f32_16x16x32_f16 v[68:71], v[116:119], v[96:99], v[68:71]
  v_mfma_f32_16x16x32_f16 v[64:67], v[116:119], v[92:95], v[64:67]
  ds_read_b64_tr_b16 v[116:117], v24 offset:3168
  ds_read_b64_tr_b16 v[118:119], v24 offset:3160
  s_waitcnt lgkmcnt(12)
  v_mfma_f32_16x16x32_f16 v[76:79], v[12:15], v[100:103], v[76:79]
  ds_read_b128 v[100:103], v25 offset:2912
  v_mfma_f32_16x16x32_f16 v[72:75], v[12:15], v[96:99], v[72:75]
  v_mfma_f32_16x16x32_f16 v[68:71], v[12:15], v[92:95], v[68:71]
  v_mfma_f32_16x16x32_f16 v[64:67], v[12:15], v[88:91], v[64:67]
  ds_read_b64_tr_b16 v[12:13], v24 offset:3680
  ds_read_b64_tr_b16 v[14:15], v24 offset:3672
  s_waitcnt lgkmcnt(12)
  v_mfma_f32_16x16x32_f16 v[76:79], v[16:19], v[96:99], v[76:79]
  ds_read_b128 v[96:99], v25 offset:2400
  v_mfma_f32_16x16x32_f16 v[72:75], v[16:19], v[92:95], v[72:75]
  v_mfma_f32_16x16x32_f16 v[68:71], v[16:19], v[88:91], v[68:71]
  v_mfma_f32_16x16x32_f16 v[64:67], v[16:19], v[84:87], v[64:67]
  ds_read_b64_tr_b16 v[16:17], v24 offset:160
  ds_read_b64_tr_b16 v[18:19], v24 offset:152
  s_waitcnt lgkmcnt(12)
  v_mfma_f32_16x16x32_f16 v[76:79], v[20:23], v[92:95], v[76:79]
  ds_read_b128 v[92:95], v25 offset:1888
  v_mfma_f32_16x16x32_f16 v[72:75], v[20:23], v[88:91], v[72:75]
  v_mfma_f32_16x16x32_f16 v[68:71], v[20:23], v[84:87], v[68:71]
  v_mfma_f32_16x16x32_f16 v[64:67], v[20:23], v[80:83], v[64:67]
  ds_read_b64_tr_b16 v[20:21], v24 offset:672
  ds_read_b64_tr_b16 v[22:23], v24 offset:664
  s_waitcnt lgkmcnt(12)
  v_mfma_f32_16x16x32_f16 v[76:79], v[112:115], v[88:91], v[76:79]
  ds_read_b128 v[88:91], v25 offset:1376
  v_mfma_f32_16x16x32_f16 v[72:75], v[112:115], v[84:87], v[72:75]
  v_mfma_f32_16x16x32_f16 v[68:71], v[112:115], v[80:83], v[68:71]
  ds_read_b64_tr_b16 v[112:113], v24 offset:1184
  ds_read_b64_tr_b16 v[114:115], v24 offset:1176
  s_waitcnt lgkmcnt(12)
  v_mfma_f32_16x16x32_f16 v[76:79], v[116:119], v[84:87], v[76:79]
  ds_read_b128 v[84:87], v25 offset:864
  v_mfma_f32_16x16x32_f16 v[72:75], v[116:119], v[80:83], v[72:75]
  ds_read_b64_tr_b16 v[116:117], v24 offset:1696
  ds_read_b64_tr_b16 v[118:119], v24 offset:1688
  s_waitcnt lgkmcnt(12)
  v_mfma_f32_16x16x32_f16 v[76:79], v[12:15], v[80:83], v[76:79]
  ds_read_b128 v[80:83], v25 offset:352
  ds_read_b64_tr_b16 v[12:13], v24 offset:2208
  ds_read_b64_tr_b16 v[14:15], v24 offset:2200
  s_waitcnt lgkmcnt(12)
  v_mfma_f32_16x16x32_f16 v[76:79], v[16:19], v[108:111], v[76:79]
  ds_read_b128 v[108:111], v25 offset:3872
  v_mfma_f32_16x16x32_f16 v[72:75], v[16:19], v[104:107], v[72:75]
  v_mfma_f32_16x16x32_f16 v[68:71], v[16:19], v[100:103], v[68:71]
  v_mfma_f32_16x16x32_f16 v[64:67], v[16:19], v[96:99], v[64:67]
  ds_read_b64_tr_b16 v[16:17], v24 offset:2720
  ds_read_b64_tr_b16 v[18:19], v24 offset:2712
  s_waitcnt lgkmcnt(12)
  v_mfma_f32_16x16x32_f16 v[76:79], v[20:23], v[104:107], v[76:79]
  ds_read_b128 v[104:107], v25 offset:3360
  v_mfma_f32_16x16x32_f16 v[72:75], v[20:23], v[100:103], v[72:75]
  v_mfma_f32_16x16x32_f16 v[68:71], v[20:23], v[96:99], v[68:71]
  v_mfma_f32_16x16x32_f16 v[64:67], v[20:23], v[92:95], v[64:67]
  ds_read_b64_tr_b16 v[20:21], v24 offset:3232
  ds_read_b64_tr_b16 v[22:23], v24 offset:3224
  s_waitcnt lgkmcnt(12)
  v_mfma_f32_16x16x32_f16 v[76:79], v[112:115], v[100:103], v[76:79]
  ds_read_b128 v[100:103], v25 offset:2848
  v_mfma_f32_16x16x32_f16 v[72:75], v[112:115], v[96:99], v[72:75]
  v_mfma_f32_16x16x32_f16 v[68:71], v[112:115], v[92:95], v[68:71]
  v_mfma_f32_16x16x32_f16 v[64:67], v[112:115], v[88:91], v[64:67]
  ds_read_b64_tr_b16 v[112:113], v24 offset:3744
  ds_read_b64_tr_b16 v[114:115], v24 offset:3736
  s_waitcnt lgkmcnt(12)
  v_mfma_f32_16x16x32_f16 v[76:79], v[116:119], v[96:99], v[76:79]
  ds_read_b128 v[96:99], v25 offset:2336
  v_mfma_f32_16x16x32_f16 v[72:75], v[116:119], v[92:95], v[72:75]
  v_mfma_f32_16x16x32_f16 v[68:71], v[116:119], v[88:91], v[68:71]
  v_mfma_f32_16x16x32_f16 v[64:67], v[116:119], v[84:87], v[64:67]
  ds_read_b64_tr_b16 v[116:117], v24 offset:224
  ds_read_b64_tr_b16 v[118:119], v24 offset:216
  s_waitcnt lgkmcnt(12)
  v_mfma_f32_16x16x32_f16 v[76:79], v[12:15], v[92:95], v[76:79]
  ds_read_b128 v[92:95], v25 offset:1824
  v_mfma_f32_16x16x32_f16 v[72:75], v[12:15], v[88:91], v[72:75]
  v_mfma_f32_16x16x32_f16 v[68:71], v[12:15], v[84:87], v[68:71]
  v_mfma_f32_16x16x32_f16 v[64:67], v[12:15], v[80:83], v[64:67]
  ds_read_b64_tr_b16 v[12:13], v24 offset:736
  ds_read_b64_tr_b16 v[14:15], v24 offset:728
  s_waitcnt lgkmcnt(12)
  v_mfma_f32_16x16x32_f16 v[76:79], v[16:19], v[88:91], v[76:79]
  ds_read_b128 v[88:91], v25 offset:1312
  v_mfma_f32_16x16x32_f16 v[72:75], v[16:19], v[84:87], v[72:75]
  v_mfma_f32_16x16x32_f16 v[68:71], v[16:19], v[80:83], v[68:71]
  ds_read_b64_tr_b16 v[16:17], v24 offset:1248
  ds_read_b64_tr_b16 v[18:19], v24 offset:1240
  s_waitcnt lgkmcnt(12)
  v_mfma_f32_16x16x32_f16 v[76:79], v[20:23], v[84:87], v[76:79]
  ds_read_b128 v[84:87], v25 offset:800
  v_mfma_f32_16x16x32_f16 v[72:75], v[20:23], v[80:83], v[72:75]
  ds_read_b64_tr_b16 v[20:21], v24 offset:1760
  ds_read_b64_tr_b16 v[22:23], v24 offset:1752
  s_waitcnt lgkmcnt(12)
  v_mfma_f32_16x16x32_f16 v[76:79], v[112:115], v[80:83], v[76:79]
  ds_read_b128 v[80:83], v25 offset:288
  ds_read_b64_tr_b16 v[112:113], v24 offset:2272
  ds_read_b64_tr_b16 v[114:115], v24 offset:2264
  s_waitcnt lgkmcnt(12)
  v_mfma_f32_16x16x32_f16 v[76:79], v[116:119], v[108:111], v[76:79]
  v_mfma_f32_16x16x32_f16 v[72:75], v[116:119], v[104:107], v[72:75]
  v_mfma_f32_16x16x32_f16 v[68:71], v[116:119], v[100:103], v[68:71]
  v_mfma_f32_16x16x32_f16 v[64:67], v[116:119], v[96:99], v[64:67]
  ds_read_b64_tr_b16 v[116:117], v24 offset:2784
  ds_read_b64_tr_b16 v[118:119], v24 offset:2776
  s_waitcnt lgkmcnt(11)
  v_mfma_f32_16x16x32_f16 v[76:79], v[12:15], v[104:107], v[76:79]
  v_mfma_f32_16x16x32_f16 v[72:75], v[12:15], v[100:103], v[72:75]
  v_mfma_f32_16x16x32_f16 v[68:71], v[12:15], v[96:99], v[68:71]
  v_mfma_f32_16x16x32_f16 v[64:67], v[12:15], v[92:95], v[64:67]
  ds_read_b64_tr_b16 v[12:13], v24 offset:3296
  ds_read_b64_tr_b16 v[14:15], v24 offset:3288
  s_waitcnt lgkmcnt(10)
  v_mfma_f32_16x16x32_f16 v[76:79], v[16:19], v[100:103], v[76:79]
  v_mfma_f32_16x16x32_f16 v[72:75], v[16:19], v[96:99], v[72:75]
  v_mfma_f32_16x16x32_f16 v[68:71], v[16:19], v[92:95], v[68:71]
  v_mfma_f32_16x16x32_f16 v[64:67], v[16:19], v[88:91], v[64:67]
  ds_read_b64_tr_b16 v[16:17], v24 offset:3808
  ds_read_b64_tr_b16 v[18:19], v24 offset:3800
  s_waitcnt lgkmcnt(9)
  v_mfma_f32_16x16x32_f16 v[76:79], v[20:23], v[96:99], v[76:79]
  v_mfma_f32_16x16x32_f16 v[72:75], v[20:23], v[92:95], v[72:75]
  v_mfma_f32_16x16x32_f16 v[68:71], v[20:23], v[88:91], v[68:71]
  v_mfma_f32_16x16x32_f16 v[64:67], v[20:23], v[84:87], v[64:67]
  s_waitcnt lgkmcnt(6)
  v_mfma_f32_16x16x32_f16 v[76:79], v[112:115], v[92:95], v[76:79]
  v_mfma_f32_16x16x32_f16 v[72:75], v[112:115], v[88:91], v[72:75]
  v_mfma_f32_16x16x32_f16 v[68:71], v[112:115], v[84:87], v[68:71]
  v_mfma_f32_16x16x32_f16 v[64:67], v[112:115], v[80:83], v[64:67]
  s_waitcnt lgkmcnt(4)
  v_mfma_f32_16x16x32_f16 v[76:79], v[116:119], v[88:91], v[76:79]
  v_mfma_f32_16x16x32_f16 v[72:75], v[116:119], v[84:87], v[72:75]
  v_mfma_f32_16x16x32_f16 v[68:71], v[116:119], v[80:83], v[68:71]
  s_waitcnt lgkmcnt(2)
  v_mfma_f32_16x16x32_f16 v[76:79], v[12:15], v[84:87], v[76:79]
  v_mfma_f32_16x16x32_f16 v[72:75], v[12:15], v[80:83], v[72:75]
  s_waitcnt lgkmcnt(0)
  v_mfma_f32_16x16x32_f16 v[76:79], v[16:19], v[80:83], v[76:79]
  s_waitcnt lgkmcnt(0)
  s_nop 6
  ds_write_b128 v26, v[76:79] offset:7168
  ds_write_b128 v26, v[72:75] offset:6144
  ds_write_b128 v26, v[68:71] offset:5120
  ds_write_b128 v26, v[64:67] offset:4096
  ds_read_b64 v[96:97], v32 offset:11776
  ds_read_b64 v[100:101], v32 offset:3072
  ds_read_b64 v[98:99], v32 offset:15872
  ds_read_b64 v[102:103], v32 offset:7680
  s_waitcnt lgkmcnt(0)
  s_barrier
  ds_read_b128 v[80:83], v31 offset:4096
  ds_read_b128 v[84:87], v31 offset:20480
  ds_read_b128 v[88:91], v31 offset:12288
  ds_read_b128 v[92:95], v31 offset:28672
  v_cvt_f32_f16 v112, v100
  v_cvt_f32_f16 v114, v101
  v_cvt_f32_f16_sdwa v113, v100 dst_sel:DWORD dst_unused:UNUSED_PAD src0_sel:WORD_1
  v_cvt_f32_f16_sdwa v115, v101 dst_sel:DWORD dst_unused:UNUSED_PAD src0_sel:WORD_1
  v_lshlrev_b32 v104, 16, v96
  v_lshlrev_b32 v106, 16, v97
  v_and_b32 v105, 0xffff0000, v96
  v_and_b32 v107, 0xffff0000, v97
  v_fmac_f32 v104, s44, v112
  v_fmac_f32 v106, s44, v114
  v_fmac_f32 v105, s44, v113
  v_fmac_f32 v107, s44, v115
  v_cvt_f32_f16 v112, v102
  v_cvt_f32_f16 v114, v103
  v_cvt_f32_f16_sdwa v113, v102 dst_sel:DWORD dst_unused:UNUSED_PAD src0_sel:WORD_1
  v_cvt_f32_f16_sdwa v115, v103 dst_sel:DWORD dst_unused:UNUSED_PAD src0_sel:WORD_1
  v_lshlrev_b32 v108, 16, v98
  v_lshlrev_b32 v110, 16, v99
  v_and_b32 v109, 0xffff0000, v98
  v_and_b32 v111, 0xffff0000, v99
  v_fmac_f32 v108, s45, v112
  v_fmac_f32 v110, s45, v114
  v_fmac_f32 v109, s45, v113
  v_fmac_f32 v111, s45, v115
  s_waitcnt lgkmcnt(0)
  v_pk_add_f32 v[80:81], v[80:81], v[84:85]
  v_pk_add_f32 v[82:83], v[82:83], v[86:87]
  v_fmac_f32 v104, s64, v80
  v_fmac_f32 v105, s64, v81
  v_fmac_f32 v106, s64, v82
  v_fmac_f32 v107, s64, v83
  v_pk_add_f32 v[88:89], v[88:89], v[92:93]
  v_pk_add_f32 v[90:91], v[90:91], v[94:95]
  v_fmac_f32 v108, s65, v88
  v_fmac_f32 v109, s65, v89
  v_fmac_f32 v110, s65, v90
  v_fmac_f32 v111, s65, v91
  v_cvt_pk_bf16_f32 v112, v104, v108
  v_add_u32 v116, 1048576, v33
  buffer_store_dword v112, v116, s[92:95], 0 offen
  v_cvt_pk_bf16_f32 v113, v105, v109
  v_add_u32 v117, 1049600, v33
  buffer_store_dword v113, v117, s[92:95], 0 offen
  v_cvt_pk_bf16_f32 v114, v106, v110
  v_add_u32 v116, 1050624, v33
  buffer_store_dword v114, v116, s[92:95], 0 offen
  v_cvt_pk_bf16_f32 v115, v107, v111
  v_add_u32 v117, 1051648, v33
  buffer_store_dword v115, v117, s[92:95], 0 offen
L_end:
  s_endpgm
.section .rodata,"a"
.p2align 6
.amdhsa_kernel interleave_layers__linear_kernel_hedgehog__ssm_conv_s4d__prompt_kernel
  .amdhsa_next_free_vgpr 512
  .amdhsa_next_free_sgpr 100
  .amdhsa_accum_offset 256
  .amdhsa_group_segment_fixed_size 0
  .amdhsa_kernarg_size 112
  .amdhsa_user_sgpr_count 2
  .amdhsa_user_sgpr_kernarg_segment_ptr 1
  .amdhsa_system_sgpr_workgroup_id_x 1
  .amdhsa_float_denorm_mode_32 3
.end_amdhsa_kernel
```
